```python
import torch

def _softmax(x, axis=-1):
    return torch.softmax(x, dim=axis)

def _gelu(x):
    return torch.nn.functional.gelu(x, approximate='tanh')

def _silu(x):
    return torch.nn.functional.silu(x)

def _sigmoid(x):
    return torch.sigmoid(x)

def _layernorm(x, axis=-1, eps=1e-05):
    m = x.mean(dim=axis, keepdim=True)
    v = x.var(dim=axis, keepdim=True, unbiased=False)
    return (x - m) / torch.sqrt(v + eps)

def _scatter_add(tgt, idx, src, axis=0):
    return tgt.clone().index_add_(axis, idx, src)

def _segment_sum(src, seg, n):
    out = torch.zeros((n,) + src.shape[1:], dtype=src.dtype)
    return out.index_add_(0, seg, src)

def _pad(x, pw):
    flat = tuple((v for pair in reversed(pw) for v in pair))
    return torch.nn.functional.pad(x, flat)
kernel_name = 'interleave_layers__ssm_conv_h3__memory_aug_recurrent_mem_tr__prompt'

def setup_inputs():

    _w = lambda a: (lambda t: t.to(torch.bfloat16) if t.is_floating_point() else t)(torch.as_tensor(a))

    def _A_setup():
        B, S, D = (1, 2048, 512)
        ks = 4
        return {'q': _w((lambda *s: torch.randn(*s, dtype=torch.bfloat16) * 0.05)(B, S, D)), 'k': _w((lambda *s: torch.randn(*s, dtype=torch.bfloat16) * 0.2)(B, S, D)), 'v': _w((lambda *s: torch.randn(*s, dtype=torch.bfloat16) * 0.2)(B, S, D)), 'shift_k': _w((lambda *s: torch.randn(*s, dtype=torch.bfloat16) * 0.2)(D, ks) * 0.5), 'ssm_k': _w((lambda *s: torch.randn(*s, dtype=torch.bfloat16) * 0.4)(D, S) * (1.0 / S ** 0.5)), 'ssm_D': _w((lambda *s: torch.randn(*s, dtype=torch.bfloat16) * 0.2)(D))}
    _A_in = _A_setup()

    def _B_setup():
        B, S, Dm = (1, 2048, 512)
        H, Dh = (32, 128)
        M, seg = (8, 32)
        seg = min(seg, S)
        S = S // seg * seg
        return {'x': _w((lambda *s: torch.randn(*s, dtype=torch.bfloat16) * 0.05)(B, S, Dm)), 'mem0': _w((lambda *s: torch.randn(*s, dtype=torch.bfloat16) * 0.2)(B, M, Dm)), 'Wq': _w((lambda *s: torch.randn(*s, dtype=torch.bfloat16) * 1.6)(Dm, H, Dh) * Dm ** (-0.5)), 'Wk': _w((lambda *s: torch.randn(*s, dtype=torch.bfloat16) * 1.6)(Dm, H, Dh) * Dm ** (-0.5)), 'Wv': _w((lambda *s: torch.randn(*s, dtype=torch.bfloat16) * 0.2)(Dm, H, Dh) * Dm ** (-0.5)), 'Wo': _w((lambda *s: torch.randn(*s, dtype=torch.bfloat16) * 0.2)(H, Dh, Dm) * (H * Dh) ** (-0.5)), 'seg_len': seg}
    _B_in = _B_setup()
    return {'A_q': _A_in['q'], 'A_k': _A_in['k'], 'A_v': _A_in['v'], 'A_shift_k': _A_in['shift_k'], 'A_ssm_k': _A_in['ssm_k'], 'A_ssm_D': _A_in['ssm_D'], 'B_x': _B_in['x'], 'B_mem0': _B_in['mem0'], 'B_Wq': _B_in['Wq'], 'B_Wk': _B_in['Wk'], 'B_Wv': _B_in['Wv'], 'B_Wo': _B_in['Wo'], 'B_seg_len': _B_in['seg_len']}

def reference(A_q, A_k, A_v, A_shift_k, A_ssm_k, A_ssm_D, B_x, B_mem0, B_Wq, B_Wk, B_Wv, B_Wo, B_seg_len):

    def _A_ref(q, k, v, shift_k, ssm_k, ssm_D):
        B, S, D = q.shape
        ks = shift_k.shape[-1]
        k_pad = _pad(k, ((0, 0), (ks - 1, 0), (0, 0)))
        k_shift = torch.zeros_like(k)
        for t in range(ks):
            k_shift = k_shift + k_pad[:, t:t + S, :] * shift_k[:, ks - 1 - t][None, None, :]
        kv = k_shift * v
        L = 2 * S
        kv_pad = _pad(kv, ((0, 0), (0, S), (0, 0)))
        kf_pad = _pad(ssm_k, ((0, 0), (0, S)))
        kv_f = (lambda x, axes=(-2, -1): torch.fft.rfft2(x.float(), dim=axes))(kv_pad[:, None, :, :], axes=(1, 2))
        kf_f = (lambda x, axes=(-2, -1): torch.fft.rfft2(x.float(), dim=axes))(kf_pad[:, None, :], axes=(1, 2))
        kf_f = (lambda x, *d: x.permute(*d))(kf_f, 1, 2, 0)
        y_f = kv_f * kf_f[None, :, :, :]
        y = (lambda x, s, axes=(-2, -1): torch.fft.irfft2(x, s=s, dim=axes).to(torch.bfloat16))(y_f, (1, L), axes=(1, 2))[:, 0, :S, :]
        y = y + kv * ssm_D[None, None, :]
        return q * y

    def _B_ref(x, mem0, Wq, Wk, Wv, Wo, seg_len):
        B, S, Dm = x.shape
        H, Dh = (Wq.shape[1], Wq.shape[2])
        M = mem0.shape[1]
        scale = Dh ** (-0.5)
        n_seg = S // seg_len
        L = M + seg_len
        idx = torch.arange(L)
        mask = (idx[:, None] < M) | (idx[:, None] >= idx[None, :])
        mem = mem0
        outs = []
        for s in range(n_seg):
            xs = x[:, s * seg_len:(s + 1) * seg_len, :].clone()
            h = torch.concatenate([mem, xs], axis=1)
            q = torch.einsum('btd,dhe->bhte', h, Wq)
            k = torch.einsum('btd,dhe->bhte', h, Wk)
            v = torch.einsum('btd,dhe->bhte', h, Wv)
            scores = torch.einsum('bhqe,bhke->bhqk', q, k) * scale
            scores = torch.where(mask[None, None], scores, -1000000000.0)
            p = _softmax(scores, axis=-1)
            o = torch.einsum('bhqk,bhke->bhqe', p, v)
            o = torch.einsum('bhte,hed->btd', o, Wo)
            mem = o[:, :M, :].clone()
            outs.append(o[:, M:, :])
        return torch.concatenate(outs, axis=1)
    x = A_q
    x = x + _A_ref(_layernorm(x, axis=-1), A_k, A_v, A_shift_k, A_ssm_k, A_ssm_D)
    x = x + _B_ref(_layernorm(x, axis=-1), B_mem0, B_Wq, B_Wk, B_Wv, B_Wo, B_seg_len)
    x = x + _A_ref(_layernorm(x, axis=-1), A_k, A_v, A_shift_k, A_ssm_k, A_ssm_D)
    x = x + _B_ref(_layernorm(x, axis=-1), B_mem0, B_Wq, B_Wk, B_Wv, B_Wo, B_seg_len)
    return x
```

```asm
; @launch grid=(256,1,1) block=(256,1,1) lds=163840
.amdgcn_target "amdgcn-amd-amdhsa--gfx950"
.text
.globl interleave_layers__ssm_conv_h3__memory_aug_recurrent_mem_tr__prompt_kernel
.p2align 8
.type interleave_layers__ssm_conv_h3__memory_aug_recurrent_mem_tr__prompt_kernel,@function
interleave_layers__ssm_conv_h3__memory_aug_recurrent_mem_tr__prompt_kernel:
    s_cmp_ge_u32 s2, 256
    s_cbranch_scc1 main_exit
    s_getpc_b64 s[20:21]
main_pc:
    s_mov_b32 s22, main_end - main_pc
    s_mov_b32 s23, 0x00020000
    s_mov_b32 s24, 32768
    v_lshlrev_b32_e64 v1, 7, v0
    buffer_load_dword v253, v1, s[20:23], 0 offen
    buffer_load_dword v253, v1, s[20:23], s24 offen
    s_load_dwordx2 s[4:5], s[0:1], 112
    s_load_dwordx2 s[8:9], s[0:1], 120
    s_load_dwordx2 s[56:57], s[0:1], 104
    s_load_dwordx2 s[68:69], s[0:1], 64
    s_load_dwordx2 s[72:73], s[0:1], 72
    s_load_dwordx2 s[76:77], s[0:1], 80
    s_load_dwordx2 s[80:81], s[0:1], 88
    s_mov_b32 s70, 4194304
    s_mov_b32 s71, 0x00020000
    s_mov_b32 s74, 4194304
    s_mov_b32 s75, 0x00020000
    s_mov_b32 s78, 4194304
    s_mov_b32 s79, 0x00020000
    s_mov_b32 s82, 4194304
    s_mov_b32 s83, 0x00020000
    s_mov_b32 s3, 1000000
    s_mov_b32 s6, 256
    s_mov_b32 s7, 0x00020000
    s_mov_b32 s10, 268435456
    s_mov_b32 s11, 0x00020000
    s_mov_b32 s58, 2097152
    s_mov_b32 s59, 0x00020000
    v_lshrrev_b32 v1, 6, v0
    s_nop 0
    v_readfirstlane_b32 s12, v1
    s_mov_b32 s18, 1040356334
    s_mov_b32 s19, 4286709633
    s_getreg_b32 s84, hwreg(HW_REG_XCC_ID, 0, 4)
    s_waitcnt lgkmcnt(0)
    s_lshl_b32 s22, s84, 2
    s_lshr_b32 s22, 1966227808, s22
    s_and_b32 s22, s22, 7
    s_cmp_lt_u32 s84, 8
    s_cselect_b32 s84, s22, s84
    v_mov_b32 v254, v0
    s_lshr_b32 s13, s2, 3
    s_and_b32 s14, s84, 7
    v_mov_b32 v255, -1
    s_cmp_lt_u32 s84, 8
    s_cselect_b32 s67, 1, 0
    s_cmp_eq_u32 s12, 0
    s_cselect_b32 s67, s67, 0
    s_branch main_dispatch
    s_nop 0
    s_nop 0
    s_nop 0
    s_nop 0
    s_nop 0
    s_nop 0
main_late:
    s_waitcnt vmcnt(0) lgkmcnt(0)
    s_cmp_lg_u32 s12, 0
    s_cbranch_scc1 main_late_wait
    s_mov_b64 exec, 1
    s_mov_b32 s24, 64
    s_cmp_ge_u32 s84, 8
    s_cbranch_scc1 main_late_tot
    v_mov_b32 v2, 1
    s_lshl_b32 s22, s84, 2
    buffer_atomic_add v2, off, s[4:7], s22 offset:32 sc0
    s_waitcnt vmcnt(0)
    v_readfirstlane_b32 s24, v2
main_late_tot:
    v_mov_b32 v2, 1
    buffer_atomic_add v2, off, s[4:7], 0 offset:64
    s_mov_b64 exec, 0x1ffff
    v_and_b32 v3, 63, v254
    v_lshlrev_b32_e64 v3, 2, v3
main_late_poll:
    s_sub_u32 s3, s3, 1
    s_cbranch_scc1 main_timeout
    buffer_load_dword v2, v3, s[4:7], 0 offen sc1
    s_waitcnt vmcnt(0)
    v_readlane_b32 s25, v2, 16
    v_readlane_b32 s32, v2, 0
    s_nop 0
    s_bcnt1_i32_b32 s22, s32
    s_add_u32 s25, s25, s22
    v_readlane_b32 s33, v2, 1
    s_nop 0
    s_bcnt1_i32_b32 s22, s33
    s_add_u32 s25, s25, s22
    v_readlane_b32 s34, v2, 2
    s_nop 0
    s_bcnt1_i32_b32 s22, s34
    s_add_u32 s25, s25, s22
    v_readlane_b32 s35, v2, 3
    s_nop 0
    s_bcnt1_i32_b32 s22, s35
    s_add_u32 s25, s25, s22
    v_readlane_b32 s36, v2, 4
    s_nop 0
    s_bcnt1_i32_b32 s22, s36
    s_add_u32 s25, s25, s22
    v_readlane_b32 s37, v2, 5
    s_nop 0
    s_bcnt1_i32_b32 s22, s37
    s_add_u32 s25, s25, s22
    v_readlane_b32 s38, v2, 6
    s_nop 0
    s_bcnt1_i32_b32 s22, s38
    s_add_u32 s25, s25, s22
    v_readlane_b32 s39, v2, 7
    s_nop 0
    s_bcnt1_i32_b32 s22, s39
    s_add_u32 s25, s25, s22
    s_cmp_lt_u32 s25, 256
    s_cbranch_scc1 main_late_poll
    buffer_load_dword v2, v3, s[4:7], 0 offen sc1
    s_waitcnt vmcnt(0)
    s_mov_b64 exec, 1
    s_and_b32 s26, s84, 7
    s_nop 1
    s_nop 1
    v_readlane_b32 s27, v2, s26
    s_nop 0
    s_bcnt0_i32_b32 s22, s27
    s_cmp_lt_u32 s24, s22
    s_cbranch_scc1 main_late_pick
    v_mov_b32_e64 v4, 1
    buffer_atomic_add v4, off, s[4:7], 0 offset:68 sc0
    s_waitcnt vmcnt(0)
    v_readfirstlane_b32 s28, v4
    s_mov_b32 s26, 0
main_late_scan:
    s_add_u32 s29, s26, 8
    s_nop 1
    s_nop 1
    v_readlane_b32 s27, v2, s26
    v_readlane_b32 s24, v2, s29
    s_bcnt0_i32_b32 s22, s27
    s_min_u32 s24, s24, s22
    s_sub_u32 s22, s22, s24
    s_cmp_lt_u32 s28, s22
    s_cbranch_scc1 main_late_found
    s_sub_u32 s28, s28, s22
    s_add_u32 s26, s26, 1
    s_cmp_lt_u32 s26, 8
    s_cbranch_scc1 main_late_scan
    s_branch main_timeout
    s_nop 0
    s_nop 0
main_late_found:
    s_add_u32 s24, s24, s28
    s_lshl_b32 s22, 1, s26
    v_mov_b32 v4, s22
    buffer_atomic_or v4, off, s[4:7], 0 offset:132
main_late_pick:
    s_ff0_i32_b32 s22, s27
    s_bitset1_b32 s27, s22
    s_sub_u32 s24, s24, 1
    s_cbranch_scc0 main_late_pick
    v_mov_b32 v2, s26
    v_mov_b32 v3, s22
    v_mov_b32 v4, 0
    ds_write_b64 v4, v[2:3]
    s_waitcnt vmcnt(0) lgkmcnt(0)
    s_mov_b64 exec, -1
main_late_wait:
    s_barrier
    v_mov_b32 v4, 0
    ds_read_b64 v[2:3], v4
    s_waitcnt lgkmcnt(0)
    v_readfirstlane_b32 s14, v2
    v_readfirstlane_b32 s13, v3
    s_barrier
    s_and_b32 s14, s14, 7
    s_and_b32 s13, s13, 31
    v_mov_b32 v255, 0
    v_mov_b32_e64 v0, v254
main_dispatch:
    s_lshr_b32 s16, 0xca, s14
    s_and_b32 s16, s16, 1
    s_cbranch_scc1 pre_role
    s_cmp_eq_u32 s67, 0
    s_cbranch_scc1 clm_1
    s_lshl_b32 s21, 1, s13
    v_mov_b32_e64 v255, s21
    s_lshl_b32 s22, s14, 2
    s_mov_b64 exec, 1
    buffer_atomic_or v255, off, s[4:7], s22 sc0
    s_mov_b64 exec, -1
    s_mov_b32 s67, 0
    s_branch clm_1_d
clm_1:
    buffer_load_dword v253, off, s[4:7], 0 offset:1024
clm_1_d:
main_roles:
    s_cmp_lt_u32 s14, 2
    s_cbranch_scc1 chain_role
    s_cmp_lt_u32 s14, 4
    s_cbranch_scc1 kv_role
    s_branch at_role
    s_nop 0
    s_nop 0
    s_nop 0
    s_nop 0
main_exit:
    s_endpgm
    s_nop 0
    s_nop 0
    s_nop 0
    s_nop 0
    s_nop 0
    s_nop 0
    s_nop 0
main_timeout:
    s_mov_b64 exec, 1
    v_mov_b32 v2, 1
    buffer_atomic_add v2, off, s[4:7], 0 offset:72
    s_waitcnt vmcnt(0)
    s_endpgm
chain_role:
    v_and_b32 v0, 63, v0
    s_mov_b32 s33, 0
    s_and_b32 s38, s33, 6
    s_lshl_b32 s38, s38, 2
    s_and_b32 s22, s33, 8
    s_lshl_b32 s22, s22, 3
    s_or_b32 s38, s38, s22
    s_and_b32 s22, s33, 1
    s_lshl_b32 s22, s22, 5
    s_or_b32 s38, s38, s22
    s_mov_b32 s38, 0
    v_lshrrev_b32 v62, 4, v0
    v_lshlrev_b32 v53, 2, v62
    v_xor_b32 v53, v53, v0
    v_and_b32 v53, 15, v53
    v_lshlrev_b32 v53, 4, v53
    v_bfe_u32 v52, v0, 4, 1
    v_lshl_add_u32 v52, v52, 13, v53
    v_lshrrev_b32 v54, 5, v0
    v_lshl_add_u32 v52, v54, 18, v52
    v_lshl_add_u32 v53, v62, 10, v53
    s_lshl_b32 s40, s13, 8
    s_lshl_b32 s42, s12, 20
    s_add_u32 s40, s40, s42
    s_lshl_b32 s41, s13, 17
    s_lshl_b32 s42, s12, 8
    s_add_u32 s41, s41, s42
    s_lshl_b32 s42, s12, 13
    s_add_u32 s42, s42, 32768
    s_lshl_b32 s39, s12, 15
    s_and_b32 s22, s38, 32
    s_lshl_b32 s22, s22, 13
    v_xor_b32 v52, s22, v52
    s_and_b32 s20, s38, 0x58
    s_lshl_b32 s20, s20, 13
    s_add_u32 s43, s40, 0
    s_add_u32 m0, s42, 0
    s_xor_b32 s23, s43, s20
    buffer_load_dwordx4 v52, s[68:71], s23 offen lds
    s_add_u32 s43, s43, 16384
    s_add_u32 m0, s42, 1024
    s_xor_b32 s23, s43, s20
    buffer_load_dwordx4 v52, s[68:71], s23 offen lds
    s_add_u32 s43, s43, 16384
    s_add_u32 m0, s42, 2048
    s_xor_b32 s23, s43, s20
    buffer_load_dwordx4 v52, s[68:71], s23 offen lds
    s_add_u32 s43, s43, 16384
    s_add_u32 m0, s42, 3072
    s_xor_b32 s23, s43, s20
    buffer_load_dwordx4 v52, s[68:71], s23 offen lds
    s_add_u32 s43, s43, 16384
    s_add_u32 m0, s42, 4096
    s_xor_b32 s23, s43, s20
    buffer_load_dwordx4 v52, s[68:71], s23 offen lds
    s_add_u32 s43, s43, 16384
    s_add_u32 m0, s42, 5120
    s_xor_b32 s23, s43, s20
    buffer_load_dwordx4 v52, s[68:71], s23 offen lds
    s_add_u32 s43, s43, 16384
    s_add_u32 m0, s42, 6144
    s_xor_b32 s23, s43, s20
    buffer_load_dwordx4 v52, s[68:71], s23 offen lds
    s_add_u32 s43, s43, 16384
    s_add_u32 m0, s42, 7168
    s_xor_b32 s23, s43, s20
    buffer_load_dwordx4 v52, s[68:71], s23 offen lds
    v_lshrrev_b32 v62, 4, v0
    v_lshlrev_b32_e64 v58, 11, v62
    v_bfe_u32 v62, v0, 2, 2
    v_mul_u32_u24 v62, 320, v62
    v_add_u32 v58, v58, v62
    v_and_b32 v62, 3, v0
    v_lshl_add_u32 v58, v62, 4, v58
    s_lshl_b32 s43, s12, 6
    v_xor_b32 v54, s43, v58
    v_add_u32 v54, s42, v54
    v_add_u32 v58, s42, v58
    v_xor_b32 v55, 8192, v54
    v_xor_b32_e64 v59, 64, v58
    v_xor_b32 v56, 16384, v54
    v_xor_b32 v60, 128, v58
    v_xor_b32 v57, 24576, v54
    v_xor_b32 v61, 192, v58
    s_waitcnt vmcnt(8)
    v_mov_b32 v3, 0
    s_cmp_lg_u32 s12, 0
    s_cbranch_scc1 rdy_2
    s_mov_b64 exec, 1
    ds_write_b32 v3, v255
    s_mov_b64 exec, -1
    s_waitcnt lgkmcnt(0)
rdy_2:
    s_barrier
    ds_read_b32 v2, v3
    s_waitcnt lgkmcnt(0)
    v_readfirstlane_b32 s22, v2
    s_barrier
    s_bitcmp1_b32 s22, s13
    s_cbranch_scc1 main_late
    v_lshlrev_b32 v1, 4, v0
    v_add_u32 v2, s42, v1
    v_add_u32 v7, 65536, v2
    s_lshl_b32 s21, s12, 11
    v_add_u32_e64 v3, s21, v1
    v_xor_b32 v4, 2048, v3
    v_xor_b32 v5, 4096, v3
    v_xor_b32 v6, 6144, v3
    v_bfe_u32 v11, v0, 3, 1
    v_mul_u32_u24 v48, 0xaaaa, v11
    v_add_u32 v48, 0x4444, v48
    v_and_b32 v49, 31, v0
    v_lshlrev_b32 v49, 7, v49
    v_add_u32 v49, 524288, v49
    v_lshrrev_b32 v10, 2, v0
    s_lshl_b32 s22, s12, 5
    v_add_u32 v10, s22, v10
    v_lshlrev_b32 v10, 11, v10
    v_and_b32 v11, 3, v0
    v_lshlrev_b32 v11, 4, v11
    v_lshrrev_b32 v8, 2, v0
    v_mul_u32_u24 v8, 0, v8
    s_lshl_b32 s22, s13, 0
    s_lshr_b32 s23, s22, 5
    s_or_b32 s22, s22, s23
    s_mul_i32 s23, s12, 0
    s_add_u32 s22, s22, s23
    v_add_u32 v8, s22, v8
    v_and_b32 v8, 31, v8
    v_lshlrev_b32 v8, 6, v8
    v_add3_u32 v8, v10, v11, v8
    v_lshrrev_b32 v10, 4, v0
    v_lshlrev_b32_e64 v10, 3, v10
    s_lshl_b32 s22, s13, 2
    s_add_u32 s24, s22, s12
    s_lshl_b32 s22, s24, 6
    v_add3_u32 v9, v10, v11, s22
    v_and_b32 v10, 15, v0
    v_mov_b32 v12, 0
    v_mov_b32 v11, 0x3f80
    v_cmp_eq_u32 vcc, 0, v10
    s_nop 1
    v_cndmask_b32 v12, v12, v11, vcc
    v_mov_b32 v11, 0x3f800000
    v_cmp_eq_u32 vcc, 1, v10
    s_nop 1
    v_cndmask_b32 v12, v12, v11, vcc
    v_mov_b32 v13, 0
    v_mov_b32 v11, 0x3f80
    v_cmp_eq_u32 vcc, 2, v10
    s_nop 1
    v_cndmask_b32 v13, v13, v11, vcc
    v_mov_b32 v11, 0x3f800000
    v_cmp_eq_u32 vcc, 3, v10
    s_nop 1
    v_cndmask_b32 v13, v13, v11, vcc
    v_mov_b32 v14, 0
    v_mov_b32 v11, 0x3f80
    v_cmp_eq_u32 vcc, 4, v10
    s_nop 1
    v_cndmask_b32 v14, v14, v11, vcc
    v_mov_b32 v11, 0x3f800000
    v_cmp_eq_u32 vcc, 5, v10
    s_nop 1
    v_cndmask_b32 v14, v14, v11, vcc
    v_mov_b32 v15, 0
    v_mov_b32 v11, 0x3f80
    v_cmp_eq_u32 vcc, 6, v10
    s_nop 1
    v_cndmask_b32 v15, v15, v11, vcc
    v_mov_b32 v11, 0x3f800000
    v_cmp_eq_u32 vcc, 7, v10
    s_nop 1
    v_cndmask_b32 v15, v15, v11, vcc
    v_and_b32 v10, 7, v0
    v_bfe_u32 v11, v0, 4, 1
    v_lshlrev_b32 v11, 2, v11
    v_sub_u32 v10, v10, v11
    v_mov_b32 v50, 0
    v_mov_b32 v11, 0x3f80
    v_cmp_eq_u32 vcc, 0, v10
    s_nop 1
    v_cndmask_b32 v50, v50, v11, vcc
    v_mov_b32 v11, 0x3f800000
    v_cmp_eq_u32 vcc, 1, v10
    s_nop 1
    v_cndmask_b32 v50, v50, v11, vcc
    v_mov_b32 v51, 0
    v_mov_b32 v11, 0x3f80
    v_cmp_eq_u32 vcc, 2, v10
    s_nop 1
    v_cndmask_b32 v51, v51, v11, vcc
    v_mov_b32_e64 v11, 0x3f800000
    v_cmp_eq_u32_e64 vcc, 3, v10
    s_nop 0
    s_nop 0
    v_cndmask_b32 v51, v51, v11, vcc
    s_lshl_b32 s50, s16, 20
    s_add_u32 s50, s50, 140509184
    s_add_u32 s53, s50, 32768
    s_lshl_b32 s22, s24, 11
    s_add_u32 s51, s50, s22
    s_xor_b32 s49, s51, 0x80000
    s_lshl_b32 s26, s16, 14
    s_add_u32 s26, s26, 142606336
    s_add_u32 s48, s26, 8192
    s_add_u32 s52, s48, s21
    s_mul_i32 s22, s16, 16777216
    s_mul_i32 s23, s13, 8192
    s_add_u32 s22, s22, s23
    s_add_u32 s22, s22, s21
    s_lshl_b32 s28, s22, 1
    s_add_u32 s28, s28, 0
    s_add_u32 s30, s22, 75497472
    s_lshl_b32 s22, s16, 14
    s_lshl_b32 s23, s24, 7
    s_add_u32 s22, s22, s23
    s_add_u32 s31, s22, 143654912
    s_add_u32 s32, s22, 143687680
    s_mov_b32 s34, 0x00ff00ff
    s_mov_b32 s35, 0x00ff00ff
    s_mov_b32 s36, 0x000f000f
    s_mov_b32 s37, 0
    v_mov_b32 v128, s19
    v_mov_b32 v129, s19
    v_mov_b32_e64 v130, s19
    v_mov_b32_e64 v131, s19
    buffer_store_dwordx4 v[128:131], v1, s[8:11], s51 offen sc1
    buffer_store_dwordx4 v[128:131], v1, s[8:11], s51 offen offset:1024 sc1
    s_mov_b64 exec, 0x000f000f
    buffer_store_dwordx2 v[128:129], v9, s[8:11], s48 offen sc1
    s_mov_b64 exec, -1
    s_add_u32 s43, s40, 131072
    s_add_u32 m0, s42, 32768
    s_xor_b32 s23, s43, s20
    buffer_load_dwordx4 v52, s[68:71], s23 offen lds
    s_add_u32 s43, s43, 16384
    s_add_u32 m0, s42, 33792
    s_xor_b32 s23, s43, s20
    buffer_load_dwordx4 v52, s[68:71], s23 offen lds
    s_add_u32 s43, s43, 16384
    s_add_u32 m0, s42, 34816
    s_xor_b32 s23, s43, s20
    buffer_load_dwordx4 v52, s[68:71], s23 offen lds
    s_add_u32 s43, s43, 16384
    s_add_u32 m0, s42, 35840
    s_xor_b32 s23, s43, s20
    buffer_load_dwordx4 v52, s[68:71], s23 offen lds
    s_add_u32 s43, s43, 16384
    s_add_u32 m0, s42, 36864
    s_xor_b32 s23, s43, s20
    buffer_load_dwordx4 v52, s[68:71], s23 offen lds
    s_add_u32 s43, s43, 16384
    s_add_u32 m0, s42, 37888
    s_xor_b32 s23, s43, s20
    buffer_load_dwordx4 v52, s[68:71], s23 offen lds
    s_add_u32 s43, s43, 16384
    s_add_u32 m0, s42, 38912
    s_xor_b32 s23, s43, s20
    buffer_load_dwordx4 v52, s[68:71], s23 offen lds
    s_add_u32 s43, s43, 16384
    s_add_u32 m0, s42, 39936
    s_xor_b32 s23, s43, s20
    buffer_load_dwordx4 v52, s[68:71], s23 offen lds
    s_waitcnt vmcnt(8)
    s_barrier
    s_cmp_lg_u32 s12, 0
    s_cbranch_scc1 cnt_3
    s_mov_b64 exec, 1
    s_add_u32 s22, s16, 1
    v_mov_b32 v10, s22
    s_lshl_b32 s22, s16, 3
    buffer_atomic_add v10, off, s[4:7], s22 offset:128
    s_cmp_eq_u32 s16, 0
    s_cbranch_scc1 cnt_3_x
    v_mov_b32_e64 v253, 3
    buffer_store_dword v253, off, s[8:11], s55 sc1
cnt_3_x:
    s_mov_b64 exec, -1
cnt_3:
    s_add_u32 s43, s40, 0
    s_add_u32 m0, s42, 65536
    s_xor_b32 s23, s43, s20
    buffer_load_dwordx4 v52, s[72:75], s23 offen lds
    s_add_u32 s43, s43, 16384
    s_add_u32 m0, s42, 66560
    s_xor_b32 s23, s43, s20
    buffer_load_dwordx4 v52, s[72:75], s23 offen lds
    s_add_u32 s43, s43, 16384
    s_add_u32 m0, s42, 67584
    s_xor_b32 s23, s43, s20
    buffer_load_dwordx4 v52, s[72:75], s23 offen lds
    s_add_u32 s43, s43, 16384
    s_add_u32 m0, s42, 68608
    s_xor_b32 s23, s43, s20
    buffer_load_dwordx4 v52, s[72:75], s23 offen lds
    s_add_u32 s43, s43, 16384
    s_add_u32 m0, s42, 69632
    s_xor_b32 s23, s43, s20
    buffer_load_dwordx4 v52, s[72:75], s23 offen lds
    s_add_u32 s43, s43, 16384
    s_add_u32 m0, s42, 70656
    s_xor_b32 s23, s43, s20
    buffer_load_dwordx4 v52, s[72:75], s23 offen lds
    s_add_u32 s43, s43, 16384
    s_add_u32 m0, s42, 71680
    s_xor_b32 s23, s43, s20
    buffer_load_dwordx4 v52, s[72:75], s23 offen lds
    s_add_u32 s43, s43, 16384
    s_add_u32 m0, s42, 72704
    s_xor_b32 s23, s43, s20
    buffer_load_dwordx4 v52, s[72:75], s23 offen lds
    s_waitcnt vmcnt(16)
    s_barrier
    s_add_u32 s43, s40, 131072
    s_add_u32 m0, s42, 98304
    s_xor_b32 s23, s43, s20
    buffer_load_dwordx4 v52, s[72:75], s23 offen lds
    s_add_u32 s43, s43, 16384
    s_add_u32 m0, s42, 99328
    s_xor_b32 s23, s43, s20
    buffer_load_dwordx4 v52, s[72:75], s23 offen lds
    s_add_u32 s43, s43, 16384
    s_add_u32 m0, s42, 100352
    s_xor_b32 s23, s43, s20
    buffer_load_dwordx4 v52, s[72:75], s23 offen lds
    s_add_u32 s43, s43, 16384
    s_add_u32 m0, s42, 101376
    s_xor_b32 s23, s43, s20
    buffer_load_dwordx4 v52, s[72:75], s23 offen lds
    s_add_u32 s43, s43, 16384
    s_add_u32 m0, s42, 102400
    s_xor_b32 s23, s43, s20
    buffer_load_dwordx4 v52, s[72:75], s23 offen lds
    s_add_u32 s43, s43, 16384
    s_add_u32 m0, s42, 103424
    s_xor_b32 s23, s43, s20
    buffer_load_dwordx4 v52, s[72:75], s23 offen lds
    s_add_u32 s43, s43, 16384
    s_add_u32 m0, s42, 104448
    s_xor_b32 s23, s43, s20
    buffer_load_dwordx4 v52, s[72:75], s23 offen lds
    s_add_u32 s43, s43, 16384
    s_add_u32 m0, s42, 105472
    s_xor_b32 s23, s43, s20
    buffer_load_dwordx4 v52, s[72:75], s23 offen lds
    ds_read_b64_tr_b16 a[0:1], v54 offset:0
    ds_read_b64_tr_b16 a[2:3], v54 offset:1024
    ds_read_b64_tr_b16 a[8:9], v54 offset:8
    ds_read_b64_tr_b16 a[10:11], v54 offset:1032
    ds_read_b64_tr_b16 a[80:81], v55 offset:0
    ds_read_b64_tr_b16 a[82:83], v55 offset:1024
    ds_read_b64_tr_b16 a[88:89], v55 offset:8
    ds_read_b64_tr_b16 a[90:91], v55 offset:1032
    ds_read_b64_tr_b16 a[96:97], v56 offset:0
    ds_read_b64_tr_b16 a[98:99], v56 offset:1024
    ds_read_b64_tr_b16 a[104:105], v56 offset:8
    ds_read_b64_tr_b16 a[106:107], v56 offset:1032
    ds_read_b64_tr_b16 a[112:113], v57 offset:0
    ds_read_b64_tr_b16 a[114:115], v57 offset:1024
    ds_read_b64_tr_b16 a[120:121], v57 offset:8
    ds_read_b64_tr_b16 a[122:123], v57 offset:1032
    s_waitcnt lgkmcnt(0)
    s_waitcnt vmcnt(16)
    s_barrier
    s_add_u32 s43, s40, 524288
    s_add_u32 m0, s42, 0
    s_xor_b32 s23, s43, s20
    buffer_load_dwordx4 v52, s[72:75], s23 offen lds
    s_add_u32 s43, s43, 16384
    s_add_u32 m0, s42, 1024
    s_xor_b32 s23, s43, s20
    buffer_load_dwordx4 v52, s[72:75], s23 offen lds
    s_add_u32 s43, s43, 16384
    s_add_u32 m0, s42, 2048
    s_xor_b32 s23, s43, s20
    buffer_load_dwordx4 v52, s[72:75], s23 offen lds
    s_add_u32 s43, s43, 16384
    s_add_u32 m0, s42, 3072
    s_xor_b32 s23, s43, s20
    buffer_load_dwordx4 v52, s[72:75], s23 offen lds
    s_add_u32 s43, s43, 16384
    s_add_u32 m0, s42, 4096
    s_xor_b32 s23, s43, s20
    buffer_load_dwordx4 v52, s[72:75], s23 offen lds
    s_add_u32 s43, s43, 16384
    s_add_u32 m0, s42, 5120
    s_xor_b32 s23, s43, s20
    buffer_load_dwordx4 v52, s[72:75], s23 offen lds
    s_add_u32 s43, s43, 16384
    s_add_u32 m0, s42, 6144
    s_xor_b32 s23, s43, s20
    buffer_load_dwordx4 v52, s[72:75], s23 offen lds
    s_add_u32 s43, s43, 16384
    s_add_u32 m0, s42, 7168
    s_xor_b32 s23, s43, s20
    buffer_load_dwordx4 v52, s[72:75], s23 offen lds
    ds_read_b64_tr_b16 a[4:5], v54 offset:32768
    ds_read_b64_tr_b16 a[6:7], v54 offset:33792
    ds_read_b64_tr_b16 a[12:13], v54 offset:32776
    ds_read_b64_tr_b16 a[14:15], v54 offset:33800
    ds_read_b64_tr_b16 a[84:85], v55 offset:32768
    ds_read_b64_tr_b16 a[86:87], v55 offset:33792
    ds_read_b64_tr_b16 a[92:93], v55 offset:32776
    ds_read_b64_tr_b16 a[94:95], v55 offset:33800
    ds_read_b64_tr_b16 a[100:101], v56 offset:32768
    ds_read_b64_tr_b16 a[102:103], v56 offset:33792
    ds_read_b64_tr_b16 a[108:109], v56 offset:32776
    ds_read_b64_tr_b16 a[110:111], v56 offset:33800
    ds_read_b64_tr_b16 a[116:117], v57 offset:32768
    ds_read_b64_tr_b16 a[118:119], v57 offset:33792
    ds_read_b64_tr_b16 a[124:125], v57 offset:32776
    ds_read_b64_tr_b16 a[126:127], v57 offset:33800
    s_waitcnt lgkmcnt(0)
    s_waitcnt vmcnt(16)
    s_barrier
    s_add_u32 s43, s40, 655360
    s_add_u32 m0, s42, 32768
    s_xor_b32 s23, s43, s20
    buffer_load_dwordx4 v52, s[72:75], s23 offen lds
    s_add_u32 s43, s43, 16384
    s_add_u32 m0, s42, 33792
    s_xor_b32 s23, s43, s20
    buffer_load_dwordx4 v52, s[72:75], s23 offen lds
    s_add_u32 s43, s43, 16384
    s_add_u32 m0, s42, 34816
    s_xor_b32 s23, s43, s20
    buffer_load_dwordx4 v52, s[72:75], s23 offen lds
    s_add_u32 s43, s43, 16384
    s_add_u32 m0, s42, 35840
    s_xor_b32 s23, s43, s20
    buffer_load_dwordx4 v52, s[72:75], s23 offen lds
    s_add_u32 s43, s43, 16384
    s_add_u32 m0, s42, 36864
    s_xor_b32 s23, s43, s20
    buffer_load_dwordx4 v52, s[72:75], s23 offen lds
    s_add_u32 s43, s43, 16384
    s_add_u32 m0, s42, 37888
    s_xor_b32 s23, s43, s20
    buffer_load_dwordx4 v52, s[72:75], s23 offen lds
    s_add_u32 s43, s43, 16384
    s_add_u32 m0, s42, 38912
    s_xor_b32 s23, s43, s20
    buffer_load_dwordx4 v52, s[72:75], s23 offen lds
    s_add_u32 s43, s43, 16384
    s_add_u32 m0, s42, 39936
    s_xor_b32 s23, s43, s20
    buffer_load_dwordx4 v52, s[72:75], s23 offen lds
    v_add_u32 v54, 65536, v54
    v_add_u32 v55, 65536, v55
    v_add_u32 v56, 65536, v56
    v_add_u32 v57, 65536, v57
    v_add_u32 v58, 65536, v58
    v_add_u32 v59, 65536, v59
    v_add_u32 v60, 65536, v60
    v_add_u32 v61, 65536, v61
    ds_read_b64_tr_b16 a[16:17], v54 offset:0
    ds_read_b64_tr_b16 a[18:19], v54 offset:1024
    ds_read_b64_tr_b16 a[24:25], v54 offset:8
    ds_read_b64_tr_b16 a[26:27], v54 offset:1032
    ds_read_b64_tr_b16 a[128:129], v55 offset:0
    ds_read_b64_tr_b16 a[130:131], v55 offset:1024
    ds_read_b64_tr_b16 a[136:137], v55 offset:8
    ds_read_b64_tr_b16 a[138:139], v55 offset:1032
    ds_read_b64_tr_b16 a[160:161], v56 offset:0
    ds_read_b64_tr_b16 a[162:163], v56 offset:1024
    ds_read_b64_tr_b16 a[168:169], v56 offset:8
    ds_read_b64_tr_b16 a[170:171], v56 offset:1032
    ds_read_b64_tr_b16 a[192:193], v57 offset:0
    ds_read_b64_tr_b16 a[194:195], v57 offset:1024
    ds_read_b64_tr_b16 a[200:201], v57 offset:8
    ds_read_b64_tr_b16 a[202:203], v57 offset:1032
    s_waitcnt lgkmcnt(0)
    s_waitcnt vmcnt(16)
    s_barrier
    s_add_u32 s43, s40, 0
    s_add_u32 m0, s42, 65536
    s_xor_b32 s23, s43, s20
    buffer_load_dwordx4 v52, s[76:79], s23 offen lds
    s_add_u32 s43, s43, 16384
    s_add_u32 m0, s42, 66560
    s_xor_b32 s23, s43, s20
    buffer_load_dwordx4 v52, s[76:79], s23 offen lds
    s_add_u32 s43, s43, 16384
    s_add_u32 m0, s42, 67584
    s_xor_b32 s23, s43, s20
    buffer_load_dwordx4 v52, s[76:79], s23 offen lds
    s_add_u32 s43, s43, 16384
    s_add_u32 m0, s42, 68608
    s_xor_b32 s23, s43, s20
    buffer_load_dwordx4 v52, s[76:79], s23 offen lds
    s_add_u32 s43, s43, 16384
    s_add_u32 m0, s42, 69632
    s_xor_b32 s23, s43, s20
    buffer_load_dwordx4 v52, s[76:79], s23 offen lds
    s_add_u32 s43, s43, 16384
    s_add_u32 m0, s42, 70656
    s_xor_b32 s23, s43, s20
    buffer_load_dwordx4 v52, s[76:79], s23 offen lds
    s_add_u32 s43, s43, 16384
    s_add_u32 m0, s42, 71680
    s_xor_b32 s23, s43, s20
    buffer_load_dwordx4 v52, s[76:79], s23 offen lds
    s_add_u32 s43, s43, 16384
    s_add_u32 m0, s42, 72704
    s_xor_b32 s23, s43, s20
    buffer_load_dwordx4 v52, s[76:79], s23 offen lds
    ds_read_b64_tr_b16 a[20:21], v54 offset:32768
    ds_read_b64_tr_b16 a[22:23], v54 offset:33792
    ds_read_b64_tr_b16 a[28:29], v54 offset:32776
    ds_read_b64_tr_b16 a[30:31], v54 offset:33800
    ds_read_b64_tr_b16 a[132:133], v55 offset:32768
    ds_read_b64_tr_b16 a[134:135], v55 offset:33792
    ds_read_b64_tr_b16 a[140:141], v55 offset:32776
    ds_read_b64_tr_b16 a[142:143], v55 offset:33800
    ds_read_b64_tr_b16 a[164:165], v56 offset:32768
    ds_read_b64_tr_b16 a[166:167], v56 offset:33792
    ds_read_b64_tr_b16 a[172:173], v56 offset:32776
    ds_read_b64_tr_b16 a[174:175], v56 offset:33800
    ds_read_b64_tr_b16 a[196:197], v57 offset:32768
    ds_read_b64_tr_b16 a[198:199], v57 offset:33792
    ds_read_b64_tr_b16 a[204:205], v57 offset:32776
    ds_read_b64_tr_b16 a[206:207], v57 offset:33800
    s_waitcnt lgkmcnt(0)
    s_waitcnt vmcnt(16)
    s_barrier
    v_and_b32 v10, 7, v0
    v_lshlrev_b32_e64 v10, 10, v10
    v_bfe_u32 v11, v0, 3, 1
    v_lshl_add_u32 v10, v11, 6, v10
    v_lshrrev_b32_e64 v11, 4, v0
    v_lshl_add_u32 v10, v11, 4, v10
    s_lshl_b32 s22, s38, 1
    v_xor_b32_e64 v10, s22, v10
    v_xor_b32 v11, 128, v10
    s_lshl_b32 s22, s12, 8
    s_load_dwordx2 s[44:45], s[0:1], 56
    s_mov_b32 s46, 8192
    s_mov_b32 s47, 0x00020000
    s_waitcnt lgkmcnt(0)
    buffer_load_dwordx4 v[16:19], v10, s[44:47], s22 offen
    buffer_load_dwordx4 v[20:23], v11, s[44:47], s22 offen
    s_add_u32 s43, s40, 131072
    s_add_u32 m0, s42, 98304
    s_xor_b32 s23, s43, s20
    buffer_load_dwordx4 v52, s[76:79], s23 offen lds
    s_add_u32 s43, s43, 16384
    s_add_u32 m0, s42, 99328
    s_xor_b32 s23, s43, s20
    buffer_load_dwordx4 v52, s[76:79], s23 offen lds
    s_add_u32 s43, s43, 16384
    s_add_u32 m0, s42, 100352
    s_xor_b32 s23, s43, s20
    buffer_load_dwordx4 v52, s[76:79], s23 offen lds
    s_add_u32 s43, s43, 16384
    s_add_u32 m0, s42, 101376
    s_xor_b32 s23, s43, s20
    buffer_load_dwordx4 v52, s[76:79], s23 offen lds
    s_add_u32 s43, s43, 16384
    s_add_u32 m0, s42, 102400
    s_xor_b32 s23, s43, s20
    buffer_load_dwordx4 v52, s[76:79], s23 offen lds
    s_add_u32 s43, s43, 16384
    s_add_u32 m0, s42, 103424
    s_xor_b32 s23, s43, s20
    buffer_load_dwordx4 v52, s[76:79], s23 offen lds
    s_add_u32 s43, s43, 16384
    s_add_u32 m0, s42, 104448
    s_xor_b32 s23, s43, s20
    buffer_load_dwordx4 v52, s[76:79], s23 offen lds
    s_add_u32 s43, s43, 16384
    s_add_u32 m0, s42, 105472
    s_xor_b32 s23, s43, s20
    buffer_load_dwordx4 v52, s[76:79], s23 offen lds
    v_add_u32 v54, 4294901760, v54
    v_add_u32 v55, 4294901760, v55
    v_add_u32 v56, 4294901760, v56
    v_add_u32 v57, 4294901760, v57
    v_add_u32 v58, 4294901760, v58
    v_add_u32 v59, 4294901760, v59
    v_add_u32 v60, 4294901760, v60
    v_add_u32 v61, 4294901760, v61
    ds_read_b64_tr_b16 a[48:49], v54 offset:0
    ds_read_b64_tr_b16 a[50:51], v54 offset:1024
    ds_read_b64_tr_b16 a[56:57], v54 offset:8
    ds_read_b64_tr_b16 a[58:59], v54 offset:1032
    ds_read_b64_tr_b16 a[144:145], v55 offset:0
    ds_read_b64_tr_b16 a[146:147], v55 offset:1024
    ds_read_b64_tr_b16 a[152:153], v55 offset:8
    ds_read_b64_tr_b16 a[154:155], v55 offset:1032
    ds_read_b64_tr_b16 a[176:177], v56 offset:0
    ds_read_b64_tr_b16 a[178:179], v56 offset:1024
    ds_read_b64_tr_b16 a[184:185], v56 offset:8
    ds_read_b64_tr_b16 a[186:187], v56 offset:1032
    ds_read_b64_tr_b16 a[208:209], v57 offset:0
    ds_read_b64_tr_b16 a[210:211], v57 offset:1024
    ds_read_b64_tr_b16 a[216:217], v57 offset:8
    ds_read_b64_tr_b16 a[218:219], v57 offset:1032
    s_waitcnt lgkmcnt(0)
    s_waitcnt vmcnt(16)
    s_barrier
    s_add_u32 s43, s40, 524288
    s_add_u32 m0, s42, 0
    s_xor_b32 s23, s43, s20
    buffer_load_dwordx4 v52, s[76:79], s23 offen lds
    s_add_u32 s43, s43, 16384
    s_add_u32 m0, s42, 1024
    s_xor_b32 s23, s43, s20
    buffer_load_dwordx4 v52, s[76:79], s23 offen lds
    s_add_u32 s43, s43, 16384
    s_add_u32 m0, s42, 2048
    s_xor_b32 s23, s43, s20
    buffer_load_dwordx4 v52, s[76:79], s23 offen lds
    s_add_u32 s43, s43, 16384
    s_add_u32 m0, s42, 3072
    s_xor_b32 s23, s43, s20
    buffer_load_dwordx4 v52, s[76:79], s23 offen lds
    s_add_u32 s43, s43, 16384
    s_add_u32 m0, s42, 4096
    s_xor_b32 s23, s43, s20
    buffer_load_dwordx4 v52, s[76:79], s23 offen lds
    s_add_u32 s43, s43, 16384
    s_add_u32 m0, s42, 5120
    s_xor_b32 s23, s43, s20
    buffer_load_dwordx4 v52, s[76:79], s23 offen lds
    s_add_u32 s43, s43, 16384
    s_add_u32 m0, s42, 6144
    s_xor_b32 s23, s43, s20
    buffer_load_dwordx4 v52, s[76:79], s23 offen lds
    s_add_u32 s43, s43, 16384
    s_add_u32 m0, s42, 7168
    s_xor_b32 s23, s43, s20
    buffer_load_dwordx4 v52, s[76:79], s23 offen lds
    ds_read_b64_tr_b16 a[52:53], v54 offset:32768
    ds_read_b64_tr_b16 a[54:55], v54 offset:33792
    ds_read_b64_tr_b16 a[60:61], v54 offset:32776
    ds_read_b64_tr_b16 a[62:63], v54 offset:33800
    ds_read_b64_tr_b16 a[148:149], v55 offset:32768
    ds_read_b64_tr_b16 a[150:151], v55 offset:33792
    ds_read_b64_tr_b16 a[156:157], v55 offset:32776
    ds_read_b64_tr_b16 a[158:159], v55 offset:33800
    ds_read_b64_tr_b16 a[180:181], v56 offset:32768
    ds_read_b64_tr_b16 a[182:183], v56 offset:33792
    ds_read_b64_tr_b16 a[188:189], v56 offset:32776
    ds_read_b64_tr_b16 a[190:191], v56 offset:33800
    ds_read_b64_tr_b16 a[212:213], v57 offset:32768
    ds_read_b64_tr_b16 a[214:215], v57 offset:33792
    ds_read_b64_tr_b16 a[220:221], v57 offset:32776
    ds_read_b64_tr_b16 a[222:223], v57 offset:33800
    s_waitcnt lgkmcnt(0)
    s_waitcnt vmcnt(16)
    s_barrier
    s_add_u32 s43, s40, 655360
    s_add_u32 m0, s42, 32768
    s_xor_b32 s23, s43, s20
    buffer_load_dwordx4 v52, s[76:79], s23 offen lds
    s_add_u32 s43, s43, 16384
    s_add_u32 m0, s42, 33792
    s_xor_b32 s23, s43, s20
    buffer_load_dwordx4 v52, s[76:79], s23 offen lds
    s_add_u32 s43, s43, 16384
    s_add_u32 m0, s42, 34816
    s_xor_b32 s23, s43, s20
    buffer_load_dwordx4 v52, s[76:79], s23 offen lds
    s_add_u32 s43, s43, 16384
    s_add_u32 m0, s42, 35840
    s_xor_b32 s23, s43, s20
    buffer_load_dwordx4 v52, s[76:79], s23 offen lds
    s_add_u32 s43, s43, 16384
    s_add_u32 m0, s42, 36864
    s_xor_b32 s23, s43, s20
    buffer_load_dwordx4 v52, s[76:79], s23 offen lds
    s_add_u32 s43, s43, 16384
    s_add_u32 m0, s42, 37888
    s_xor_b32 s23, s43, s20
    buffer_load_dwordx4 v52, s[76:79], s23 offen lds
    s_add_u32 s43, s43, 16384
    s_add_u32 m0, s42, 38912
    s_xor_b32 s23, s43, s20
    buffer_load_dwordx4 v52, s[76:79], s23 offen lds
    s_add_u32 s43, s43, 16384
    s_add_u32 m0, s42, 39936
    s_xor_b32 s23, s43, s20
    buffer_load_dwordx4 v52, s[76:79], s23 offen lds
    v_add_u32 v54, 65536, v54
    v_add_u32 v55, 65536, v55
    v_add_u32 v56, 65536, v56
    v_add_u32 v57, 65536, v57
    v_add_u32 v58, 65536, v58
    v_add_u32 v59, 65536, v59
    v_add_u32 v60, 65536, v60
    v_add_u32 v61, 65536, v61
    ds_read_b64_tr_b16 a[32:33], v54 offset:0
    ds_read_b64_tr_b16 a[34:35], v54 offset:1024
    ds_read_b64_tr_b16 a[40:41], v54 offset:8
    ds_read_b64_tr_b16 a[42:43], v54 offset:1032
    ds_read_b64_tr_b16 a[224:225], v55 offset:0
    ds_read_b64_tr_b16 a[226:227], v55 offset:1024
    ds_read_b64_tr_b16 a[232:233], v55 offset:8
    ds_read_b64_tr_b16 a[234:235], v55 offset:1032
    ds_read_b64_tr_b16 v[136:137], v56 offset:0
    ds_read_b64_tr_b16 v[138:139], v56 offset:1024
    ds_read_b64_tr_b16 v[144:145], v56 offset:8
    ds_read_b64_tr_b16 v[146:147], v56 offset:1032
    ds_read_b64_tr_b16 v[168:169], v57 offset:0
    ds_read_b64_tr_b16 v[170:171], v57 offset:1024
    ds_read_b64_tr_b16 v[176:177], v57 offset:8
    ds_read_b64_tr_b16 v[178:179], v57 offset:1032
    s_waitcnt lgkmcnt(0)
    s_waitcnt vmcnt(16)
    s_barrier
    s_xor_b32 s43, s39, 32768
    s_add_u32 s43, s43, s41
    s_add_u32 m0, s42, 65536
    s_nop 0
    buffer_load_dwordx4 v53, s[80:83], s43 offen lds
    s_add_u32 s43, s43, 4096
    s_add_u32 m0, s42, 66560
    s_nop 0
    buffer_load_dwordx4 v53, s[80:83], s43 offen lds
    s_add_u32 s43, s43, 4096
    s_add_u32 m0, s42, 67584
    s_nop 0
    buffer_load_dwordx4 v53, s[80:83], s43 offen lds
    s_add_u32 s43, s43, 4096
    s_add_u32 m0, s42, 68608
    s_nop 0
    buffer_load_dwordx4 v53, s[80:83], s43 offen lds
    s_add_u32 s43, s43, 4096
    s_add_u32 m0, s42, 69632
    s_nop 0
    buffer_load_dwordx4 v53, s[80:83], s43 offen lds
    s_add_u32 s43, s43, 4096
    s_add_u32 m0, s42, 70656
    s_nop 0
    buffer_load_dwordx4 v53, s[80:83], s43 offen lds
    s_add_u32 s43, s43, 4096
    s_add_u32 m0, s42, 71680
    s_nop 0
    buffer_load_dwordx4 v53, s[80:83], s43 offen lds
    s_add_u32 s43, s43, 4096
    s_add_u32 m0, s42, 72704
    s_nop 0
    buffer_load_dwordx4 v53, s[80:83], s43 offen lds
    ds_read_b64_tr_b16 a[36:37], v54 offset:32768
    ds_read_b64_tr_b16 a[38:39], v54 offset:33792
    ds_read_b64_tr_b16 a[44:45], v54 offset:32776
    ds_read_b64_tr_b16 a[46:47], v54 offset:33800
    ds_read_b64_tr_b16 a[228:229], v55 offset:32768
    ds_read_b64_tr_b16 a[230:231], v55 offset:33792
    ds_read_b64_tr_b16 a[236:237], v55 offset:32776
    ds_read_b64_tr_b16 a[238:239], v55 offset:33800
    ds_read_b64_tr_b16 v[140:141], v56 offset:32768
    ds_read_b64_tr_b16 v[142:143], v56 offset:33792
    ds_read_b64_tr_b16 v[148:149], v56 offset:32776
    ds_read_b64_tr_b16 v[150:151], v56 offset:33800
    ds_read_b64_tr_b16 v[172:173], v57 offset:32768
    ds_read_b64_tr_b16 v[174:175], v57 offset:33792
    ds_read_b64_tr_b16 v[180:181], v57 offset:32776
    ds_read_b64_tr_b16 v[182:183], v57 offset:33800
    s_waitcnt lgkmcnt(0)
    s_waitcnt vmcnt(16)
    s_barrier
    s_xor_b32 s43, s39, 98304
    s_add_u32 s43, s43, s41
    s_add_u32 m0, s42, 98304
    s_nop 0
    buffer_load_dwordx4 v53, s[80:83], s43 offen lds
    s_add_u32 s43, s43, 4096
    s_add_u32 m0, s42, 99328
    s_nop 0
    buffer_load_dwordx4 v53, s[80:83], s43 offen lds
    s_add_u32 s43, s43, 4096
    s_add_u32 m0, s42, 100352
    s_nop 0
    buffer_load_dwordx4 v53, s[80:83], s43 offen lds
    s_add_u32 s43, s43, 4096
    s_add_u32 m0, s42, 101376
    s_nop 0
    buffer_load_dwordx4 v53, s[80:83], s43 offen lds
    s_add_u32 s43, s43, 4096
    s_add_u32 m0, s42, 102400
    s_nop 0
    buffer_load_dwordx4 v53, s[80:83], s43 offen lds
    s_add_u32 s43, s43, 4096
    s_add_u32 m0, s42, 103424
    s_nop 0
    buffer_load_dwordx4 v53, s[80:83], s43 offen lds
    s_add_u32 s43, s43, 4096
    s_add_u32 m0, s42, 104448
    s_nop 0
    buffer_load_dwordx4 v53, s[80:83], s43 offen lds
    s_add_u32 s43, s43, 4096
    s_add_u32 m0, s42, 105472
    s_nop 0
    buffer_load_dwordx4 v53, s[80:83], s43 offen lds
    v_add_u32 v54, 4294901760, v54
    v_add_u32 v55, 4294901760, v55
    v_add_u32 v56, 4294901760, v56
    v_add_u32 v57, 4294901760, v57
    v_add_u32 v58, 4294901760, v58
    v_add_u32 v59, 4294901760, v59
    v_add_u32 v60, 4294901760, v60
    v_add_u32 v61, 4294901760, v61
    ds_read_b64_tr_b16 a[64:65], v54 offset:0
    ds_read_b64_tr_b16 a[66:67], v54 offset:1024
    ds_read_b64_tr_b16 a[72:73], v54 offset:8
    ds_read_b64_tr_b16 a[74:75], v54 offset:1032
    ds_read_b64_tr_b16 a[240:241], v55 offset:0
    ds_read_b64_tr_b16 a[242:243], v55 offset:1024
    ds_read_b64_tr_b16 a[248:249], v55 offset:8
    ds_read_b64_tr_b16 a[250:251], v55 offset:1032
    ds_read_b64_tr_b16 v[152:153], v56 offset:0
    ds_read_b64_tr_b16 v[154:155], v56 offset:1024
    ds_read_b64_tr_b16 v[160:161], v56 offset:8
    ds_read_b64_tr_b16 v[162:163], v56 offset:1032
    ds_read_b64_tr_b16 v[184:185], v57 offset:0
    ds_read_b64_tr_b16 v[186:187], v57 offset:1024
    ds_read_b64_tr_b16 v[192:193], v57 offset:8
    ds_read_b64_tr_b16 v[194:195], v57 offset:1032
    s_waitcnt lgkmcnt(0)
    s_waitcnt vmcnt(16)
    s_barrier
    s_add_u32 s43, s40, 524288
    s_add_u32 m0, s42, 0
    s_xor_b32 s23, s43, s20
    buffer_load_dwordx4 v52, s[68:71], s23 offen lds
    s_add_u32 s43, s43, 16384
    s_add_u32 m0, s42, 1024
    s_xor_b32 s23, s43, s20
    buffer_load_dwordx4 v52, s[68:71], s23 offen lds
    s_add_u32 s43, s43, 16384
    s_add_u32 m0, s42, 2048
    s_xor_b32 s23, s43, s20
    buffer_load_dwordx4 v52, s[68:71], s23 offen lds
    s_add_u32 s43, s43, 16384
    s_add_u32 m0, s42, 3072
    s_xor_b32 s23, s43, s20
    buffer_load_dwordx4 v52, s[68:71], s23 offen lds
    s_add_u32 s43, s43, 16384
    s_add_u32 m0, s42, 4096
    s_xor_b32 s23, s43, s20
    buffer_load_dwordx4 v52, s[68:71], s23 offen lds
    s_add_u32 s43, s43, 16384
    s_add_u32 m0, s42, 5120
    s_xor_b32 s23, s43, s20
    buffer_load_dwordx4 v52, s[68:71], s23 offen lds
    s_add_u32 s43, s43, 16384
    s_add_u32 m0, s42, 6144
    s_xor_b32 s23, s43, s20
    buffer_load_dwordx4 v52, s[68:71], s23 offen lds
    s_add_u32 s43, s43, 16384
    s_add_u32 m0, s42, 7168
    s_xor_b32 s23, s43, s20
    buffer_load_dwordx4 v52, s[68:71], s23 offen lds
    ds_read_b64_tr_b16 a[68:69], v54 offset:32768
    ds_read_b64_tr_b16 a[70:71], v54 offset:33792
    ds_read_b64_tr_b16 a[76:77], v54 offset:32776
    ds_read_b64_tr_b16 a[78:79], v54 offset:33800
    ds_read_b64_tr_b16 a[244:245], v55 offset:32768
    ds_read_b64_tr_b16 a[246:247], v55 offset:33792
    ds_read_b64_tr_b16 a[252:253], v55 offset:32776
    ds_read_b64_tr_b16 a[254:255], v55 offset:33800
    ds_read_b64_tr_b16 v[156:157], v56 offset:32768
    ds_read_b64_tr_b16 v[158:159], v56 offset:33792
    ds_read_b64_tr_b16 v[164:165], v56 offset:32776
    ds_read_b64_tr_b16 v[166:167], v56 offset:33800
    ds_read_b64_tr_b16 v[188:189], v57 offset:32768
    ds_read_b64_tr_b16 v[190:191], v57 offset:33792
    ds_read_b64_tr_b16 v[196:197], v57 offset:32776
    ds_read_b64_tr_b16 v[198:199], v57 offset:33800
    s_waitcnt lgkmcnt(0)
    s_waitcnt vmcnt(16)
    s_barrier
    s_add_u32 s43, s40, 655360
    s_add_u32 m0, s42, 32768
    s_xor_b32 s23, s43, s20
    buffer_load_dwordx4 v52, s[68:71], s23 offen lds
    s_add_u32 s43, s43, 16384
    s_add_u32 m0, s42, 33792
    s_xor_b32 s23, s43, s20
    buffer_load_dwordx4 v52, s[68:71], s23 offen lds
    s_add_u32 s43, s43, 16384
    s_add_u32 m0, s42, 34816
    s_xor_b32 s23, s43, s20
    buffer_load_dwordx4 v52, s[68:71], s23 offen lds
    s_add_u32 s43, s43, 16384
    s_add_u32 m0, s42, 35840
    s_xor_b32 s23, s43, s20
    buffer_load_dwordx4 v52, s[68:71], s23 offen lds
    s_add_u32 s43, s43, 16384
    s_add_u32 m0, s42, 36864
    s_xor_b32 s23, s43, s20
    buffer_load_dwordx4 v52, s[68:71], s23 offen lds
    s_add_u32 s43, s43, 16384
    s_add_u32 m0, s42, 37888
    s_xor_b32 s23, s43, s20
    buffer_load_dwordx4 v52, s[68:71], s23 offen lds
    s_add_u32 s43, s43, 16384
    s_add_u32 m0, s42, 38912
    s_xor_b32 s23, s43, s20
    buffer_load_dwordx4 v52, s[68:71], s23 offen lds
    s_add_u32 s43, s43, 16384
    s_add_u32 m0, s42, 39936
    s_xor_b32 s23, s43, s20
    buffer_load_dwordx4 v52, s[68:71], s23 offen lds
    v_add_u32 v54, 65536, v54
    v_add_u32 v55, 65536, v55
    v_add_u32 v56, 65536, v56
    v_add_u32 v57, 65536, v57
    v_add_u32 v58, 65536, v58
    v_add_u32 v59, 65536, v59
    v_add_u32 v60, 65536, v60
    v_add_u32 v61, 65536, v61
    ds_read_b64_tr_b16 v[200:201], v58 offset:0
    ds_read_b64_tr_b16 v[202:203], v58 offset:1024
    ds_read_b64_tr_b16 v[204:205], v58 offset:8
    ds_read_b64_tr_b16 v[206:207], v58 offset:1032
    ds_read_b64_tr_b16 v[208:209], v59 offset:0
    ds_read_b64_tr_b16 v[210:211], v59 offset:1024
    ds_read_b64_tr_b16 v[212:213], v59 offset:8
    ds_read_b64_tr_b16 v[214:215], v59 offset:1032
    ds_read_b64_tr_b16 v[228:229], v60 offset:0
    ds_read_b64_tr_b16 v[230:231], v60 offset:1024
    ds_read_b64_tr_b16 v[232:233], v60 offset:8
    ds_read_b64_tr_b16 v[234:235], v60 offset:1032
    ds_read_b64_tr_b16 v[236:237], v61 offset:0
    ds_read_b64_tr_b16 v[238:239], v61 offset:1024
    ds_read_b64_tr_b16 v[240:241], v61 offset:8
    ds_read_b64_tr_b16 v[242:243], v61 offset:1032
    s_waitcnt lgkmcnt(0)
    s_waitcnt vmcnt(16)
    s_barrier
    buffer_load_dwordx4 v[24:27], off, s[4:7], 0 offset:128 sc1
    s_xor_b32 s43, s39, 0
    s_add_u32 s43, s43, s41
    s_add_u32 m0, s42, 65536
    s_nop 0
    buffer_load_dwordx4 v53, s[80:83], s43 offen lds
    s_add_u32 s43, s43, 4096
    s_add_u32 m0, s42, 66560
    s_nop 0
    buffer_load_dwordx4 v53, s[80:83], s43 offen lds
    s_add_u32 s43, s43, 4096
    s_add_u32 m0, s42, 67584
    s_nop 0
    buffer_load_dwordx4 v53, s[80:83], s43 offen lds
    s_add_u32 s43, s43, 4096
    s_add_u32 m0, s42, 68608
    s_nop 0
    buffer_load_dwordx4 v53, s[80:83], s43 offen lds
    s_add_u32 s43, s43, 4096
    s_add_u32 m0, s42, 69632
    s_nop 0
    buffer_load_dwordx4 v53, s[80:83], s43 offen lds
    s_add_u32 s43, s43, 4096
    s_add_u32 m0, s42, 70656
    s_nop 0
    buffer_load_dwordx4 v53, s[80:83], s43 offen lds
    s_add_u32 s43, s43, 4096
    s_add_u32 m0, s42, 71680
    s_nop 0
    buffer_load_dwordx4 v53, s[80:83], s43 offen lds
    s_add_u32 s43, s43, 4096
    s_add_u32 m0, s42, 72704
    s_nop 0
    buffer_load_dwordx4 v53, s[80:83], s43 offen lds
    ds_read_b64_tr_b16 v[216:217], v58 offset:32768
    ds_read_b64_tr_b16 v[218:219], v58 offset:33792
    ds_read_b64_tr_b16 v[76:77], v58 offset:32776
    ds_read_b64_tr_b16 v[78:79], v58 offset:33800
    ds_read_b64_tr_b16 v[220:221], v59 offset:32768
    ds_read_b64_tr_b16 v[222:223], v59 offset:33792
    ds_read_b64_tr_b16 v[224:225], v59 offset:32776
    ds_read_b64_tr_b16 v[226:227], v59 offset:33800
    ds_read_b64_tr_b16 v[244:245], v60 offset:32768
    ds_read_b64_tr_b16 v[246:247], v60 offset:33792
    ds_read_b64_tr_b16 v[80:81], v60 offset:32776
    ds_read_b64_tr_b16 v[82:83], v60 offset:33800
    ds_read_b64_tr_b16 v[248:249], v61 offset:32768
    ds_read_b64_tr_b16 v[250:251], v61 offset:33792
    ds_read_b64_tr_b16 v[252:253], v61 offset:32776
    ds_read_b64_tr_b16 v[254:255], v61 offset:33800
    s_waitcnt lgkmcnt(0)
    s_barrier
    ds_write_b128 v3, v[76:79] offset:24576
    ds_write_b128 v3, v[80:83] offset:25600
    s_waitcnt vmcnt(16)
    s_barrier
    s_xor_b32 s43, s39, 65536
    s_add_u32 s43, s43, s41
    s_add_u32 m0, s42, 98304
    s_nop 0
    buffer_load_dwordx4 v53, s[80:83], s43 offen lds
    s_add_u32 s43, s43, 4096
    s_add_u32 m0, s42, 99328
    s_nop 0
    buffer_load_dwordx4 v53, s[80:83], s43 offen lds
    s_add_u32 s43, s43, 4096
    s_add_u32 m0, s42, 100352
    s_nop 0
    buffer_load_dwordx4 v53, s[80:83], s43 offen lds
    s_add_u32 s43, s43, 4096
    s_add_u32 m0, s42, 101376
    s_nop 0
    buffer_load_dwordx4 v53, s[80:83], s43 offen lds
    s_add_u32 s43, s43, 4096
    s_add_u32 m0, s42, 102400
    s_nop 0
    buffer_load_dwordx4 v53, s[80:83], s43 offen lds
    s_add_u32 s43, s43, 4096
    s_add_u32 m0, s42, 103424
    s_nop 0
    buffer_load_dwordx4 v53, s[80:83], s43 offen lds
    s_add_u32 s43, s43, 4096
    s_add_u32 m0, s42, 104448
    s_nop 0
    buffer_load_dwordx4 v53, s[80:83], s43 offen lds
    s_add_u32 s43, s43, 4096
    s_add_u32 m0, s42, 105472
    s_nop 0
    buffer_load_dwordx4 v53, s[80:83], s43 offen lds
    v_add_u32 v54, 4294901760, v54
    v_add_u32 v55, 4294901760, v55
    v_add_u32 v56, 4294901760, v56
    v_add_u32 v57, 4294901760, v57
    v_add_u32 v58, 4294901760, v58
    v_add_u32 v59, 4294901760, v59
    v_add_u32 v60, 4294901760, v60
    v_add_u32 v61, 4294901760, v61
    ds_read_b64_tr_b16 v[76:77], v54 offset:0
    ds_read_b64_tr_b16 v[78:79], v54 offset:1024
    ds_read_b64_tr_b16 v[80:81], v54 offset:8
    ds_read_b64_tr_b16 v[82:83], v54 offset:1032
    ds_read_b64_tr_b16 v[84:85], v55 offset:0
    ds_read_b64_tr_b16 v[86:87], v55 offset:1024
    ds_read_b64_tr_b16 v[88:89], v55 offset:8
    ds_read_b64_tr_b16 v[90:91], v55 offset:1032
    ds_read_b64_tr_b16 v[92:93], v56 offset:0
    ds_read_b64_tr_b16 v[94:95], v56 offset:1024
    ds_read_b64_tr_b16 v[96:97], v56 offset:8
    ds_read_b64_tr_b16 v[98:99], v56 offset:1032
    ds_read_b64_tr_b16 v[100:101], v57 offset:0
    ds_read_b64_tr_b16 v[102:103], v57 offset:1024
    ds_read_b64_tr_b16 v[104:105], v57 offset:8
    ds_read_b64_tr_b16 v[106:107], v57 offset:1032
    s_waitcnt lgkmcnt(0)
    s_barrier
    ds_write_b128 v2, v[76:79] offset:0
    ds_write_b128 v2, v[80:83] offset:1024
    ds_write_b128 v2, v[84:87] offset:2048
    ds_write_b128 v2, v[88:91] offset:3072
    ds_write_b128 v2, v[92:95] offset:4096
    ds_write_b128 v2, v[96:99] offset:5120
    ds_write_b128 v2, v[100:103] offset:6144
    ds_write_b128 v2, v[104:107] offset:7168
    s_waitcnt vmcnt(16)
    s_barrier
    v_and_b32 v11, 15, v0
    v_lshlrev_b32_e64 v11, 7, v11
    s_xor_b32 s22, s52, 8192
    buffer_load_dword v30, v11, s[8:11], s51 offen sc1
    buffer_load_dword v31, v11, s[8:11], s49 offen sc1
    buffer_load_dword v32, v11, s[8:11], s52 offen sc1
    buffer_load_dword v33, v11, s[8:11], s22 offen sc1
    ds_read_b64_tr_b16 v[76:77], v54 offset:32768
    ds_read_b64_tr_b16 v[78:79], v54 offset:33792
    ds_read_b64_tr_b16 v[80:81], v54 offset:32776
    ds_read_b64_tr_b16 v[82:83], v54 offset:33800
    ds_read_b64_tr_b16 v[84:85], v55 offset:32768
    ds_read_b64_tr_b16 v[86:87], v55 offset:33792
    ds_read_b64_tr_b16 v[88:89], v55 offset:32776
    ds_read_b64_tr_b16 v[90:91], v55 offset:33800
    ds_read_b64_tr_b16 v[92:93], v56 offset:32768
    ds_read_b64_tr_b16 v[94:95], v56 offset:33792
    ds_read_b64_tr_b16 v[96:97], v56 offset:32776
    ds_read_b64_tr_b16 v[98:99], v56 offset:33800
    ds_read_b64_tr_b16 v[100:101], v57 offset:32768
    ds_read_b64_tr_b16 v[102:103], v57 offset:33792
    ds_read_b64_tr_b16 v[104:105], v57 offset:32776
    ds_read_b64_tr_b16 v[106:107], v57 offset:33800
    s_waitcnt lgkmcnt(0)
    s_barrier
    ds_write_b128 v2, v[76:79] offset:32768
    ds_write_b128 v2, v[80:83] offset:33792
    ds_write_b128 v2, v[84:87] offset:34816
    ds_write_b128 v2, v[88:91] offset:35840
    ds_write_b128 v2, v[92:95] offset:36864
    ds_write_b128 v2, v[96:99] offset:37888
    ds_write_b128 v2, v[100:103] offset:38912
    ds_write_b128 v2, v[104:107] offset:39936
    s_waitcnt vmcnt(8)
    s_barrier
    v_mov_b32_e64 v29, v24
    buffer_load_dword v28, off, s[4:7], 0 offset:132 sc1
    v_add_u32 v54, 65536, v54
    v_add_u32 v55, 65536, v55
    v_add_u32 v56, 65536, v56
    v_add_u32 v57, 65536, v57
    v_add_u32 v58, 65536, v58
    v_add_u32 v59, 65536, v59
    v_add_u32 v60, 65536, v60
    v_add_u32 v61, 65536, v61
    ds_read_b64_tr_b16 v[76:77], v58 offset:0
    ds_read_b64_tr_b16 v[78:79], v58 offset:1024
    ds_read_b64_tr_b16 v[80:81], v58 offset:8
    ds_read_b64_tr_b16 v[82:83], v58 offset:1032
    ds_read_b64_tr_b16 v[84:85], v59 offset:0
    ds_read_b64_tr_b16 v[86:87], v59 offset:1024
    ds_read_b64_tr_b16 v[88:89], v59 offset:8
    ds_read_b64_tr_b16 v[90:91], v59 offset:1032
    ds_read_b64_tr_b16 v[92:93], v60 offset:0
    ds_read_b64_tr_b16 v[94:95], v60 offset:1024
    ds_read_b64_tr_b16 v[96:97], v60 offset:8
    ds_read_b64_tr_b16 v[98:99], v60 offset:1032
    ds_read_b64_tr_b16 v[100:101], v61 offset:0
    ds_read_b64_tr_b16 v[102:103], v61 offset:1024
    ds_read_b64_tr_b16 v[104:105], v61 offset:8
    ds_read_b64_tr_b16 v[106:107], v61 offset:1032
    s_waitcnt lgkmcnt(0)
    s_barrier
    ds_write_b128 v7, v[76:79] offset:0
    ds_write_b128 v7, v[80:83] offset:1024
    ds_write_b128 v7, v[84:87] offset:2048
    ds_write_b128 v7, v[88:91] offset:3072
    ds_write_b128 v7, v[92:95] offset:4096
    ds_write_b128 v7, v[96:99] offset:5120
    ds_write_b128 v7, v[100:103] offset:6144
    ds_write_b128 v7, v[104:107] offset:7168
    s_waitcnt vmcnt(0)
    s_barrier
    ds_read_b64_tr_b16 v[76:77], v58 offset:32768
    ds_read_b64_tr_b16 v[78:79], v58 offset:33792
    ds_read_b64_tr_b16 v[80:81], v58 offset:32776
    ds_read_b64_tr_b16 v[82:83], v58 offset:33800
    ds_read_b64_tr_b16 v[84:85], v59 offset:32768
    ds_read_b64_tr_b16 v[86:87], v59 offset:33792
    ds_read_b64_tr_b16 v[88:89], v59 offset:32776
    ds_read_b64_tr_b16 v[90:91], v59 offset:33800
    ds_read_b64_tr_b16 v[92:93], v60 offset:32768
    ds_read_b64_tr_b16 v[94:95], v60 offset:33792
    ds_read_b64_tr_b16 v[96:97], v60 offset:32776
    ds_read_b64_tr_b16 v[98:99], v60 offset:33800
    ds_read_b64_tr_b16 v[100:101], v61 offset:32768
    ds_read_b64_tr_b16 v[102:103], v61 offset:33792
    ds_read_b64_tr_b16 v[104:105], v61 offset:32776
    ds_read_b64_tr_b16 v[106:107], v61 offset:33800
    s_waitcnt lgkmcnt(0)
    s_barrier
    ds_write_b128 v7, v[76:79] offset:32768
    ds_write_b128 v7, v[80:83] offset:33792
    ds_write_b128 v7, v[84:87] offset:34816
    ds_write_b128 v7, v[88:91] offset:35840
    ds_write_b128 v7, v[92:95] offset:36864
    ds_write_b128 v7, v[96:99] offset:37888
    ds_write_b128 v7, v[100:103] offset:38912
    ds_write_b128 v7, v[104:107] offset:39936
    s_cmp_eq_u32 s16, 0
    s_cselect_b64 vcc, -1, 0
    v_cndmask_b32 v26, v26, v27, vcc
    v_min_u32 v24, v24, v26
    v_cmp_gt_u32 vcc, 0x80, v24
    v_mov_b32_e64 v25, v28
    s_cbranch_vccz wr_6
    s_mul_i32 s23, s16, 0
wr_4:
    buffer_load_dwordx4 v[24:27], off, s[4:7], s23 offset:128 sc1
    s_waitcnt vmcnt(0)
    s_cmp_eq_u32 s16, 0
    s_cselect_b64 vcc, -1, 0
    v_cndmask_b32 v26, v26, v27, vcc
    v_min_u32_e64 v24, v24, v26
    v_cmp_gt_u32 vcc, 0x80, v24
    s_cbranch_vccz wr_5
    s_sub_u32 s3, s3, 1
    s_cbranch_scc1 main_timeout
    s_sleep 4
    s_branch wr_4
    s_nop 0
    s_nop 0
    s_nop 0
    s_nop 0
wr_5:
    buffer_load_dword v25, off, s[4:7], 0 offset:132 sc1
    s_waitcnt vmcnt(0)
wr_6:
    v_readfirstlane_b32 s22, v25
    s_nop 0
    s_bitcmp0_b32 s22, s14
    s_cselect_b32 s15, 1, 0
    buffer_load_dword v0, off, s[8:11], s31 sc1
    v_mov_b32 v52, 0
    v_mov_b32 v53, 0
    v_mov_b32 v54, 0
    v_mov_b32 v55, 0
    v_mov_b32 v56, 0
    v_mov_b32 v57, 0
    v_mov_b32 v58, 0
    v_mov_b32 v59, 0
    v_mov_b32 v60, 0
    v_mov_b32 v61, 0
    v_mov_b32 v62, 0
    v_mov_b32 v63, 0
    v_mov_b32 v64, 0
    v_mov_b32 v65, 0
    v_mov_b32 v66, 0
    v_mov_b32 v67, 0
    v_mov_b32 v68, 0
    v_mov_b32 v69, 0
    v_mov_b32 v70, 0
    v_mov_b32 v71, 0
    v_mov_b32 v72, 0
    v_mov_b32 v73, 0
    v_mov_b32 v74, 0
    v_mov_b32_e64 v75, 0
    s_waitcnt lgkmcnt(0)
    ds_read_b128 v[92:95], v2 offset:0
    ds_read_b128 v[96:99], v2 offset:32768
    ds_read_b128 v[100:103], v2 offset:1024
    ds_read_b128 v[104:107], v2 offset:33792
    ds_read_b128 v[108:111], v2 offset:2048
    ds_read_b128 v[112:115], v2 offset:34816
    s_mov_b32 s17, 0
    s_add_u32 s27, s28, 524288
    s_and_b32 s22, s33, 7
    s_lshl_b32 s22, s22, 7
    v_xor_b32_e64 v10, s22, v1
    s_and_b32 s22, s33, 8
    s_lshl_b32 s22, s22, 7
    s_add_u32 s51, s51, s22
    v_mov_b32_e64 v128, s19
    v_mov_b32_e64 v129, s19
    v_mov_b32_e64 v130, s19
    v_mov_b32 v131, s19
    ds_write_b128 v3, v[16:19]
    ds_write_b128 v3, v[20:23] offset:1024
    s_waitcnt vmcnt(0)
    v_cmp_gt_u32_e64 vcc, 1, v0
    s_cbranch_vccz ch_go
ch_kv0_7:
    s_sub_u32 s3, s3, 1
    s_cbranch_scc1 main_timeout
    buffer_load_dword v0, off, s[8:11], s31 sc1
    s_waitcnt vmcnt(0)
    v_cmp_gt_u32_e64 vcc, 1, v0
    s_cbranch_vccnz ch_kv0_7
ch_go:
    s_cmp_eq_u32 s15, 0
    s_cbranch_scc1 chain_slow_step
    s_branch chain_fast_step
    s_nop 0
    s_nop 0
    s_nop 0
    s_nop 0
chain_fast_gather:
    v_mov_b32 v65, 0
    s_nop 3
    v_mov_b32 v66, 0
    s_nop 3
    v_mov_b32 v67, 0
    s_nop 3
    v_mov_b32 v68, 0
    s_nop 3
    v_mov_b32 v69, 0
    s_nop 3
    v_mov_b32 v70, 0
    s_nop 3
    buffer_load_dwordx4 v[16:19], v1, s[8:11], s52 offen sc1
    buffer_load_dwordx4 v[20:23], v1, s[8:11], s45 offen sc1
    v_mov_b32 v71, 0
    s_nop 3
    v_mov_b32 v72, 0
    s_nop 3
    v_mov_b32 v73, 0
    s_nop 3
    v_mov_b32 v74, 0
    s_nop 3
    v_mov_b32 v75, 0
    s_nop 3
    v_mov_b32 v11, 0
    s_nop 3
    v_mov_b32 v11, 0
    s_nop 3
    v_mov_b32 v11, 0
    s_nop 3
    v_mov_b32 v11, 0
    s_nop 0
    buffer_load_dwordx4 v[16:19], v1, s[8:11], s52 offen sc1
    buffer_load_dwordx4 v[20:23], v1, s[8:11], s45 offen sc1
    v_mov_b32 v11, 0
    s_nop 3
    v_mov_b32 v11, 0
    s_nop 3
    s_waitcnt vmcnt(3)
    v_max3_u32 v116, v16, v17, v18
    v_max_u32 v116, v116, v19
    ds_write_b128 v3, v[16:19]
    s_waitcnt vmcnt(2)
    v_max3_u32 v116, v116, v20, v21
    v_max3_u32 v116, v116, v22, v23
    v_cmp_le_u32_e64 vcc, s19, v116
    ds_write_b128 v3, v[20:23] offset:1024
    s_cbranch_vccnz chain_fast_gretry
chain_fast_step:
    v_smfmac_f32_16x16x64_bf16 v[56:59], v[16:19], a[8:15], v48
    buffer_load_dwordx4 v[76:79], v1, s[8:11], s28 offen offset:0 sc1
    v_smfmac_f32_16x16x64_bf16 v[68:71], v[16:19], a[32:39], v48
    buffer_load_dwordx4 v[80:83], v1, s[8:11], s28 offen offset:1024 sc1
    v_smfmac_f32_16x16x64_bf16 v[60:63], v[16:19], a[16:23], v48
    buffer_load_dwordx4 v[84:87], v1, s[8:11], s28 offen offset:2048 sc1
    v_smfmac_f32_16x16x64_bf16 v[72:75], v[16:19], a[40:47], v48
    buffer_load_dwordx4 v[88:91], v1, s[8:11], s28 offen offset:3072 sc1
    v_smfmac_f32_16x16x64_bf16 v[64:67], v[16:19], a[24:31], v48
    s_waitcnt lgkmcnt(0)
    s_barrier
    v_smfmac_f32_16x16x64_bf16 v[60:63], v[20:23], a[48:55], v48
    ds_read_b128 v[24:27], v4
    v_smfmac_f32_16x16x64_bf16 v[64:67], v[20:23], a[56:63], v48
    ds_read_b128 v[32:35], v5
    v_smfmac_f32_16x16x64_bf16 v[56:59], v[20:23], v[100:107], v48
    ds_read_b128 v[28:31], v4 offset:1024
    v_smfmac_f32_16x16x64_bf16 v[52:55], v[16:19], a[0:7], v48
    buffer_load_dword v0, v49, s[8:11], s28 offen sc1
    v_smfmac_f32_16x16x64_bf16 v[52:55], v[20:23], v[92:99], v48
    ds_read_b128 v[96:99], v2 offset:35840
    s_waitcnt lgkmcnt(3)
    v_smfmac_f32_16x16x64_bf16 v[56:59], v[24:27], a[88:95], v48
    ds_read_b128 v[104:107], v2 offset:36864
    v_smfmac_f32_16x16x64_bf16 v[64:67], v[24:27], a[136:143], v48
    ds_read_b128 v[92:95], v2 offset:3072
    v_smfmac_f32_16x16x64_bf16 v[52:55], v[24:27], a[80:87], v48
    s_waitcnt lgkmcnt(3)
    v_smfmac_f32_16x16x64_bf16 v[52:55], v[28:31], v[108:115], v48
    ds_read_b128 v[112:115], v2 offset:37888
    v_smfmac_f32_16x16x64_bf16 v[60:63], v[24:27], a[128:135], v48
    ds_read_b128 v[100:103], v2 offset:4096
    v_smfmac_f32_16x16x64_bf16 v[64:67], v[28:31], a[152:159], v48
    ds_read_b128 v[36:39], v5 offset:1024
    v_smfmac_f32_16x16x64_bf16 v[64:67], v[32:35], a[168:175], v48
    buffer_load_dword v0, off, s[8:11], s31 sc1
    v_smfmac_f32_16x16x64_bf16 v[60:63], v[28:31], a[144:151], v48
    ds_read_b128 v[108:111], v2 offset:5120
    v_smfmac_f32_16x16x64_bf16 v[52:55], v[32:35], a[96:103], v48
    ds_read_b128 v[40:43], v6
    v_smfmac_f32_16x16x64_bf16 v[60:63], v[32:35], a[160:167], v48
    ds_read_b128 v[44:47], v6 offset:1024
    s_waitcnt lgkmcnt(3)
    v_smfmac_f32_16x16x64_bf16 v[52:55], v[36:39], v[100:107], v48
    ds_read_b128 v[104:107], v2 offset:39936
    v_smfmac_f32_16x16x64_bf16 v[56:59], v[28:31], v[92:99], v48
    ds_read_b128 v[92:95], v2 offset:6144
    v_smfmac_f32_16x16x64_bf16 v[60:63], v[36:39], a[176:183], v48
    ds_read_b128 v[96:99], v2 offset:38912
    v_smfmac_f32_16x16x64_bf16 v[56:59], v[32:35], a[104:111], v48
    ds_read_b128 v[100:103], v2 offset:7168
    s_waitcnt lgkmcnt(6)
    v_smfmac_f32_16x16x64_bf16 v[56:59], v[36:39], v[108:115], v48
    ds_read_b128 v[112:115], v7 offset:5120
    s_waitcnt lgkmcnt(6)
    v_smfmac_f32_16x16x64_bf16 v[56:59], v[40:43], a[120:127], v48
    v_smfmac_f32_16x16x64_bf16 v[52:55], v[40:43], a[112:119], v48
    s_waitcnt lgkmcnt(2)
    v_smfmac_f32_16x16x64_bf16 v[52:55], v[44:47], v[92:99], v48
    s_nop 0
    v_smfmac_f32_16x16x64_bf16 v[64:67], v[36:39], a[184:191], v48
    s_waitcnt lgkmcnt(1)
    v_smfmac_f32_16x16x64_bf16 v[56:59], v[44:47], v[100:107], v48
    ds_read_b128 v[100:103], v7 offset:2048
    v_cvt_pk_bf16_f32 v117, v54, v55
    v_smfmac_f32_16x16x64_bf16 v[64:67], v[40:43], a[200:207], v48
    ds_read_b128 v[92:95], v7 offset:0
    v_cvt_pk_bf16_f32 v116, v52, v53
    v_smfmac_f32_16x16x64_bf16 v[60:63], v[40:43], a[192:199], v48
    v_cvt_pk_bf16_f32 v119, v58, v59
    v_smfmac_f32_16x16x64_bf16 v[64:67], v[44:47], a[216:223], v48
    v_cvt_pk_bf16_f32 v118, v56, v57
    v_smfmac_f32_16x16x64_bf16 v[60:63], v[44:47], a[208:215], v48
    buffer_store_dwordx4 v[128:131], v1, s[8:11], s49 offen
    v_mfma_f32_16x16x16_bf16 v[56:59], v[118:119], v[50:51], 0
    v_cvt_pk_bf16_f32 v122, v64, v65
    ds_read_b128 v[104:107], v7 offset:3072
    v_mfma_f32_16x16x16_bf16 v[52:55], v[116:117], v[50:51], 0
    v_cvt_pk_bf16_f32 v123, v66, v67
    v_cvt_pk_bf16_f32 v121, v62, v63
    s_nop 0
    v_mfma_f32_16x16x16_bf16 v[64:67], v[122:123], v[50:51], 0
    v_cvt_pk_bf16_f32 v120, v60, v61
    v_cvt_pk_bf16_f32 v119, v58, v59
    v_cvt_pk_bf16_f32 v118, v56, v57
    v_mfma_f32_16x16x16_bf16 v[60:63], v[120:121], v[50:51], 0
    v_cvt_pk_bf16_f32 v116, v52, v53
    v_cvt_pk_bf16_f32 v117, v54, v55
    s_waitcnt vmcnt(5)
    s_nop 0
    v_mfma_f32_16x16x32_bf16 v[56:59], v[80:83], v[116:119], 0
    s_nop 0
    v_cvt_pk_bf16_f32 v122, v64, v65
    v_cvt_pk_bf16_f32 v123, v66, v67
    v_mfma_f32_16x16x32_bf16 v[52:55], v[76:79], v[116:119], 0
    v_cvt_pk_bf16_f32 v121, v62, v63
    v_cvt_pk_bf16_f32 v120, v60, v61
    v_smfmac_f32_16x16x64_bf16 v[72:75], v[20:23], a[72:79], v48
    ds_read_b128 v[96:99], v7 offset:1024
    v_mfma_f32_16x16x32_bf16 v[60:63], v[120:123], v[116:119], 0
    v_mov_b32_dpp v52, v56 quad_perm:[0,1,2,3] row_mask:0xf bank_mask:0xc
    v_mov_b32_dpp v55, v59 quad_perm:[0,1,2,3] row_mask:0xf bank_mask:0xc
    v_smfmac_f32_16x16x64_bf16 v[72:75], v[24:27], a[232:239], v48
    v_mov_b32_dpp v53, v57 quad_perm:[0,1,2,3] row_mask:0xf bank_mask:0xc
    v_smfmac_f32_16x16x64_bf16 v[72:75], v[28:31], a[248:255], v48
    s_nop 0
    v_mov_b32_dpp v61, v63 quad_perm:[0,1,2,3] row_mask:0xf bank_mask:0xc
    v_mov_b32_dpp v60, v62 quad_perm:[0,1,2,3] row_mask:0xf bank_mask:0xc
    v_smfmac_f32_16x16x64_bf16 v[72:75], v[32:35], v[144:151], v48
    ds_write_b64 v3, v[60:61] offset:17408
    v_mov_b32_dpp v54, v58 quad_perm:[0,1,2,3] row_mask:0xf bank_mask:0xc
    v_smfmac_f32_16x16x64_bf16 v[72:75], v[36:39], v[160:167], v48
    ds_write_b128 v3, v[52:55] offset:16384
    v_smfmac_f32_16x16x64_bf16 v[72:75], v[40:43], v[176:183], v48
    buffer_store_dwordx4 v[120:123], v1, s[8:11], s30 offen sc1
    v_smfmac_f32_16x16x64_bf16 v[68:71], v[20:23], a[64:71], v48
    s_waitcnt lgkmcnt(0)
    s_waitcnt vmcnt(8)
    s_barrier
    v_smfmac_f32_16x16x64_bf16 v[68:71], v[24:27], a[224:231], v48
    ds_read_b64 v[62:63], v4 offset:17408
    ds_read_b128 v[76:79], v5 offset:16384
    v_smfmac_f32_16x16x64_bf16 v[68:71], v[28:31], a[240:247], v48
    ds_read_b128 v[56:59], v4 offset:16384
    ds_read_b64 v[66:67], v6 offset:17408
    v_smfmac_f32_16x16x64_bf16 v[68:71], v[32:35], v[136:143], v48
    ds_read_b64 v[64:65], v5 offset:17408
    ds_read_b128 v[80:83], v6 offset:16384
    v_smfmac_f32_16x16x64_bf16 v[72:75], v[44:47], v[192:199], v48
    buffer_store_dwordx4 v[128:131], v1, s[8:11], s49 offen offset:1024
    s_waitcnt lgkmcnt(3)
    v_pk_add_f32 v[52:53], v[52:53], v[56:57]
    v_pk_add_f32 v[54:55], v[54:55], v[58:59]
    v_pk_add_f32 v[54:55], v[54:55], v[78:79]
    v_pk_add_f32 v[60:61], v[60:61], v[62:63]
    v_pk_add_f32 v[52:53], v[52:53], v[76:77]
    s_waitcnt lgkmcnt(0)
    v_pk_add_f32 v[52:53], v[52:53], v[80:81]
    v_pk_add_f32 v[54:55], v[54:55], v[82:83]
    v_pk_add_f32 v[60:61], v[60:61], v[64:65]
    v_pk_add_f32 v[60:61], v[60:61], v[66:67]
    v_max3_f32 v132, v52, v53, v54
    v_max3_f32 v133, v55, v60, v61
    v_max_f32 v132, v132, v133
    v_smfmac_f32_16x16x64_bf16 v[68:71], v[36:39], v[152:159], v48
    s_nop 0
    v_max_f32_dpp v132, v132, v132 row_ror:8 row_mask:0xf bank_mask:0xf
    v_mov_b32 v133, v132
    v_smfmac_f32_16x16x64_bf16 v[68:71], v[40:43], v[168:175], v48
    s_nop 0
    v_permlane16_swap_b32 v132, v133
    v_max_f32 v132, v132, v133
    v_mov_b32 v133, v132
    v_smfmac_f32_16x16x64_bf16 v[68:71], v[44:47], v[184:191], v48
    ds_read_b128 v[108:111], v7 offset:4096
    v_permlane32_swap_b32 v132, v133
    v_max_f32 v132, v132, v133
    v_mul_f32 v132, s18, v132
    v_pk_fma_f32 v[60:61], v[60:61], s[18:19], v[132:133] op_sel_hi:[1,0,0] neg_lo:[0,0,1] neg_hi:[0,0,1]
    v_pk_fma_f32 v[54:55], v[54:55], s[18:19], v[132:133] op_sel_hi:[1,0,0] neg_lo:[0,0,1] neg_hi:[0,0,1]
    v_pk_fma_f32 v[52:53], v[52:53], s[18:19], v[132:133] op_sel_hi:[1,0,0] neg_lo:[0,0,1] neg_hi:[0,0,1]
    v_exp_f32 v55, v55
    v_exp_f32 v61, v61
    v_exp_f32 v53, v53
    v_exp_f32 v52, v52
    v_exp_f32 v54, v54
    v_cvt_pk_bf16_f32 v124, v68, v69
    v_cvt_pk_bf16_f32 v125, v70, v71
    v_exp_f32 v60, v60
    v_cvt_pk_bf16_f32 v128, v52, v53
    v_cvt_pk_bf16_f32 v129, v54, v55
    v_cvt_pk_bf16_f32 v126, v72, v73
    v_pk_add_f32 v[52:53], v[52:53], v[54:55]
    v_pk_fma_f32 v[52:53], v[60:61], 0.5, v[52:53] op_sel_hi:[1,0,1]
    v_mov_b32_dpp v130, v128 row_ror:8 row_mask:0xf bank_mask:0xf
    v_mov_b32_dpp v131, v129 row_ror:8 row_mask:0xf bank_mask:0xf
    v_cvt_pk_bf16_f32 v127, v74, v75
    v_add_f32 v134, v52, v53
    s_waitcnt vmcnt(6)
    v_mfma_f32_16x16x32_bf16 v[76:79], v[84:87], v[128:131], 0
    buffer_store_dwordx4 v[124:127], v1, s[8:11], s30 offen offset:1024 sc1
    v_cvt_pk_bf16_f32 v62, v60, v61
    v_add_f32_dpp v134, v134, v134 row_ror:8 row_mask:0xf bank_mask:0xf
    v_mov_b32 v135, v134
    s_waitcnt vmcnt(6)
    v_mfma_f32_16x16x32_bf16 v[80:83], v[88:91], v[128:131], 0
    v_mov_b32_dpp v63, v62 row_ror:8 row_mask:0xf bank_mask:0xf
    v_permlane16_swap_b32 v134, v135
    s_nop 0
    v_mfma_f32_16x16x16_bf16 v[76:79], v[124:125], v[62:63], v[76:79]
    v_add_f32 v134, v134, v135
    v_mov_b32 v135, v134
    v_mfma_f32_16x16x16_bf16 v[80:83], v[126:127], v[62:63], v[80:83]
    s_nop 0
    v_permlane32_swap_b32 v134, v135
    v_add_f32 v134, v134, v135
    v_rcp_f32 v134, v134
    s_nop 0
    v_cndmask_b32 v134, 0, v134, s[34:35]
    v_pk_mul_f32 v[76:77], v[76:77], v[134:135] op_sel_hi:[1,0]
    v_pk_mul_f32 v[78:79], v[78:79], v[134:135] op_sel_hi:[1,0]
    v_cvt_pk_bf16_f32 v116, v76, v77
    v_pk_mul_f32 v[82:83], v[82:83], v[134:135] op_sel_hi:[1,0]
    v_pk_mul_f32 v[80:81], v[80:81], v[134:135] op_sel_hi:[1,0]
    v_cvt_pk_bf16_f32 v117, v78, v79
    v_cvt_pk_bf16_f32 v118, v80, v81
    v_cvt_pk_bf16_f32 v119, v82, v83
    ds_write_b128 v3, v[116:119] offset:8192
    s_nop 0
    v_mfma_f32_16x16x32_bf16 v[16:19], v[92:95], v[116:119], 0
    ds_read_b128 v[92:95], v7 offset:6144
    v_mfma_f32_16x16x32_bf16 v[20:23], v[96:99], v[116:119], 0
    ds_read_b128 v[96:99], v7 offset:7168
    v_mfma_f32_16x16x32_bf16 v[28:31], v[104:107], v[116:119], 0
    s_waitcnt lgkmcnt(2)
    s_barrier
    v_mfma_f32_16x16x32_bf16 v[32:35], v[108:111], v[116:119], 0
    ds_read_b128 v[68:71], v4 offset:8192
    v_mfma_f32_16x16x32_bf16 v[24:27], v[100:103], v[116:119], 0
    ds_read_b128 v[108:111], v7 offset:34816
    v_mfma_f32_16x16x32_bf16 v[36:39], v[112:115], v[116:119], 0
    ds_read_b128 v[100:103], v7 offset:32768
    s_waitcnt lgkmcnt(3)
    v_mfma_f32_16x16x32_bf16 v[44:47], v[96:99], v[116:119], 0
    ds_read_b128 v[72:75], v5 offset:8192
    v_mfma_f32_16x16x32_bf16 v[40:43], v[92:95], v[116:119], 0
    ds_read_b128 v[128:131], v6 offset:8192
    s_waitcnt lgkmcnt(4)
    v_mfma_f32_16x16x32_bf16 v[24:27], v[208:211], v[68:71], v[24:27]
    ds_read_b128 v[104:107], v7 offset:33792
    v_mfma_f32_16x16x32_bf16 v[20:23], v[204:207], v[68:71], v[20:23]
    ds_read_b128 v[92:95], v3 offset:24576
    v_mfma_f32_16x16x32_bf16 v[16:19], v[200:203], v[68:71], v[16:19]
    ds_read_b128 v[112:115], v7 offset:35840
    s_waitcnt lgkmcnt(4)
    v_mfma_f32_16x16x32_bf16 v[16:19], v[100:103], v[72:75], v[16:19]
    ds_read_b128 v[100:103], v7 offset:37888
    s_waitcnt lgkmcnt(4)
    v_mfma_f32_16x16x32_bf16 v[16:19], v[216:219], v[128:131], v[16:19]
    v_mfma_f32_16x16x32_bf16 v[24:27], v[108:111], v[72:75], v[24:27]
    ds_read_b128 v[108:111], v7 offset:39936
    v_mfma_f32_16x16x32_bf16 v[24:27], v[220:223], v[128:131], v[24:27]
    ds_read_b128 v[96:99], v7 offset:36864
    s_waitcnt lgkmcnt(5)
    v_mfma_f32_16x16x32_bf16 v[20:23], v[104:107], v[72:75], v[20:23]
    ds_read_b128 v[104:107], v7 offset:38912
    s_waitcnt lgkmcnt(5)
    v_mfma_f32_16x16x32_bf16 v[20:23], v[92:95], v[128:131], v[20:23]
    s_nop 0
    v_cvt_pk_bf16_f32 v53, v18, v19
    v_cvt_pk_bf16_f32 v57, v26, v27
    v_mfma_f32_16x16x32_bf16 v[28:31], v[212:215], v[68:71], v[28:31]
    s_nop 0
    v_mov_b32_dpp v53, v57 row_ror:8 row_mask:0xf bank_mask:0xc
    s_waitcnt lgkmcnt(4)
    v_mfma_f32_16x16x32_bf16 v[28:31], v[112:115], v[72:75], v[28:31]
    s_nop 0
    v_cvt_pk_bf16_f32 v54, v20, v21
    v_cvt_pk_bf16_f32 v56, v24, v25
    v_mfma_f32_16x16x32_bf16 v[28:31], v[224:227], v[128:131], v[28:31]
    v_cvt_pk_bf16_f32 v55, v22, v23
    v_cvt_pk_bf16_f32 v52, v16, v17
    v_mfma_f32_16x16x32_bf16 v[40:43], v[236:239], v[68:71], v[40:43]
    s_nop 0
    v_mov_b32_dpp v52, v56 row_ror:8 row_mask:0xf bank_mask:0xc
    s_waitcnt lgkmcnt(0)
    v_mfma_f32_16x16x32_bf16 v[40:43], v[104:107], v[72:75], v[40:43]
    v_cvt_pk_bf16_f32 v58, v28, v29
    v_cvt_pk_bf16_f32 v59, v30, v31
    v_mfma_f32_16x16x32_bf16 v[32:35], v[228:231], v[68:71], v[32:35]
    v_mov_b32_dpp v54, v58 row_ror:8 row_mask:0xf bank_mask:0xc
    v_mov_b32_dpp v55, v59 row_ror:8 row_mask:0xf bank_mask:0xc
    v_mfma_f32_16x16x32_bf16 v[36:39], v[232:235], v[68:71], v[36:39]
    buffer_store_dwordx4 v[52:55], v8, s[8:11], s50 offen
    v_mfma_f32_16x16x32_bf16 v[32:35], v[96:99], v[72:75], v[32:35]
    ds_read_b128 v[112:115], v3 offset:25600
    v_mfma_f32_16x16x32_bf16 v[32:35], v[244:247], v[128:131], v[32:35]
    v_mfma_f32_16x16x32_bf16 v[36:39], v[100:103], v[72:75], v[36:39]
    v_mfma_f32_16x16x32_bf16 v[40:43], v[248:251], v[128:131], v[40:43]
    v_cvt_pk_bf16_f32 v61, v34, v35
    v_mfma_f32_16x16x32_bf16 v[44:47], v[240:243], v[68:71], v[44:47]
    v_mfma_f32_16x16x32_bf16 v[44:47], v[108:111], v[72:75], v[44:47]
    v_cvt_pk_bf16_f32 v60, v32, v33
    s_waitcnt lgkmcnt(0)
    v_mfma_f32_16x16x32_bf16 v[36:39], v[112:115], v[128:131], v[36:39]
    s_nop 0
    v_cvt_pk_bf16_f32 v64, v40, v41
    v_cvt_pk_bf16_f32 v65, v42, v43
    v_mfma_f32_16x16x32_bf16 v[44:47], v[252:255], v[128:131], v[44:47]
    s_nop 3
    v_cvt_pk_bf16_f32 v62, v36, v37
    v_cvt_pk_bf16_f32 v63, v38, v39
    v_mov_b32_dpp v60, v64 row_ror:8 row_mask:0xf bank_mask:0xc
    s_nop 0
    v_cvt_pk_bf16_f32 v67, v46, v47
    v_cvt_pk_bf16_f32 v66, v44, v45
    v_mov_b32_dpp v61, v65 row_ror:8 row_mask:0xf bank_mask:0xc
    v_mov_b32_dpp v63, v67 row_ror:8 row_mask:0xf bank_mask:0xc
    v_mov_b32_dpp v62, v66 row_ror:8 row_mask:0xf bank_mask:0xc
    buffer_store_dwordx4 v[60:63], v8, s[8:11], s53 offen
    s_xor_b32 s47, s48, 8192
    s_add_u32 s52, s48, s21
    s_xor_b32 s45, s52, 1024
    s_xor_b32 s44, s51, 1024
    s_add_u32 s17, s17, 1
    s_mov_b32 s26, 8
    v_mov_b32 v11, 0
    s_add_u32 s28, s28, 524288
    s_add_u32 s30, s30, 262144
    s_cmp_eq_u32 s17, 63
    s_cselect_b32 s29, 64, s17
    ds_read_b128 v[92:95], v2 offset:0
    v_mov_b32 v11, 0
    ds_read_b128 v[96:99], v2 offset:32768
    ds_read_b128 v[100:103], v2 offset:1024
    v_mov_b32 v11, 0
    ds_read_b128 v[104:107], v2 offset:33792
    ds_read_b128 v[108:111], v2 offset:2048
    v_mov_b32 v11, 0
    ds_read_b128 v[112:115], v2 offset:34816
    v_mov_b32 v128, s19
    s_nop 3
    v_mov_b32 v129, s19
    s_nop 3
    v_mov_b32 v130, s19
    s_nop 3
    v_mov_b32 v131, s19
    s_nop 3
    v_mov_b32 v52, 0
    s_nop 3
    v_mov_b32 v53, 0
    s_nop 0
    buffer_load_dwordx4 v[24:27], v10, s[8:11], s51 offen sc1
    buffer_load_dwordx4 v[28:31], v10, s[8:11], s44 offen sc1
    v_mov_b32 v54, 0
    s_nop 3
    v_mov_b32 v55, 0
    s_nop 3
    v_mov_b32 v56, 0
    s_nop 3
    v_mov_b32 v57, 0
    s_nop 3
    v_mov_b32 v58, 0
    s_nop 3
    v_mov_b32 v59, 0
    s_nop 3
    v_mov_b32 v60, 0
    s_nop 1
    s_nop 1
    v_mov_b32_e64 v61, 0
    s_nop 0
    s_nop 0
    buffer_load_dwordx4 v[24:27], v10, s[8:11], s51 offen sc1
    buffer_load_dwordx4 v[28:31], v10, s[8:11], s44 offen sc1
    v_mov_b32_e64 v62, 0
    s_nop 1
    s_nop 1
    v_mov_b32 v63, 0
    s_nop 1
    s_nop 1
    v_mov_b32_e64 v64, 0
    s_nop 1
    s_nop 1
chain_fast_rpoll:
    s_waitcnt vmcnt(3)
    v_max3_u32 v116, v24, v25, v26
    v_max_u32 v116, v116, v27
    v_mfma_f32_16x16x32_bf16 v[132:135], v[12:15], v[24:27], 0
    s_waitcnt vmcnt(2)
    v_max3_u32 v116, v116, v28, v29
    v_max3_u32 v116, v116, v30, v31
    v_cmp_le_u32 vcc, s19, v116
    v_mfma_f32_16x16x32_bf16 v[132:135], v[12:15], v[28:31], v[132:135]
    s_sub_u32 s26, s26, 1
    s_nop 2
    s_nop 2
    s_cbranch_vccnz chain_fast_rretry
chain_fast_rok:
    v_add_f32_dpp v132, v132, v132 row_ror:4 row_mask:0xf bank_mask:0xf
    v_add_f32_dpp v133, v133, v133 row_ror:4 row_mask:0xf bank_mask:0xf
    v_add_f32_dpp v134, v134, v134 row_ror:4 row_mask:0xf bank_mask:0xf
    v_add_f32_dpp v135, v135, v135 row_ror:4 row_mask:0xf bank_mask:0xf
    v_add_f32_dpp v132, v132, v132 row_ror:8 row_mask:0xf bank_mask:0xf
    v_add_f32_dpp v133, v133, v133 row_ror:8 row_mask:0xf bank_mask:0xf
    v_add_f32_dpp v134, v134, v134 row_ror:8 row_mask:0xf bank_mask:0xf
    v_add_f32_dpp v135, v135, v135 row_ror:8 row_mask:0xf bank_mask:0xf
    v_cvt_pk_bf16_f32 v132, v132, v133
    v_cvt_pk_bf16_f32 v133, v134, v135
    s_mov_b64 exec, s[36:37]
    buffer_store_dwordx2 v[132:133], v9, s[8:11], s48 offen
    buffer_store_dwordx2 v[128:129], v9, s[8:11], s47 offen
    s_mov_b64 exec, -1
    v_cmp_ge_u32_e64 vcc, s29, v0
    s_xor_b32 s50, s50, 0x80000
    s_xor_b32 s53, s53, 0x80000
    s_xor_b32 s51, s51, 0x80000
    s_xor_b32 s49, s49, 0x80000
    s_xor_b32 s48, s48, 8192
    s_mov_b32 s26, 8
    s_cbranch_vccz chain_fast_gather
    v_mov_b32 v65, 0
    v_mov_b32 v66, 0
    v_mov_b32 v67, 0
    v_mov_b32 v68, 0
    v_mov_b32 v69, 0
    v_mov_b32 v70, 0
    v_mov_b32 v71, 0
    v_mov_b32 v72, 0
    v_mov_b32 v73, 0
    v_mov_b32 v74, 0
    v_mov_b32 v75, 0
    s_branch chain_fast_special
    s_nop 0
    s_nop 0
    s_nop 0
    s_nop 0
    s_nop 0
chain_fast_gretry:
    s_sub_u32 s26, s26, 1
    s_cbranch_scc1 chain_fast_gexact
    buffer_load_dwordx4 v[16:19], v1, s[8:11], s52 offen sc1
    buffer_load_dwordx4 v[20:23], v1, s[8:11], s45 offen sc1
    s_waitcnt vmcnt(3)
    v_max3_u32 v116, v16, v17, v18
    v_max_u32_e64 v116, v116, v19
    ds_write_b128 v3, v[16:19]
    s_waitcnt vmcnt(2)
    v_max3_u32 v116, v116, v20, v21
    v_max3_u32 v116, v116, v22, v23
    v_cmp_le_u32_e64 vcc, s19, v116
    ds_write_b128 v3, v[20:23] offset:1024
    s_cbranch_vccnz chain_fast_gretry
    s_branch chain_fast_step
    s_nop 0
    s_nop 0
    s_nop 0
    s_nop 0
    s_nop 0
    s_nop 0
chain_fast_rretry:
    s_cbranch_scc1 chain_fast_rexact
    buffer_load_dwordx4 v[24:27], v10, s[8:11], s51 offen sc1
    buffer_load_dwordx4 v[28:31], v10, s[8:11], s44 offen sc1
    s_branch chain_fast_rpoll
    s_nop 0
    s_nop 0
chain_fast_rexact:
    s_sub_u32 s3, s3, 1
    s_cbranch_scc1 main_timeout
    buffer_load_dwordx4 v[24:27], v10, s[8:11], s51 offen sc1
    buffer_load_dwordx4 v[28:31], v10, s[8:11], s44 offen sc1
    s_waitcnt vmcnt(0)
    v_cmp_eq_u32 vcc, s19, v24
    v_cmp_eq_u32 s[54:55], s19, v25
    s_nop 0
    s_or_b64 vcc, vcc, s[54:55]
    v_cmp_eq_u32 s[54:55], s19, v26
    s_nop 0
    s_or_b64 vcc, vcc, s[54:55]
    v_cmp_eq_u32 s[54:55], s19, v27
    s_nop 0
    s_or_b64 vcc, vcc, s[54:55]
    v_cmp_eq_u32 s[54:55], s19, v28
    s_nop 0
    s_or_b64 vcc, vcc, s[54:55]
    v_cmp_eq_u32 s[54:55], s19, v29
    s_nop 0
    s_or_b64 vcc, vcc, s[54:55]
    v_cmp_eq_u32 s[54:55], s19, v30
    s_nop 0
    s_or_b64 vcc, vcc, s[54:55]
    v_cmp_eq_u32 s[54:55], s19, v31
    s_nop 0
    s_or_b64 vcc, vcc, s[54:55]
    s_cbranch_vccnz chain_fast_rexact
    v_mfma_f32_16x16x32_bf16 v[132:135], v[12:15], v[24:27], 0
    v_mfma_f32_16x16x32_bf16 v[132:135], v[12:15], v[28:31], v[132:135]
    s_nop 7
    s_branch chain_fast_rok
    s_nop 0
    s_nop 0
    s_nop 0
    s_nop 0
    s_nop 0
chain_fast_kvwait:
    s_sub_u32 s3, s3, 1
    s_cbranch_scc1 main_timeout
    buffer_load_dword v0, off, s[8:11], s31 sc1
    s_nop 12
    s_nop 12
    s_nop 6
    s_nop 6
    buffer_load_dwordx4 v[16:19], v1, s[8:11], s52 offen sc1
    buffer_load_dwordx4 v[20:23], v1, s[8:11], s45 offen sc1
    s_waitcnt vmcnt(0)
chain_fast_special:
    v_cmp_ge_u32 vcc, s17, v0
    s_cbranch_vccnz chain_fast_kvwait
    s_cmp_eq_u32 s17, 63
    s_cbranch_scc0 chain_fast_gretry
    s_nop 11
    s_nop 11
chain_fast_gexact:
    buffer_load_dwordx4 v[16:19], v1, s[8:11], s52 offen sc1
    buffer_load_dwordx4 v[20:23], v1, s[8:11], s45 offen sc1
    s_waitcnt vmcnt(0)
    s_sub_u32 s3, s3, 1
    s_cbranch_scc1 main_timeout
    s_waitcnt vmcnt(3)
    v_max3_u32 v116, v16, v17, v18
    v_max_u32 v116, v116, v19
    ds_write_b128 v3, v[16:19]
    s_waitcnt vmcnt(2)
    v_max3_u32 v116, v116, v20, v21
    v_max3_u32 v116, v116, v22, v23
    v_cmp_le_u32_e64 vcc, s19, v116
    ds_write_b128 v3, v[20:23] offset:1024
    s_cbranch_vccz chain_fast_spok
    v_cmp_eq_u32_e64 vcc, s19, v16
    v_cmp_eq_u32 s[54:55], s19, v17
    s_nop 0
    s_or_b64 vcc, vcc, s[54:55]
    v_cmp_eq_u32 s[54:55], s19, v18
    s_nop 0
    s_or_b64 vcc, vcc, s[54:55]
    v_cmp_eq_u32 s[54:55], s19, v19
    s_nop 0
    s_or_b64 vcc, vcc, s[54:55]
    v_cmp_eq_u32 s[54:55], s19, v20
    s_nop 0
    s_or_b64 vcc, vcc, s[54:55]
    v_cmp_eq_u32 s[54:55], s19, v21
    s_nop 0
    s_or_b64 vcc, vcc, s[54:55]
    v_cmp_eq_u32 s[54:55], s19, v22
    s_nop 0
    s_or_b64 vcc, vcc, s[54:55]
    v_cmp_eq_u32 s[54:55], s19, v23
    s_nop 0
    s_or_b64 vcc, vcc, s[54:55]
    s_cbranch_vccnz chain_fast_gexact
chain_fast_spok:
    s_cmp_eq_u32 s17, 63
    s_cbranch_scc0 chain_fast_step
    s_waitcnt lgkmcnt(0)
    s_branch chain_last
    s_nop 0
    s_nop 0
    s_nop 0
chain_slow_gather:
    v_mov_b32 v65, 0
    s_nop 3
    v_mov_b32 v66, 0
    s_nop 3
    v_mov_b32 v67, 0
    s_nop 3
    v_mov_b32 v68, 0
    s_nop 3
    v_mov_b32 v69, 0
    s_nop 3
    v_mov_b32 v70, 0
    s_nop 3
    buffer_load_dwordx4 v[16:19], v1, s[8:11], s52 offen sc1
    buffer_load_dwordx4 v[20:23], v1, s[8:11], s45 offen sc1
    v_mov_b32 v71, 0
    s_nop 3
    v_mov_b32 v72, 0
    s_nop 3
    v_mov_b32 v73, 0
    s_nop 3
    v_mov_b32 v74, 0
    s_nop 3
    v_mov_b32 v75, 0
    s_nop 3
    v_mov_b32 v11, 0
    s_nop 3
    v_mov_b32 v11, 0
    s_nop 3
    v_mov_b32 v11, 0
    s_nop 3
    v_mov_b32 v11, 0
    s_nop 0
    buffer_load_dwordx4 v[16:19], v1, s[8:11], s52 offen sc1
    buffer_load_dwordx4 v[20:23], v1, s[8:11], s45 offen sc1
    v_mov_b32 v11, 0
    s_nop 3
    v_mov_b32 v11, 0
    s_nop 3
    s_waitcnt vmcnt(3)
    v_max3_u32 v116, v16, v17, v18
    v_max_u32 v116, v116, v19
    ds_write_b128 v3, v[16:19]
    s_waitcnt vmcnt(2)
    v_max3_u32 v116, v116, v20, v21
    v_max3_u32 v116, v116, v22, v23
    v_cmp_le_u32_e64 vcc, s19, v116
    ds_write_b128 v3, v[20:23] offset:1024
    s_cbranch_vccnz chain_slow_gretry
chain_slow_step:
    v_smfmac_f32_16x16x64_bf16 v[56:59], v[16:19], a[8:15], v48
    buffer_load_dwordx4 v[76:79], v1, s[8:11], s28 offen offset:0 sc1
    v_smfmac_f32_16x16x64_bf16 v[68:71], v[16:19], a[32:39], v48
    buffer_load_dwordx4 v[80:83], v1, s[8:11], s28 offen offset:1024 sc1
    v_smfmac_f32_16x16x64_bf16 v[60:63], v[16:19], a[16:23], v48
    buffer_load_dwordx4 v[84:87], v1, s[8:11], s28 offen offset:2048 sc1
    v_smfmac_f32_16x16x64_bf16 v[72:75], v[16:19], a[40:47], v48
    buffer_load_dwordx4 v[88:91], v1, s[8:11], s28 offen offset:3072 sc1
    v_smfmac_f32_16x16x64_bf16 v[64:67], v[16:19], a[24:31], v48
    s_waitcnt lgkmcnt(0)
    s_barrier
    v_smfmac_f32_16x16x64_bf16 v[60:63], v[20:23], a[48:55], v48
    ds_read_b128 v[24:27], v4
    v_smfmac_f32_16x16x64_bf16 v[64:67], v[20:23], a[56:63], v48
    ds_read_b128 v[32:35], v5
    v_smfmac_f32_16x16x64_bf16 v[56:59], v[20:23], v[100:107], v48
    ds_read_b128 v[28:31], v4 offset:1024
    v_smfmac_f32_16x16x64_bf16 v[52:55], v[16:19], a[0:7], v48
    buffer_load_dword v0, v49, s[8:11], s28 offen sc1
    v_smfmac_f32_16x16x64_bf16 v[52:55], v[20:23], v[92:99], v48
    ds_read_b128 v[96:99], v2 offset:35840
    s_waitcnt lgkmcnt(3)
    v_smfmac_f32_16x16x64_bf16 v[56:59], v[24:27], a[88:95], v48
    ds_read_b128 v[104:107], v2 offset:36864
    v_smfmac_f32_16x16x64_bf16 v[64:67], v[24:27], a[136:143], v48
    ds_read_b128 v[92:95], v2 offset:3072
    v_smfmac_f32_16x16x64_bf16 v[52:55], v[24:27], a[80:87], v48
    s_waitcnt lgkmcnt(3)
    v_smfmac_f32_16x16x64_bf16 v[52:55], v[28:31], v[108:115], v48
    ds_read_b128 v[112:115], v2 offset:37888
    v_smfmac_f32_16x16x64_bf16 v[60:63], v[24:27], a[128:135], v48
    ds_read_b128 v[100:103], v2 offset:4096
    v_smfmac_f32_16x16x64_bf16 v[64:67], v[28:31], a[152:159], v48
    ds_read_b128 v[36:39], v5 offset:1024
    v_smfmac_f32_16x16x64_bf16 v[64:67], v[32:35], a[168:175], v48
    buffer_load_dword v0, off, s[8:11], s31 sc1
    v_smfmac_f32_16x16x64_bf16 v[60:63], v[28:31], a[144:151], v48
    ds_read_b128 v[108:111], v2 offset:5120
    v_smfmac_f32_16x16x64_bf16 v[52:55], v[32:35], a[96:103], v48
    ds_read_b128 v[40:43], v6
    v_smfmac_f32_16x16x64_bf16 v[60:63], v[32:35], a[160:167], v48
    ds_read_b128 v[44:47], v6 offset:1024
    s_waitcnt lgkmcnt(3)
    v_smfmac_f32_16x16x64_bf16 v[52:55], v[36:39], v[100:107], v48
    ds_read_b128 v[104:107], v2 offset:39936
    v_smfmac_f32_16x16x64_bf16 v[56:59], v[28:31], v[92:99], v48
    ds_read_b128 v[92:95], v2 offset:6144
    v_smfmac_f32_16x16x64_bf16 v[60:63], v[36:39], a[176:183], v48
    ds_read_b128 v[96:99], v2 offset:38912
    v_smfmac_f32_16x16x64_bf16 v[56:59], v[32:35], a[104:111], v48
    ds_read_b128 v[100:103], v2 offset:7168
    s_waitcnt lgkmcnt(6)
    v_smfmac_f32_16x16x64_bf16 v[56:59], v[36:39], v[108:115], v48
    ds_read_b128 v[112:115], v7 offset:5120
    s_waitcnt lgkmcnt(6)
    v_smfmac_f32_16x16x64_bf16 v[56:59], v[40:43], a[120:127], v48
    v_smfmac_f32_16x16x64_bf16 v[52:55], v[40:43], a[112:119], v48
    s_waitcnt lgkmcnt(2)
    v_smfmac_f32_16x16x64_bf16 v[52:55], v[44:47], v[92:99], v48
    s_nop 0
    v_smfmac_f32_16x16x64_bf16 v[64:67], v[36:39], a[184:191], v48
    s_waitcnt lgkmcnt(1)
    v_smfmac_f32_16x16x64_bf16 v[56:59], v[44:47], v[100:107], v48
    ds_read_b128 v[100:103], v7 offset:2048
    v_cvt_pk_bf16_f32 v117, v54, v55
    v_smfmac_f32_16x16x64_bf16 v[64:67], v[40:43], a[200:207], v48
    ds_read_b128 v[92:95], v7 offset:0
    v_cvt_pk_bf16_f32 v116, v52, v53
    v_smfmac_f32_16x16x64_bf16 v[60:63], v[40:43], a[192:199], v48
    v_cvt_pk_bf16_f32 v119, v58, v59
    v_smfmac_f32_16x16x64_bf16 v[64:67], v[44:47], a[216:223], v48
    v_cvt_pk_bf16_f32 v118, v56, v57
    v_smfmac_f32_16x16x64_bf16 v[60:63], v[44:47], a[208:215], v48
    buffer_store_dwordx4 v[128:131], v1, s[8:11], s49 offen sc1
    v_mfma_f32_16x16x16_bf16 v[56:59], v[118:119], v[50:51], 0
    v_cvt_pk_bf16_f32 v122, v64, v65
    ds_read_b128 v[104:107], v7 offset:3072
    v_mfma_f32_16x16x16_bf16 v[52:55], v[116:117], v[50:51], 0
    v_cvt_pk_bf16_f32 v123, v66, v67
    v_cvt_pk_bf16_f32 v121, v62, v63
    s_nop 0
    v_mfma_f32_16x16x16_bf16 v[64:67], v[122:123], v[50:51], 0
    v_cvt_pk_bf16_f32 v120, v60, v61
    v_cvt_pk_bf16_f32 v119, v58, v59
    v_cvt_pk_bf16_f32 v118, v56, v57
    v_mfma_f32_16x16x16_bf16 v[60:63], v[120:121], v[50:51], 0
    v_cvt_pk_bf16_f32 v116, v52, v53
    v_cvt_pk_bf16_f32 v117, v54, v55
    s_waitcnt vmcnt(5)
    s_nop 0
    v_mfma_f32_16x16x32_bf16 v[56:59], v[80:83], v[116:119], 0
    s_nop 0
    v_cvt_pk_bf16_f32 v122, v64, v65
    v_cvt_pk_bf16_f32 v123, v66, v67
    v_mfma_f32_16x16x32_bf16 v[52:55], v[76:79], v[116:119], 0
    v_cvt_pk_bf16_f32 v121, v62, v63
    v_cvt_pk_bf16_f32 v120, v60, v61
    v_smfmac_f32_16x16x64_bf16 v[72:75], v[20:23], a[72:79], v48
    ds_read_b128 v[96:99], v7 offset:1024
    v_mfma_f32_16x16x32_bf16 v[60:63], v[120:123], v[116:119], 0
    v_mov_b32_dpp v52, v56 quad_perm:[0,1,2,3] row_mask:0xf bank_mask:0xc
    v_mov_b32_dpp v55, v59 quad_perm:[0,1,2,3] row_mask:0xf bank_mask:0xc
    v_smfmac_f32_16x16x64_bf16 v[72:75], v[24:27], a[232:239], v48
    v_mov_b32_dpp v53, v57 quad_perm:[0,1,2,3] row_mask:0xf bank_mask:0xc
    v_smfmac_f32_16x16x64_bf16 v[72:75], v[28:31], a[248:255], v48
    s_nop 0
    v_mov_b32_dpp v61, v63 quad_perm:[0,1,2,3] row_mask:0xf bank_mask:0xc
    v_mov_b32_dpp v60, v62 quad_perm:[0,1,2,3] row_mask:0xf bank_mask:0xc
    v_smfmac_f32_16x16x64_bf16 v[72:75], v[32:35], v[144:151], v48
    ds_write_b64 v3, v[60:61] offset:17408
    v_mov_b32_dpp v54, v58 quad_perm:[0,1,2,3] row_mask:0xf bank_mask:0xc
    v_smfmac_f32_16x16x64_bf16 v[72:75], v[36:39], v[160:167], v48
    ds_write_b128 v3, v[52:55] offset:16384
    v_smfmac_f32_16x16x64_bf16 v[72:75], v[40:43], v[176:183], v48
    buffer_store_dwordx4 v[120:123], v1, s[8:11], s30 offen sc1
    v_smfmac_f32_16x16x64_bf16 v[68:71], v[20:23], a[64:71], v48
    s_waitcnt lgkmcnt(0)
    s_waitcnt vmcnt(8)
    s_barrier
    v_smfmac_f32_16x16x64_bf16 v[68:71], v[24:27], a[224:231], v48
    ds_read_b64 v[62:63], v4 offset:17408
    ds_read_b128 v[76:79], v5 offset:16384
    v_smfmac_f32_16x16x64_bf16 v[68:71], v[28:31], a[240:247], v48
    ds_read_b128 v[56:59], v4 offset:16384
    ds_read_b64 v[66:67], v6 offset:17408
    v_smfmac_f32_16x16x64_bf16 v[68:71], v[32:35], v[136:143], v48
    ds_read_b64 v[64:65], v5 offset:17408
    ds_read_b128 v[80:83], v6 offset:16384
    v_smfmac_f32_16x16x64_bf16 v[72:75], v[44:47], v[192:199], v48
    buffer_store_dwordx4 v[128:131], v1, s[8:11], s49 offen offset:1024 sc1
    s_waitcnt lgkmcnt(3)
    v_pk_add_f32 v[52:53], v[52:53], v[56:57]
    v_pk_add_f32 v[54:55], v[54:55], v[58:59]
    v_pk_add_f32 v[54:55], v[54:55], v[78:79]
    v_pk_add_f32 v[60:61], v[60:61], v[62:63]
    v_pk_add_f32 v[52:53], v[52:53], v[76:77]
    s_waitcnt lgkmcnt(0)
    v_pk_add_f32 v[52:53], v[52:53], v[80:81]
    v_pk_add_f32 v[54:55], v[54:55], v[82:83]
    v_pk_add_f32 v[60:61], v[60:61], v[64:65]
    v_pk_add_f32 v[60:61], v[60:61], v[66:67]
    v_max3_f32 v132, v52, v53, v54
    v_max3_f32 v133, v55, v60, v61
    v_max_f32 v132, v132, v133
    v_smfmac_f32_16x16x64_bf16 v[68:71], v[36:39], v[152:159], v48
    s_nop 0
    v_max_f32_dpp v132, v132, v132 row_ror:8 row_mask:0xf bank_mask:0xf
    v_mov_b32 v133, v132
    v_smfmac_f32_16x16x64_bf16 v[68:71], v[40:43], v[168:175], v48
    s_nop 0
    v_permlane16_swap_b32 v132, v133
    v_max_f32 v132, v132, v133
    v_mov_b32 v133, v132
    v_smfmac_f32_16x16x64_bf16 v[68:71], v[44:47], v[184:191], v48
    ds_read_b128 v[108:111], v7 offset:4096
    v_permlane32_swap_b32 v132, v133
    v_max_f32 v132, v132, v133
    v_mul_f32 v132, s18, v132
    v_pk_fma_f32 v[60:61], v[60:61], s[18:19], v[132:133] op_sel_hi:[1,0,0] neg_lo:[0,0,1] neg_hi:[0,0,1]
    v_pk_fma_f32 v[54:55], v[54:55], s[18:19], v[132:133] op_sel_hi:[1,0,0] neg_lo:[0,0,1] neg_hi:[0,0,1]
    v_pk_fma_f32 v[52:53], v[52:53], s[18:19], v[132:133] op_sel_hi:[1,0,0] neg_lo:[0,0,1] neg_hi:[0,0,1]
    v_exp_f32 v55, v55
    v_exp_f32 v61, v61
    v_exp_f32 v53, v53
    v_exp_f32 v52, v52
    v_exp_f32 v54, v54
    v_cvt_pk_bf16_f32 v124, v68, v69
    v_cvt_pk_bf16_f32 v125, v70, v71
    v_exp_f32 v60, v60
    v_cvt_pk_bf16_f32 v128, v52, v53
    v_cvt_pk_bf16_f32 v129, v54, v55
    v_cvt_pk_bf16_f32 v126, v72, v73
    v_pk_add_f32 v[52:53], v[52:53], v[54:55]
    v_pk_fma_f32 v[52:53], v[60:61], 0.5, v[52:53] op_sel_hi:[1,0,1]
    v_mov_b32_dpp v130, v128 row_ror:8 row_mask:0xf bank_mask:0xf
    v_mov_b32_dpp v131, v129 row_ror:8 row_mask:0xf bank_mask:0xf
    v_cvt_pk_bf16_f32 v127, v74, v75
    v_add_f32 v134, v52, v53
    s_waitcnt vmcnt(6)
    v_mfma_f32_16x16x32_bf16 v[76:79], v[84:87], v[128:131], 0
    buffer_store_dwordx4 v[124:127], v1, s[8:11], s30 offen offset:1024 sc1
    v_cvt_pk_bf16_f32 v62, v60, v61
    v_add_f32_dpp v134, v134, v134 row_ror:8 row_mask:0xf bank_mask:0xf
    v_mov_b32 v135, v134
    s_waitcnt vmcnt(6)
    v_mfma_f32_16x16x32_bf16 v[80:83], v[88:91], v[128:131], 0
    v_mov_b32_dpp v63, v62 row_ror:8 row_mask:0xf bank_mask:0xf
    v_permlane16_swap_b32 v134, v135
    s_nop 0
    v_mfma_f32_16x16x16_bf16 v[76:79], v[124:125], v[62:63], v[76:79]
    v_add_f32 v134, v134, v135
    v_mov_b32 v135, v134
    v_mfma_f32_16x16x16_bf16 v[80:83], v[126:127], v[62:63], v[80:83]
    s_nop 0
    v_permlane32_swap_b32 v134, v135
    v_add_f32 v134, v134, v135
    v_rcp_f32 v134, v134
    s_nop 0
    v_cndmask_b32 v134, 0, v134, s[34:35]
    v_pk_mul_f32 v[76:77], v[76:77], v[134:135] op_sel_hi:[1,0]
    v_pk_mul_f32 v[78:79], v[78:79], v[134:135] op_sel_hi:[1,0]
    v_cvt_pk_bf16_f32 v116, v76, v77
    v_pk_mul_f32 v[82:83], v[82:83], v[134:135] op_sel_hi:[1,0]
    v_pk_mul_f32 v[80:81], v[80:81], v[134:135] op_sel_hi:[1,0]
    v_cvt_pk_bf16_f32 v117, v78, v79
    v_cvt_pk_bf16_f32 v118, v80, v81
    v_cvt_pk_bf16_f32 v119, v82, v83
    ds_write_b128 v3, v[116:119] offset:8192
    s_nop 0
    v_mfma_f32_16x16x32_bf16 v[16:19], v[92:95], v[116:119], 0
    ds_read_b128 v[92:95], v7 offset:6144
    v_mfma_f32_16x16x32_bf16 v[20:23], v[96:99], v[116:119], 0
    ds_read_b128 v[96:99], v7 offset:7168
    v_mfma_f32_16x16x32_bf16 v[28:31], v[104:107], v[116:119], 0
    s_waitcnt lgkmcnt(2)
    s_barrier
    v_mfma_f32_16x16x32_bf16 v[32:35], v[108:111], v[116:119], 0
    ds_read_b128 v[68:71], v4 offset:8192
    v_mfma_f32_16x16x32_bf16 v[24:27], v[100:103], v[116:119], 0
    ds_read_b128 v[108:111], v7 offset:34816
    v_mfma_f32_16x16x32_bf16 v[36:39], v[112:115], v[116:119], 0
    ds_read_b128 v[100:103], v7 offset:32768
    s_waitcnt lgkmcnt(3)
    v_mfma_f32_16x16x32_bf16 v[44:47], v[96:99], v[116:119], 0
    ds_read_b128 v[72:75], v5 offset:8192
    v_mfma_f32_16x16x32_bf16 v[40:43], v[92:95], v[116:119], 0
    ds_read_b128 v[128:131], v6 offset:8192
    s_waitcnt lgkmcnt(4)
    v_mfma_f32_16x16x32_bf16 v[24:27], v[208:211], v[68:71], v[24:27]
    ds_read_b128 v[104:107], v7 offset:33792
    v_mfma_f32_16x16x32_bf16 v[20:23], v[204:207], v[68:71], v[20:23]
    ds_read_b128 v[92:95], v3 offset:24576
    v_mfma_f32_16x16x32_bf16 v[16:19], v[200:203], v[68:71], v[16:19]
    ds_read_b128 v[112:115], v7 offset:35840
    s_waitcnt lgkmcnt(4)
    v_mfma_f32_16x16x32_bf16 v[16:19], v[100:103], v[72:75], v[16:19]
    ds_read_b128 v[100:103], v7 offset:37888
    s_waitcnt lgkmcnt(4)
    v_mfma_f32_16x16x32_bf16 v[16:19], v[216:219], v[128:131], v[16:19]
    v_mfma_f32_16x16x32_bf16 v[24:27], v[108:111], v[72:75], v[24:27]
    ds_read_b128 v[108:111], v7 offset:39936
    v_mfma_f32_16x16x32_bf16 v[24:27], v[220:223], v[128:131], v[24:27]
    ds_read_b128 v[96:99], v7 offset:36864
    s_waitcnt lgkmcnt(5)
    v_mfma_f32_16x16x32_bf16 v[20:23], v[104:107], v[72:75], v[20:23]
    ds_read_b128 v[104:107], v7 offset:38912
    s_waitcnt lgkmcnt(5)
    v_mfma_f32_16x16x32_bf16 v[20:23], v[92:95], v[128:131], v[20:23]
    s_nop 0
    v_cvt_pk_bf16_f32 v53, v18, v19
    v_cvt_pk_bf16_f32 v57, v26, v27
    v_mfma_f32_16x16x32_bf16 v[28:31], v[212:215], v[68:71], v[28:31]
    s_nop 0
    v_mov_b32_dpp v53, v57 row_ror:8 row_mask:0xf bank_mask:0xc
    s_waitcnt lgkmcnt(4)
    v_mfma_f32_16x16x32_bf16 v[28:31], v[112:115], v[72:75], v[28:31]
    s_nop 0
    v_cvt_pk_bf16_f32 v54, v20, v21
    v_cvt_pk_bf16_f32 v56, v24, v25
    v_mfma_f32_16x16x32_bf16 v[28:31], v[224:227], v[128:131], v[28:31]
    v_cvt_pk_bf16_f32 v55, v22, v23
    v_cvt_pk_bf16_f32 v52, v16, v17
    v_mfma_f32_16x16x32_bf16 v[40:43], v[236:239], v[68:71], v[40:43]
    s_nop 0
    v_mov_b32_dpp v52, v56 row_ror:8 row_mask:0xf bank_mask:0xc
    s_waitcnt lgkmcnt(0)
    v_mfma_f32_16x16x32_bf16 v[40:43], v[104:107], v[72:75], v[40:43]
    v_cvt_pk_bf16_f32 v58, v28, v29
    v_cvt_pk_bf16_f32 v59, v30, v31
    v_mfma_f32_16x16x32_bf16 v[32:35], v[228:231], v[68:71], v[32:35]
    v_mov_b32_dpp v54, v58 row_ror:8 row_mask:0xf bank_mask:0xc
    v_mov_b32_dpp v55, v59 row_ror:8 row_mask:0xf bank_mask:0xc
    v_mfma_f32_16x16x32_bf16 v[36:39], v[232:235], v[68:71], v[36:39]
    buffer_store_dwordx4 v[52:55], v8, s[8:11], s50 offen sc1
    v_mfma_f32_16x16x32_bf16 v[32:35], v[96:99], v[72:75], v[32:35]
    ds_read_b128 v[112:115], v3 offset:25600
    v_mfma_f32_16x16x32_bf16 v[32:35], v[244:247], v[128:131], v[32:35]
    v_mfma_f32_16x16x32_bf16 v[36:39], v[100:103], v[72:75], v[36:39]
    v_mfma_f32_16x16x32_bf16 v[40:43], v[248:251], v[128:131], v[40:43]
    v_cvt_pk_bf16_f32 v61, v34, v35
    v_mfma_f32_16x16x32_bf16 v[44:47], v[240:243], v[68:71], v[44:47]
    v_mfma_f32_16x16x32_bf16 v[44:47], v[108:111], v[72:75], v[44:47]
    v_cvt_pk_bf16_f32 v60, v32, v33
    s_waitcnt lgkmcnt(0)
    v_mfma_f32_16x16x32_bf16 v[36:39], v[112:115], v[128:131], v[36:39]
    s_nop 0
    v_cvt_pk_bf16_f32 v64, v40, v41
    v_cvt_pk_bf16_f32 v65, v42, v43
    v_mfma_f32_16x16x32_bf16 v[44:47], v[252:255], v[128:131], v[44:47]
    s_nop 3
    v_cvt_pk_bf16_f32 v62, v36, v37
    v_cvt_pk_bf16_f32 v63, v38, v39
    v_mov_b32_dpp v60, v64 row_ror:8 row_mask:0xf bank_mask:0xc
    s_nop 0
    v_cvt_pk_bf16_f32 v67, v46, v47
    v_cvt_pk_bf16_f32 v66, v44, v45
    v_mov_b32_dpp v61, v65 row_ror:8 row_mask:0xf bank_mask:0xc
    v_mov_b32_dpp v63, v67 row_ror:8 row_mask:0xf bank_mask:0xc
    v_mov_b32_dpp v62, v66 row_ror:8 row_mask:0xf bank_mask:0xc
    buffer_store_dwordx4 v[60:63], v8, s[8:11], s53 offen sc1
    s_xor_b32 s47, s48, 8192
    s_add_u32 s52, s48, s21
    s_xor_b32 s45, s52, 1024
    s_xor_b32 s44, s51, 1024
    s_add_u32 s17, s17, 1
    s_mov_b32 s26, 8
    v_mov_b32 v11, 0
    s_add_u32 s28, s28, 524288
    s_add_u32 s30, s30, 262144
    s_cmp_eq_u32 s17, 63
    s_cselect_b32 s29, 64, s17
    ds_read_b128 v[92:95], v2 offset:0
    v_mov_b32 v11, 0
    ds_read_b128 v[96:99], v2 offset:32768
    ds_read_b128 v[100:103], v2 offset:1024
    v_mov_b32 v11, 0
    ds_read_b128 v[104:107], v2 offset:33792
    ds_read_b128 v[108:111], v2 offset:2048
    v_mov_b32 v11, 0
    ds_read_b128 v[112:115], v2 offset:34816
    v_mov_b32 v128, s19
    s_nop 3
    v_mov_b32 v129, s19
    s_nop 3
    v_mov_b32 v130, s19
    s_nop 3
    v_mov_b32 v131, s19
    s_nop 3
    v_mov_b32 v52, 0
    s_nop 3
    v_mov_b32 v53, 0
    s_nop 0
    buffer_load_dwordx4 v[24:27], v10, s[8:11], s51 offen sc1
    buffer_load_dwordx4 v[28:31], v10, s[8:11], s44 offen sc1
    v_mov_b32 v54, 0
    s_nop 3
    v_mov_b32 v55, 0
    s_nop 3
    v_mov_b32 v56, 0
    s_nop 3
    v_mov_b32 v57, 0
    s_nop 3
    v_mov_b32 v58, 0
    s_nop 3
    v_mov_b32 v59, 0
    s_nop 3
    v_mov_b32 v60, 0
    s_nop 1
    s_nop 1
    v_mov_b32_e64 v61, 0
    s_nop 0
    s_nop 0
    buffer_load_dwordx4 v[24:27], v10, s[8:11], s51 offen sc1
    buffer_load_dwordx4 v[28:31], v10, s[8:11], s44 offen sc1
    v_mov_b32_e64 v62, 0
    s_nop 1
    s_nop 1
    v_mov_b32 v63, 0
    s_nop 1
    s_nop 1
    v_mov_b32_e64 v64, 0
    s_nop 1
    s_nop 1
chain_slow_rpoll:
    s_waitcnt vmcnt(3)
    v_max3_u32 v116, v24, v25, v26
    v_max_u32 v116, v116, v27
    v_mfma_f32_16x16x32_bf16 v[132:135], v[12:15], v[24:27], 0
    s_waitcnt vmcnt(2)
    v_max3_u32 v116, v116, v28, v29
    v_max3_u32 v116, v116, v30, v31
    v_cmp_le_u32 vcc, s19, v116
    v_mfma_f32_16x16x32_bf16 v[132:135], v[12:15], v[28:31], v[132:135]
    s_sub_u32 s26, s26, 1
    s_nop 2
    s_nop 2
    s_cbranch_vccnz chain_slow_rretry
chain_slow_rok:
    v_add_f32_dpp v132, v132, v132 row_ror:4 row_mask:0xf bank_mask:0xf
    v_add_f32_dpp v133, v133, v133 row_ror:4 row_mask:0xf bank_mask:0xf
    v_add_f32_dpp v134, v134, v134 row_ror:4 row_mask:0xf bank_mask:0xf
    v_add_f32_dpp v135, v135, v135 row_ror:4 row_mask:0xf bank_mask:0xf
    v_add_f32_dpp v132, v132, v132 row_ror:8 row_mask:0xf bank_mask:0xf
    v_add_f32_dpp v133, v133, v133 row_ror:8 row_mask:0xf bank_mask:0xf
    v_add_f32_dpp v134, v134, v134 row_ror:8 row_mask:0xf bank_mask:0xf
    v_add_f32_dpp v135, v135, v135 row_ror:8 row_mask:0xf bank_mask:0xf
    v_cvt_pk_bf16_f32 v132, v132, v133
    v_cvt_pk_bf16_f32 v133, v134, v135
    s_mov_b64 exec, s[36:37]
    buffer_store_dwordx2 v[132:133], v9, s[8:11], s48 offen sc1
    buffer_store_dwordx2 v[128:129], v9, s[8:11], s47 offen sc1
    s_mov_b64 exec, -1
    v_cmp_ge_u32_e64 vcc, s29, v0
    s_xor_b32 s50, s50, 0x80000
    s_xor_b32 s53, s53, 0x80000
    s_xor_b32 s51, s51, 0x80000
    s_xor_b32 s49, s49, 0x80000
    s_xor_b32 s48, s48, 8192
    s_mov_b32 s26, 8
    s_cbranch_vccz chain_slow_gather
    v_mov_b32 v65, 0
    v_mov_b32 v66, 0
    v_mov_b32 v67, 0
    v_mov_b32 v68, 0
    v_mov_b32 v69, 0
    v_mov_b32 v70, 0
    v_mov_b32 v71, 0
    v_mov_b32 v72, 0
    v_mov_b32 v73, 0
    v_mov_b32 v74, 0
    v_mov_b32 v75, 0
    s_branch chain_slow_special
    s_nop 0
    s_nop 0
    s_nop 0
    s_nop 0
    s_nop 0
chain_slow_gretry:
    s_sub_u32 s26, s26, 1
    s_cbranch_scc1 chain_slow_gexact
    buffer_load_dwordx4 v[16:19], v1, s[8:11], s52 offen sc1
    buffer_load_dwordx4 v[20:23], v1, s[8:11], s45 offen sc1
    s_waitcnt vmcnt(3)
    v_max3_u32 v116, v16, v17, v18
    v_max_u32_e64 v116, v116, v19
    ds_write_b128 v3, v[16:19]
    s_waitcnt vmcnt(2)
    v_max3_u32 v116, v116, v20, v21
    v_max3_u32 v116, v116, v22, v23
    v_cmp_le_u32_e64 vcc, s19, v116
    ds_write_b128 v3, v[20:23] offset:1024
    s_cbranch_vccnz chain_slow_gretry
    s_branch chain_slow_step
    s_nop 0
    s_nop 0
    s_nop 0
    s_nop 0
    s_nop 0
    s_nop 0
chain_slow_rretry:
    s_cbranch_scc1 chain_slow_rexact
    buffer_load_dwordx4 v[24:27], v10, s[8:11], s51 offen sc1
    buffer_load_dwordx4 v[28:31], v10, s[8:11], s44 offen sc1
    s_branch chain_slow_rpoll
    s_nop 0
    s_nop 0
chain_slow_rexact:
    s_sub_u32 s3, s3, 1
    s_cbranch_scc1 main_timeout
    buffer_load_dwordx4 v[24:27], v10, s[8:11], s51 offen sc1
    buffer_load_dwordx4 v[28:31], v10, s[8:11], s44 offen sc1
    s_waitcnt vmcnt(0)
    v_cmp_eq_u32 vcc, s19, v24
    v_cmp_eq_u32 s[54:55], s19, v25
    s_nop 0
    s_or_b64 vcc, vcc, s[54:55]
    v_cmp_eq_u32 s[54:55], s19, v26
    s_nop 0
    s_or_b64 vcc, vcc, s[54:55]
    v_cmp_eq_u32 s[54:55], s19, v27
    s_nop 0
    s_or_b64 vcc, vcc, s[54:55]
    v_cmp_eq_u32 s[54:55], s19, v28
    s_nop 0
    s_or_b64 vcc, vcc, s[54:55]
    v_cmp_eq_u32 s[54:55], s19, v29
    s_nop 0
    s_or_b64 vcc, vcc, s[54:55]
    v_cmp_eq_u32 s[54:55], s19, v30
    s_nop 0
    s_or_b64 vcc, vcc, s[54:55]
    v_cmp_eq_u32 s[54:55], s19, v31
    s_nop 0
    s_or_b64 vcc, vcc, s[54:55]
    s_cbranch_vccnz chain_slow_rexact
    v_mfma_f32_16x16x32_bf16 v[132:135], v[12:15], v[24:27], 0
    v_mfma_f32_16x16x32_bf16 v[132:135], v[12:15], v[28:31], v[132:135]
    s_nop 7
    s_branch chain_slow_rok
    s_nop 0
    s_nop 0
    s_nop 0
    s_nop 0
    s_nop 0
chain_slow_kvwait:
    s_sub_u32 s3, s3, 1
    s_cbranch_scc1 main_timeout
    buffer_load_dword v0, off, s[8:11], s31 sc1
    s_nop 12
    s_nop 12
    s_nop 6
    s_nop 6
    buffer_load_dwordx4 v[16:19], v1, s[8:11], s52 offen sc1
    buffer_load_dwordx4 v[20:23], v1, s[8:11], s45 offen sc1
    s_waitcnt vmcnt(0)
chain_slow_special:
    v_cmp_ge_u32 vcc, s17, v0
    s_cbranch_vccnz chain_slow_kvwait
    s_cmp_eq_u32 s17, 63
    s_cbranch_scc0 chain_slow_gretry
    s_nop 11
    s_nop 11
chain_slow_gexact:
    buffer_load_dwordx4 v[16:19], v1, s[8:11], s52 offen sc1
    buffer_load_dwordx4 v[20:23], v1, s[8:11], s45 offen sc1
    s_waitcnt vmcnt(0)
    s_sub_u32 s3, s3, 1
    s_cbranch_scc1 main_timeout
    s_waitcnt vmcnt(3)
    v_max3_u32 v116, v16, v17, v18
    v_max_u32 v116, v116, v19
    ds_write_b128 v3, v[16:19]
    s_waitcnt vmcnt(2)
    v_max3_u32 v116, v116, v20, v21
    v_max3_u32 v116, v116, v22, v23
    v_cmp_le_u32_e64 vcc, s19, v116
    ds_write_b128 v3, v[20:23] offset:1024
    s_cbranch_vccz chain_slow_spok
    v_cmp_eq_u32_e64 vcc, s19, v16
    v_cmp_eq_u32 s[54:55], s19, v17
    s_nop 0
    s_or_b64 vcc, vcc, s[54:55]
    v_cmp_eq_u32 s[54:55], s19, v18
    s_nop 0
    s_or_b64 vcc, vcc, s[54:55]
    v_cmp_eq_u32 s[54:55], s19, v19
    s_nop 0
    s_or_b64 vcc, vcc, s[54:55]
    v_cmp_eq_u32 s[54:55], s19, v20
    s_nop 0
    s_or_b64 vcc, vcc, s[54:55]
    v_cmp_eq_u32 s[54:55], s19, v21
    s_nop 0
    s_or_b64 vcc, vcc, s[54:55]
    v_cmp_eq_u32 s[54:55], s19, v22
    s_nop 0
    s_or_b64 vcc, vcc, s[54:55]
    v_cmp_eq_u32 s[54:55], s19, v23
    s_nop 0
    s_or_b64 vcc, vcc, s[54:55]
    s_cbranch_vccnz chain_slow_gexact
chain_slow_spok:
    s_cmp_eq_u32 s17, 63
    s_cbranch_scc0 chain_slow_step
    s_waitcnt lgkmcnt(0)
    s_branch chain_last
    s_nop 0
    s_nop 0
    s_nop 0
chain_last:
    v_smfmac_f32_16x16x64_bf16 v[72:75], v[16:19], a[40:47], v48
    v_smfmac_f32_16x16x64_bf16 v[64:67], v[16:19], a[24:31], v48
    v_smfmac_f32_16x16x64_bf16 v[68:71], v[16:19], a[32:39], v48
    s_nop 0
    s_barrier
    ds_read_b128 v[24:27], v4
    ds_read_b128 v[28:31], v4 offset:1024
    ds_read_b128 v[36:39], v5 offset:1024
    v_smfmac_f32_16x16x64_bf16 v[68:71], v[20:23], a[64:71], v48
    ds_read_b128 v[32:35], v5
    ds_read_b128 v[40:43], v6
    v_smfmac_f32_16x16x64_bf16 v[72:75], v[20:23], a[72:79], v48
    s_waitcnt lgkmcnt(4)
    v_smfmac_f32_16x16x64_bf16 v[72:75], v[24:27], a[232:239], v48
    s_waitcnt lgkmcnt(3)
    v_smfmac_f32_16x16x64_bf16 v[72:75], v[28:31], a[248:255], v48
    s_waitcnt lgkmcnt(1)
    v_smfmac_f32_16x16x64_bf16 v[72:75], v[32:35], v[144:151], v48
    v_smfmac_f32_16x16x64_bf16 v[72:75], v[36:39], v[160:167], v48
    ds_read_b128 v[44:47], v6 offset:1024
    v_smfmac_f32_16x16x64_bf16 v[68:71], v[24:27], a[224:231], v48
    v_smfmac_f32_16x16x64_bf16 v[68:71], v[28:31], a[240:247], v48
    v_smfmac_f32_16x16x64_bf16 v[68:71], v[32:35], v[136:143], v48
    v_smfmac_f32_16x16x64_bf16 v[68:71], v[36:39], v[152:159], v48
    s_waitcnt lgkmcnt(1)
    v_smfmac_f32_16x16x64_bf16 v[68:71], v[40:43], v[168:175], v48
    v_smfmac_f32_16x16x64_bf16 v[72:75], v[40:43], v[176:183], v48
    s_waitcnt lgkmcnt(0)
    v_smfmac_f32_16x16x64_bf16 v[72:75], v[44:47], v[192:199], v48
    v_smfmac_f32_16x16x64_bf16 v[68:71], v[44:47], v[184:191], v48
    s_nop 3
    v_cvt_pk_bf16_f32 v127, v74, v75
    v_cvt_pk_bf16_f32 v126, v72, v73
    s_nop 0
    s_nop 0
    v_cvt_pk_bf16_f32 v124, v68, v69
    v_cvt_pk_bf16_f32 v125, v70, v71
    buffer_store_dwordx4 v[124:127], v1, s[8:11], s30 offen offset:1024 sc1
    v_smfmac_f32_16x16x64_bf16 v[60:63], v[16:19], a[16:23], v48
    v_smfmac_f32_16x16x64_bf16 v[64:67], v[20:23], a[56:63], v48
    v_smfmac_f32_16x16x64_bf16 v[64:67], v[24:27], a[136:143], v48
    v_smfmac_f32_16x16x64_bf16 v[64:67], v[28:31], a[152:159], v48
    v_smfmac_f32_16x16x64_bf16 v[64:67], v[32:35], a[168:175], v48
    v_smfmac_f32_16x16x64_bf16 v[64:67], v[36:39], a[184:191], v48
    v_smfmac_f32_16x16x64_bf16 v[64:67], v[40:43], a[200:207], v48
    v_smfmac_f32_16x16x64_bf16 v[60:63], v[20:23], a[48:55], v48
    v_smfmac_f32_16x16x64_bf16 v[60:63], v[24:27], a[128:135], v48
    v_smfmac_f32_16x16x64_bf16 v[60:63], v[28:31], a[144:151], v48
    v_smfmac_f32_16x16x64_bf16 v[64:67], v[44:47], a[216:223], v48
    v_smfmac_f32_16x16x64_bf16 v[60:63], v[32:35], a[160:167], v48
    s_nop 1
    s_nop 1
    v_cvt_pk_bf16_f32 v122, v64, v65
    v_smfmac_f32_16x16x64_bf16 v[60:63], v[36:39], a[176:183], v48
    v_smfmac_f32_16x16x64_bf16 v[60:63], v[40:43], a[192:199], v48
    v_smfmac_f32_16x16x64_bf16 v[60:63], v[44:47], a[208:215], v48
    v_cvt_pk_bf16_f32 v123, v66, v67
    s_nop 2
    s_nop 3
    v_cvt_pk_bf16_f32 v120, v60, v61
    v_mfma_f32_16x16x16_bf16 v[64:67], v[122:123], v[50:51], 0
    v_cvt_pk_bf16_f32 v121, v62, v63
    s_nop 0
    s_nop 0
    v_mfma_f32_16x16x16_bf16 v[60:63], v[120:121], v[50:51], 0
    s_nop 3
    v_cvt_pk_bf16_f32 v122, v64, v65
    s_nop 2
    v_cvt_pk_bf16_f32 v120, v60, v61
    v_cvt_pk_bf16_f32 v121, v62, v63
    v_cvt_pk_bf16_f32 v123, v66, v67
    buffer_store_dwordx4 v[120:123], v1, s[8:11], s30 offen sc1
    ds_read_b128 v[104:107], v2 offset:36864
    s_waitcnt lgkmcnt(0)
    ds_read_b128 v[104:107], v2 offset:39936
    ds_read_b128 v[96:99], v2 offset:35840
    s_waitcnt lgkmcnt(0)
    ds_read_b128 v[96:99], v2 offset:38912
    ds_read_b128 v[92:95], v2 offset:3072
    s_waitcnt lgkmcnt(0)
    ds_read_b128 v[92:95], v2 offset:6144
    ds_read_b128 v[100:103], v2 offset:4096
    s_waitcnt lgkmcnt(0)
    ds_read_b128 v[100:103], v2 offset:7168
    ds_read_b128 v[112:115], v2 offset:37888
    ds_read_b128 v[108:111], v2 offset:5120
    s_waitcnt vmcnt(0)
    s_endpgm
    s_nop 0
    s_nop 0
kv_role:
    v_and_b32 v0, 63, v0
    v_lshlrev_b32 v240, 4, v0
    v_lshrrev_b32 v243, 5, v0
    v_lshlrev_b32 v241, 13, v243
    v_bfe_u32 v243, v0, 3, 2
    v_lshl_add_u32 v241, v243, 10, v241
    v_lshrrev_b32 v243, 3, v0
    v_and_b32 v243, 6, v243
    v_xor_b32 v243, v243, v0
    v_and_b32 v243, 7, v243
    v_lshl_add_u32 v241, v243, 4, v241
    v_and_b32 v244, 15, v0
    v_lshlrev_b32 v244, 7, v244
    v_lshrrev_b32 v243, 4, v0
    v_and_b32 v245, 6, v0
    v_xor_b32 v243, v243, v245
    v_lshl_add_u32 v244, v243, 4, v244
    v_xor_b32 v245, 64, v244
    s_lshl_b32 s20, s16, 21
    s_add_u32 s20, s20, 136314880
    s_lshr_b32 s23, s12, 1
    s_lshl_b32 s23, s23, 12
    s_add_u32 s20, s20, s23
    s_and_b32 s23, s12, 1
    s_lshl_b32 s23, s23, 14
    s_add_u32 s20, s20, s23
    s_lshl_b32 s21, s12, 10
    s_lshl_b32 s23, s12, 1
    s_add_u32 s23, s23, s13
    s_and_b32 s23, s23, 0
    s_lshl_b32 s23, s23, 7
    s_add_u32 s20, s20, s23
    s_lshl_b32 s23, s23, 5
    s_add_u32 s21, s21, s23
    s_mul_i32 s22, s16, 33554432
    s_mul_i32 s23, s13, 16384
    s_add_u32 s22, s22, s23
    s_lshl_b32 s23, s12, 12
    s_add_u32 s22, s22, s23
    s_add_u32 s28, s22, 0
    s_lshr_b32 s32, s22, 1
    s_add_u32 s32, s32, 75497472
    s_lshl_b32 s25, s13, 2
    s_add_u32 s25, s25, s12
    s_lshl_b32 s22, s16, 14
    s_lshl_b32 s23, s25, 7
    s_add_u32 s22, s22, s23
    s_add_u32 s31, s22, 143654912
    v_lshrrev_b32 v26, 4, v0
    v_lshlrev_b32 v17, 2, v26
    v_xor_b32 v17, v17, v0
    v_and_b32_e64 v17, 15, v17
    v_lshlrev_b32 v17, 4, v17
    v_lshl_add_u32 v16, v26, 13, v17
    v_lshl_add_u32 v17, v26, 10, v17
    s_lshl_b32 s40, s13, 8
    s_lshl_b32 s42, s12, 18
    s_add_u32 s40, s40, s42
    s_lshl_b32 s41, s13, 17
    s_lshl_b32 s42, s12, 8
    s_add_u32 s41, s41, s42
    s_lshl_b32 s42, s12, 13
    s_add_u32 s42, s42, 32768
    s_lshl_b32 s39, s12, 15
    s_add_u32 s43, s40, 0
    s_add_u32 m0, s42, 0
    s_nop 0
    buffer_load_dwordx4 v16, s[72:75], s43 offen lds
    s_add_u32 s43, s43, 32768
    s_add_u32 m0, s42, 1024
    s_nop 0
    buffer_load_dwordx4 v16, s[72:75], s43 offen lds
    s_add_u32 s43, s43, 32768
    s_add_u32 m0, s42, 2048
    s_nop 0
    buffer_load_dwordx4 v16, s[72:75], s43 offen lds
    s_add_u32 s43, s43, 32768
    s_add_u32 m0, s42, 3072
    s_nop 0
    buffer_load_dwordx4 v16, s[72:75], s43 offen lds
    s_add_u32 s43, s43, 32768
    s_add_u32 m0, s42, 4096
    s_nop 0
    buffer_load_dwordx4 v16, s[72:75], s43 offen lds
    s_add_u32 s43, s43, 32768
    s_add_u32 m0, s42, 5120
    s_nop 0
    buffer_load_dwordx4 v16, s[72:75], s43 offen lds
    s_add_u32 s43, s43, 32768
    s_add_u32 m0, s42, 6144
    s_nop 0
    buffer_load_dwordx4 v16, s[72:75], s43 offen lds
    s_add_u32 s43, s43, 32768
    s_add_u32 m0, s42, 7168
    s_nop 0
    buffer_load_dwordx4 v16, s[72:75], s43 offen lds
    v_lshrrev_b32 v26, 4, v0
    v_lshlrev_b32_e64 v22, 11, v26
    v_bfe_u32 v26, v0, 2, 2
    v_mul_u32_u24 v26, 320, v26
    v_add_u32 v22, v22, v26
    v_and_b32 v26, 3, v0
    v_lshl_add_u32 v22, v26, 4, v22
    s_lshl_b32 s43, s12, 6
    v_xor_b32 v18, s43, v22
    v_add_u32 v18, 32768, v18
    v_add_u32 v22, s42, v22
    v_xor_b32 v19, 8192, v18
    v_xor_b32 v23, 64, v22
    v_xor_b32 v20, 16384, v18
    v_xor_b32 v24, 128, v22
    v_xor_b32 v21, 24576, v18
    v_xor_b32 v25, 192, v22
    s_waitcnt vmcnt(8)
    v_mov_b32 v3, 0
    s_cmp_lg_u32 s12, 0
    s_cbranch_scc1 rdy_8
    s_mov_b64 exec, 1
    ds_write_b32 v3, v255
    s_mov_b64 exec, -1
    s_waitcnt lgkmcnt(0)
rdy_8:
    s_barrier
    ds_read_b32 v2, v3
    s_waitcnt lgkmcnt(0)
    v_readfirstlane_b32 s22, v2
    s_barrier
    s_bitcmp1_b32 s22, s13
    s_cbranch_scc1 main_late
    v_mov_b32_e64 v243, 0
    buffer_store_dword v243, off, s[8:11], s31 sc1
    s_add_u32 s43, s40, 1048576
    s_add_u32 m0, s42, 32768
    s_nop 0
    buffer_load_dwordx4 v16, s[72:75], s43 offen lds
    s_add_u32 s43, s43, 32768
    s_add_u32 m0, s42, 33792
    s_nop 0
    buffer_load_dwordx4 v16, s[72:75], s43 offen lds
    s_add_u32 s43, s43, 32768
    s_add_u32 m0, s42, 34816
    s_nop 0
    buffer_load_dwordx4 v16, s[72:75], s43 offen lds
    s_add_u32 s43, s43, 32768
    s_add_u32 m0, s42, 35840
    s_nop 0
    buffer_load_dwordx4 v16, s[72:75], s43 offen lds
    s_add_u32 s43, s43, 32768
    s_add_u32 m0, s42, 36864
    s_nop 0
    buffer_load_dwordx4 v16, s[72:75], s43 offen lds
    s_add_u32 s43, s43, 32768
    s_add_u32 m0, s42, 37888
    s_nop 0
    buffer_load_dwordx4 v16, s[72:75], s43 offen lds
    s_add_u32 s43, s43, 32768
    s_add_u32 m0, s42, 38912
    s_nop 0
    buffer_load_dwordx4 v16, s[72:75], s43 offen lds
    s_add_u32 s43, s43, 32768
    s_add_u32 m0, s42, 39936
    s_nop 0
    buffer_load_dwordx4 v16, s[72:75], s43 offen lds
    s_waitcnt vmcnt(8)
    s_barrier
    s_cmp_lg_u32 s12, 0
    s_cbranch_scc1 cnt_9
    s_mov_b64 exec, 1
    s_add_u32 s22, s16, 1
    v_mov_b32 v243, s22
    s_lshl_b32 s22, s16, 3
    buffer_atomic_add v243, off, s[4:7], s22 offset:128
    s_cmp_eq_u32 s16, 0
    s_cbranch_scc1 cnt_9_x
    v_mov_b32_e64 v253, 3
    buffer_store_dword v253, off, s[8:11], s55 sc1
cnt_9_x:
    s_mov_b64 exec, -1
cnt_9:
    s_add_u32 s43, s40, 2097152
    s_add_u32 m0, s42, 65536
    s_nop 0
    buffer_load_dwordx4 v16, s[72:75], s43 offen lds
    s_add_u32 s43, s43, 32768
    s_add_u32 m0, s42, 66560
    s_nop 0
    buffer_load_dwordx4 v16, s[72:75], s43 offen lds
    s_add_u32 s43, s43, 32768
    s_add_u32 m0, s42, 67584
    s_nop 0
    buffer_load_dwordx4 v16, s[72:75], s43 offen lds
    s_add_u32 s43, s43, 32768
    s_add_u32 m0, s42, 68608
    s_nop 0
    buffer_load_dwordx4 v16, s[72:75], s43 offen lds
    s_add_u32 s43, s43, 32768
    s_add_u32 m0, s42, 69632
    s_nop 0
    buffer_load_dwordx4 v16, s[72:75], s43 offen lds
    s_add_u32 s43, s43, 32768
    s_add_u32 m0, s42, 70656
    s_nop 0
    buffer_load_dwordx4 v16, s[72:75], s43 offen lds
    s_add_u32 s43, s43, 32768
    s_add_u32 m0, s42, 71680
    s_nop 0
    buffer_load_dwordx4 v16, s[72:75], s43 offen lds
    s_add_u32 s43, s43, 32768
    s_add_u32 m0, s42, 72704
    s_nop 0
    buffer_load_dwordx4 v16, s[72:75], s43 offen lds
    s_waitcnt vmcnt(16)
    s_barrier
    s_add_u32 s43, s40, 3145728
    s_add_u32 m0, s42, 98304
    s_nop 0
    buffer_load_dwordx4 v16, s[72:75], s43 offen lds
    s_add_u32 s43, s43, 32768
    s_add_u32 m0, s42, 99328
    s_nop 0
    buffer_load_dwordx4 v16, s[72:75], s43 offen lds
    s_add_u32 s43, s43, 32768
    s_add_u32 m0, s42, 100352
    s_nop 0
    buffer_load_dwordx4 v16, s[72:75], s43 offen lds
    s_add_u32 s43, s43, 32768
    s_add_u32 m0, s42, 101376
    s_nop 0
    buffer_load_dwordx4 v16, s[72:75], s43 offen lds
    s_add_u32 s43, s43, 32768
    s_add_u32 m0, s42, 102400
    s_nop 0
    buffer_load_dwordx4 v16, s[72:75], s43 offen lds
    s_add_u32 s43, s43, 32768
    s_add_u32 m0, s42, 103424
    s_nop 0
    buffer_load_dwordx4 v16, s[72:75], s43 offen lds
    s_add_u32 s43, s43, 32768
    s_add_u32 m0, s42, 104448
    s_nop 0
    buffer_load_dwordx4 v16, s[72:75], s43 offen lds
    s_add_u32 s43, s43, 32768
    s_add_u32 m0, s42, 105472
    s_nop 0
    buffer_load_dwordx4 v16, s[72:75], s43 offen lds
    ds_read_b64_tr_b16 a[0:1], v18 offset:0
    ds_read_b64_tr_b16 a[2:3], v18 offset:1024
    ds_read_b64_tr_b16 a[64:65], v18 offset:8
    ds_read_b64_tr_b16 a[66:67], v18 offset:1032
    ds_read_b64_tr_b16 a[4:5], v19 offset:0
    ds_read_b64_tr_b16 a[6:7], v19 offset:1024
    ds_read_b64_tr_b16 a[68:69], v19 offset:8
    ds_read_b64_tr_b16 a[70:71], v19 offset:1032
    ds_read_b64_tr_b16 a[8:9], v20 offset:0
    ds_read_b64_tr_b16 a[10:11], v20 offset:1024
    ds_read_b64_tr_b16 a[72:73], v20 offset:8
    ds_read_b64_tr_b16 a[74:75], v20 offset:1032
    ds_read_b64_tr_b16 a[12:13], v21 offset:0
    ds_read_b64_tr_b16 a[14:15], v21 offset:1024
    ds_read_b64_tr_b16 a[76:77], v21 offset:8
    ds_read_b64_tr_b16 a[78:79], v21 offset:1032
    s_waitcnt lgkmcnt(0)
    s_waitcnt vmcnt(16)
    s_barrier
    s_add_u32 s43, s40, 0
    s_add_u32 m0, s42, 0
    s_nop 0
    buffer_load_dwordx4 v16, s[76:79], s43 offen lds
    s_add_u32 s43, s43, 32768
    s_add_u32 m0, s42, 1024
    s_nop 0
    buffer_load_dwordx4 v16, s[76:79], s43 offen lds
    s_add_u32 s43, s43, 32768
    s_add_u32 m0, s42, 2048
    s_nop 0
    buffer_load_dwordx4 v16, s[76:79], s43 offen lds
    s_add_u32 s43, s43, 32768
    s_add_u32 m0, s42, 3072
    s_nop 0
    buffer_load_dwordx4 v16, s[76:79], s43 offen lds
    s_add_u32 s43, s43, 32768
    s_add_u32 m0, s42, 4096
    s_nop 0
    buffer_load_dwordx4 v16, s[76:79], s43 offen lds
    s_add_u32 s43, s43, 32768
    s_add_u32 m0, s42, 5120
    s_nop 0
    buffer_load_dwordx4 v16, s[76:79], s43 offen lds
    s_add_u32 s43, s43, 32768
    s_add_u32 m0, s42, 6144
    s_nop 0
    buffer_load_dwordx4 v16, s[76:79], s43 offen lds
    s_add_u32 s43, s43, 32768
    s_add_u32 m0, s42, 7168
    s_nop 0
    buffer_load_dwordx4 v16, s[76:79], s43 offen lds
    ds_read_b64_tr_b16 a[16:17], v18 offset:32768
    ds_read_b64_tr_b16 a[18:19], v18 offset:33792
    ds_read_b64_tr_b16 a[80:81], v18 offset:32776
    ds_read_b64_tr_b16 a[82:83], v18 offset:33800
    ds_read_b64_tr_b16 a[20:21], v19 offset:32768
    ds_read_b64_tr_b16 a[22:23], v19 offset:33792
    ds_read_b64_tr_b16 a[84:85], v19 offset:32776
    ds_read_b64_tr_b16 a[86:87], v19 offset:33800
    ds_read_b64_tr_b16 a[24:25], v20 offset:32768
    ds_read_b64_tr_b16 a[26:27], v20 offset:33792
    ds_read_b64_tr_b16 a[88:89], v20 offset:32776
    ds_read_b64_tr_b16 a[90:91], v20 offset:33800
    ds_read_b64_tr_b16 a[28:29], v21 offset:32768
    ds_read_b64_tr_b16 a[30:31], v21 offset:33792
    ds_read_b64_tr_b16 a[92:93], v21 offset:32776
    ds_read_b64_tr_b16 a[94:95], v21 offset:33800
    s_waitcnt lgkmcnt(0)
    s_waitcnt vmcnt(16)
    s_barrier
    s_add_u32 s43, s40, 1048576
    s_add_u32 m0, s42, 32768
    s_nop 0
    buffer_load_dwordx4 v16, s[76:79], s43 offen lds
    s_add_u32 s43, s43, 32768
    s_add_u32 m0, s42, 33792
    s_nop 0
    buffer_load_dwordx4 v16, s[76:79], s43 offen lds
    s_add_u32 s43, s43, 32768
    s_add_u32 m0, s42, 34816
    s_nop 0
    buffer_load_dwordx4 v16, s[76:79], s43 offen lds
    s_add_u32 s43, s43, 32768
    s_add_u32 m0, s42, 35840
    s_nop 0
    buffer_load_dwordx4 v16, s[76:79], s43 offen lds
    s_add_u32 s43, s43, 32768
    s_add_u32 m0, s42, 36864
    s_nop 0
    buffer_load_dwordx4 v16, s[76:79], s43 offen lds
    s_add_u32 s43, s43, 32768
    s_add_u32 m0, s42, 37888
    s_nop 0
    buffer_load_dwordx4 v16, s[76:79], s43 offen lds
    s_add_u32 s43, s43, 32768
    s_add_u32 m0, s42, 38912
    s_nop 0
    buffer_load_dwordx4 v16, s[76:79], s43 offen lds
    s_add_u32 s43, s43, 32768
    s_add_u32 m0, s42, 39936
    s_nop 0
    buffer_load_dwordx4 v16, s[76:79], s43 offen lds
    v_add_u32 v18, 65536, v18
    v_add_u32 v19, 65536, v19
    v_add_u32 v20, 65536, v20
    v_add_u32 v21, 65536, v21
    v_add_u32 v22, 65536, v22
    v_add_u32 v23, 65536, v23
    v_add_u32 v24, 65536, v24
    v_add_u32 v25, 65536, v25
    ds_read_b64_tr_b16 a[32:33], v18 offset:0
    ds_read_b64_tr_b16 a[34:35], v18 offset:1024
    ds_read_b64_tr_b16 a[96:97], v18 offset:8
    ds_read_b64_tr_b16 a[98:99], v18 offset:1032
    ds_read_b64_tr_b16 a[36:37], v19 offset:0
    ds_read_b64_tr_b16 a[38:39], v19 offset:1024
    ds_read_b64_tr_b16 a[100:101], v19 offset:8
    ds_read_b64_tr_b16 a[102:103], v19 offset:1032
    ds_read_b64_tr_b16 a[40:41], v20 offset:0
    ds_read_b64_tr_b16 a[42:43], v20 offset:1024
    ds_read_b64_tr_b16 a[104:105], v20 offset:8
    ds_read_b64_tr_b16 a[106:107], v20 offset:1032
    ds_read_b64_tr_b16 a[44:45], v21 offset:0
    ds_read_b64_tr_b16 a[46:47], v21 offset:1024
    ds_read_b64_tr_b16 a[108:109], v21 offset:8
    ds_read_b64_tr_b16 a[110:111], v21 offset:1032
    s_waitcnt lgkmcnt(0)
    s_waitcnt vmcnt(16)
    s_barrier
    s_add_u32 s43, s40, 2097152
    s_add_u32 m0, s42, 65536
    s_nop 0
    buffer_load_dwordx4 v16, s[76:79], s43 offen lds
    s_add_u32 s43, s43, 32768
    s_add_u32 m0, s42, 66560
    s_nop 0
    buffer_load_dwordx4 v16, s[76:79], s43 offen lds
    s_add_u32 s43, s43, 32768
    s_add_u32 m0, s42, 67584
    s_nop 0
    buffer_load_dwordx4 v16, s[76:79], s43 offen lds
    s_add_u32 s43, s43, 32768
    s_add_u32 m0, s42, 68608
    s_nop 0
    buffer_load_dwordx4 v16, s[76:79], s43 offen lds
    s_add_u32 s43, s43, 32768
    s_add_u32 m0, s42, 69632
    s_nop 0
    buffer_load_dwordx4 v16, s[76:79], s43 offen lds
    s_add_u32 s43, s43, 32768
    s_add_u32 m0, s42, 70656
    s_nop 0
    buffer_load_dwordx4 v16, s[76:79], s43 offen lds
    s_add_u32 s43, s43, 32768
    s_add_u32 m0, s42, 71680
    s_nop 0
    buffer_load_dwordx4 v16, s[76:79], s43 offen lds
    s_add_u32 s43, s43, 32768
    s_add_u32 m0, s42, 72704
    s_nop 0
    buffer_load_dwordx4 v16, s[76:79], s43 offen lds
    ds_read_b64_tr_b16 a[48:49], v18 offset:32768
    ds_read_b64_tr_b16 a[50:51], v18 offset:33792
    ds_read_b64_tr_b16 a[112:113], v18 offset:32776
    ds_read_b64_tr_b16 a[114:115], v18 offset:33800
    ds_read_b64_tr_b16 a[52:53], v19 offset:32768
    ds_read_b64_tr_b16 a[54:55], v19 offset:33792
    ds_read_b64_tr_b16 a[116:117], v19 offset:32776
    ds_read_b64_tr_b16 a[118:119], v19 offset:33800
    ds_read_b64_tr_b16 a[56:57], v20 offset:32768
    ds_read_b64_tr_b16 a[58:59], v20 offset:33792
    ds_read_b64_tr_b16 a[120:121], v20 offset:32776
    ds_read_b64_tr_b16 a[122:123], v20 offset:33800
    ds_read_b64_tr_b16 a[60:61], v21 offset:32768
    ds_read_b64_tr_b16 a[62:63], v21 offset:33792
    ds_read_b64_tr_b16 a[124:125], v21 offset:32776
    ds_read_b64_tr_b16 a[126:127], v21 offset:33800
    s_waitcnt lgkmcnt(0)
    s_waitcnt vmcnt(16)
    s_barrier
    s_add_u32 s43, s40, 3145728
    s_add_u32 m0, s42, 98304
    s_nop 0
    buffer_load_dwordx4 v16, s[76:79], s43 offen lds
    s_add_u32 s43, s43, 32768
    s_add_u32 m0, s42, 99328
    s_nop 0
    buffer_load_dwordx4 v16, s[76:79], s43 offen lds
    s_add_u32 s43, s43, 32768
    s_add_u32 m0, s42, 100352
    s_nop 0
    buffer_load_dwordx4 v16, s[76:79], s43 offen lds
    s_add_u32 s43, s43, 32768
    s_add_u32 m0, s42, 101376
    s_nop 0
    buffer_load_dwordx4 v16, s[76:79], s43 offen lds
    s_add_u32 s43, s43, 32768
    s_add_u32 m0, s42, 102400
    s_nop 0
    buffer_load_dwordx4 v16, s[76:79], s43 offen lds
    s_add_u32 s43, s43, 32768
    s_add_u32 m0, s42, 103424
    s_nop 0
    buffer_load_dwordx4 v16, s[76:79], s43 offen lds
    s_add_u32 s43, s43, 32768
    s_add_u32 m0, s42, 104448
    s_nop 0
    buffer_load_dwordx4 v16, s[76:79], s43 offen lds
    s_add_u32 s43, s43, 32768
    s_add_u32 m0, s42, 105472
    s_nop 0
    buffer_load_dwordx4 v16, s[76:79], s43 offen lds
    v_add_u32 v18, 4294901760, v18
    v_add_u32 v19, 4294901760, v19
    v_add_u32 v20, 4294901760, v20
    v_add_u32 v21, 4294901760, v21
    v_add_u32 v22, 4294901760, v22
    v_add_u32 v23, 4294901760, v23
    v_add_u32 v24, 4294901760, v24
    v_add_u32 v25, 4294901760, v25
    ds_read_b64_tr_b16 a[128:129], v18 offset:0
    ds_read_b64_tr_b16 a[130:131], v18 offset:1024
    ds_read_b64_tr_b16 a[192:193], v18 offset:8
    ds_read_b64_tr_b16 a[194:195], v18 offset:1032
    ds_read_b64_tr_b16 a[132:133], v19 offset:0
    ds_read_b64_tr_b16 a[134:135], v19 offset:1024
    ds_read_b64_tr_b16 a[196:197], v19 offset:8
    ds_read_b64_tr_b16 a[198:199], v19 offset:1032
    ds_read_b64_tr_b16 a[136:137], v20 offset:0
    ds_read_b64_tr_b16 a[138:139], v20 offset:1024
    ds_read_b64_tr_b16 a[200:201], v20 offset:8
    ds_read_b64_tr_b16 a[202:203], v20 offset:1032
    ds_read_b64_tr_b16 a[140:141], v21 offset:0
    ds_read_b64_tr_b16 a[142:143], v21 offset:1024
    ds_read_b64_tr_b16 a[204:205], v21 offset:8
    ds_read_b64_tr_b16 a[206:207], v21 offset:1032
    s_waitcnt lgkmcnt(0)
    s_waitcnt vmcnt(16)
    s_barrier
    ds_read_b64_tr_b16 a[144:145], v18 offset:32768
    ds_read_b64_tr_b16 a[146:147], v18 offset:33792
    ds_read_b64_tr_b16 a[208:209], v18 offset:32776
    ds_read_b64_tr_b16 a[210:211], v18 offset:33800
    ds_read_b64_tr_b16 a[148:149], v19 offset:32768
    ds_read_b64_tr_b16 a[150:151], v19 offset:33792
    ds_read_b64_tr_b16 a[212:213], v19 offset:32776
    ds_read_b64_tr_b16 a[214:215], v19 offset:33800
    ds_read_b64_tr_b16 a[152:153], v20 offset:32768
    ds_read_b64_tr_b16 a[154:155], v20 offset:33792
    ds_read_b64_tr_b16 a[216:217], v20 offset:32776
    ds_read_b64_tr_b16 a[218:219], v20 offset:33800
    ds_read_b64_tr_b16 a[156:157], v21 offset:32768
    ds_read_b64_tr_b16 a[158:159], v21 offset:33792
    ds_read_b64_tr_b16 a[220:221], v21 offset:32776
    ds_read_b64_tr_b16 a[222:223], v21 offset:33800
    s_waitcnt lgkmcnt(0)
    s_waitcnt vmcnt(8)
    s_barrier
    v_add_u32 v18, 65536, v18
    v_add_u32 v19, 65536, v19
    v_add_u32 v20, 65536, v20
    v_add_u32 v21, 65536, v21
    v_add_u32 v22, 65536, v22
    v_add_u32 v23, 65536, v23
    v_add_u32 v24, 65536, v24
    v_add_u32 v25, 65536, v25
    ds_read_b64_tr_b16 a[160:161], v18 offset:0
    ds_read_b64_tr_b16 a[162:163], v18 offset:1024
    ds_read_b64_tr_b16 a[224:225], v18 offset:8
    ds_read_b64_tr_b16 a[226:227], v18 offset:1032
    ds_read_b64_tr_b16 a[164:165], v19 offset:0
    ds_read_b64_tr_b16 a[166:167], v19 offset:1024
    ds_read_b64_tr_b16 a[228:229], v19 offset:8
    ds_read_b64_tr_b16 a[230:231], v19 offset:1032
    ds_read_b64_tr_b16 a[168:169], v20 offset:0
    ds_read_b64_tr_b16 a[170:171], v20 offset:1024
    ds_read_b64_tr_b16 a[232:233], v20 offset:8
    ds_read_b64_tr_b16 a[234:235], v20 offset:1032
    ds_read_b64_tr_b16 a[172:173], v21 offset:0
    ds_read_b64_tr_b16 a[174:175], v21 offset:1024
    ds_read_b64_tr_b16 a[236:237], v21 offset:8
    ds_read_b64_tr_b16 a[238:239], v21 offset:1032
    s_waitcnt lgkmcnt(0)
    s_waitcnt vmcnt(0)
    s_barrier
    ds_read_b64_tr_b16 a[176:177], v18 offset:32768
    ds_read_b64_tr_b16 a[178:179], v18 offset:33792
    ds_read_b64_tr_b16 a[240:241], v18 offset:32776
    ds_read_b64_tr_b16 a[242:243], v18 offset:33800
    ds_read_b64_tr_b16 a[180:181], v19 offset:32768
    ds_read_b64_tr_b16 a[182:183], v19 offset:33792
    ds_read_b64_tr_b16 a[244:245], v19 offset:32776
    ds_read_b64_tr_b16 a[246:247], v19 offset:33800
    ds_read_b64_tr_b16 a[184:185], v20 offset:32768
    ds_read_b64_tr_b16 a[186:187], v20 offset:33792
    ds_read_b64_tr_b16 a[248:249], v20 offset:32776
    ds_read_b64_tr_b16 a[250:251], v20 offset:33800
    ds_read_b64_tr_b16 a[188:189], v21 offset:32768
    ds_read_b64_tr_b16 a[190:191], v21 offset:33792
    ds_read_b64_tr_b16 a[252:253], v21 offset:32776
    ds_read_b64_tr_b16 a[254:255], v21 offset:33800
    s_waitcnt lgkmcnt(0)
    s_barrier
    s_mul_i32 s23, s16, 0
wr_10:
    buffer_load_dwordx4 v[16:19], off, s[4:7], s23 offset:128 sc1
    s_waitcnt vmcnt(0)
    s_cmp_eq_u32 s16, 0
    s_cselect_b64 vcc, -1, 0
    v_cndmask_b32 v18, v18, v19, vcc
    v_min_u32_e64 v16, v16, v18
    v_cmp_gt_u32 vcc, 0x80, v16
    s_cbranch_vccz wr_11
    s_sub_u32 s3, s3, 1
    s_cbranch_scc1 main_timeout
    s_sleep 4
    s_branch wr_10
    s_nop 0
    s_nop 0
    s_nop 0
wr_11:
    buffer_load_dword v17, off, s[4:7], 0 offset:132 sc1
    s_waitcnt vmcnt(0)
wr_12:
    v_readfirstlane_b32 s22, v17
    s_nop 0
    s_bitcmp0_b32 s22, s14
    s_cselect_b32 s15, 1, 0
    s_cmp_eq_u32 s16, 0
    s_cselect_b32 s23, 1, 4
    s_lshl_b32 s23, s23, 12
    v_lshlrev_b32 v11, 7, v0
    v_or_b32 v11, s23, v11
    s_mov_b32 s17, 0
    s_mov_b32 s29, 0x7fff0000
    s_mov_b32 s54, 14
    v_mov_b32 v247, 0x8c00
    v_mov_b32_e64 v248, s19
    v_mov_b32_e64 v249, s19
    v_mov_b32_e64 v250, s19
    v_mov_b32 v251, s19
    s_mov_b32 s22, 143802368
wa_13:
    buffer_load_dword v12, v11, s[8:11], s22 offen sc1
    s_waitcnt vmcnt(0)
    v_cmp_gt_u32_e64 vcc, 2, v12
    s_cbranch_vccz wa_14
    s_sub_u32 s3, s3, 1
    s_cbranch_scc1 main_timeout
    s_sleep 1
    s_branch wa_13
    s_nop 0
    s_nop 0
wa_14:
    s_cmp_lg_u32 s16, 0
    s_cbranch_scc1 kv_try
    s_add_u32 m0, s21, 0
    s_nop 0
    buffer_load_dwordx4 v241, s[8:11], s20 offen offset:0 sc1 lds
    s_add_u32 m0, s21, 3968
    s_nop 0
    buffer_load_dwordx4 v241, s[8:11], s20 offen offset:128 sc1 lds
    s_add_u32 m0, s21, 7936
    s_nop 0
    buffer_load_dwordx4 v241, s[8:11], s20 offen offset:256 sc1 lds
    s_add_u32 m0, s21, 11904
    s_nop 0
    buffer_load_dwordx4 v241, s[8:11], s20 offen offset:384 sc1 lds
    s_add_u32 m0, s21, 15872
    s_nop 0
    buffer_load_dwordx4 v241, s[8:11], s20 offen offset:512 sc1 lds
    s_add_u32 m0, s21, 19840
    s_nop 0
    buffer_load_dwordx4 v241, s[8:11], s20 offen offset:640 sc1 lds
    s_add_u32 m0, s21, 23808
    s_nop 0
    buffer_load_dwordx4 v241, s[8:11], s20 offen offset:768 sc1 lds
    s_add_u32 m0, s21, 27776
    s_nop 0
    buffer_load_dwordx4 v241, s[8:11], s20 offen offset:896 sc1 lds
    s_waitcnt vmcnt(0)
kv_loop0:
    s_barrier
    ds_read_b128 v[80:83], v244 offset:0
    ds_read_b128 v[84:87], v244 offset:2048
    ds_read_b128 v[88:91], v245 offset:0
    s_xor_b32 s21, s21, 32768
    ds_read_b128 v[92:95], v245 offset:2048
    s_add_u32 s20, s20, 32768
    s_add_u32 m0, s21, 0
    s_nop 0
    buffer_load_dwordx4 v241, s[8:11], s20 offen offset:0 sc1 lds
    ds_read_b128 v[104:107], v245 offset:4096
    ds_read_b128 v[100:103], v244 offset:6144
    s_add_u32 m0, s21, 3968
    s_nop 0
    buffer_load_dwordx4 v241, s[8:11], s20 offen offset:128 sc1 lds
    s_waitcnt lgkmcnt(5)
    v_mfma_f32_16x16x32_bf16 v[32:35], a[0:3], v[80:83], 0
    ds_read_b128 v[96:99], v244 offset:4096
    s_waitcnt lgkmcnt(5)
    v_mfma_f32_16x16x32_bf16 v[44:47], a[64:67], v[84:87], 0
    s_add_u32 m0, s21, 7936
    s_nop 0
    buffer_load_dwordx4 v241, s[8:11], s20 offen offset:256 sc1 lds
    v_mfma_f32_16x16x32_bf16 v[40:43], a[0:3], v[84:87], 0
    ds_read_b128 v[84:87], v244 offset:10240
    v_mfma_f32_16x16x32_bf16 v[36:39], a[64:67], v[80:83], 0
    s_waitcnt lgkmcnt(5)
    v_mfma_f32_16x16x32_bf16 v[32:35], a[4:7], v[88:91], v[32:35]
    ds_read_b128 v[80:83], v244 offset:8192
    v_mfma_f32_16x16x32_bf16 v[36:39], a[68:71], v[88:91], v[36:39]
    s_waitcnt lgkmcnt(5)
    v_mfma_f32_16x16x32_bf16 v[44:47], a[68:71], v[92:95], v[44:47]
    ds_read_b128 v[88:91], v245 offset:8192
    s_waitcnt lgkmcnt(3)
    v_mfma_f32_16x16x32_bf16 v[36:39], a[72:75], v[96:99], v[36:39]
    s_nop 0
    v_mfma_f32_16x16x32_bf16 v[40:43], a[4:7], v[92:95], v[40:43]
    ds_read_b128 v[92:95], v245 offset:10240
    v_mfma_f32_16x16x32_bf16 v[32:35], a[8:11], v[96:99], v[32:35]
    ds_read_b128 v[108:111], v245 offset:6144
    v_mfma_f32_16x16x32_bf16 v[32:35], a[12:15], v[104:107], v[32:35]
    s_waitcnt lgkmcnt(3)
    v_mfma_f32_16x16x32_bf16 v[32:35], a[16:19], v[80:83], v[32:35]
    v_mfma_f32_16x16x32_bf16 v[36:39], a[76:79], v[104:107], v[36:39]
    ds_read_b128 v[104:107], v245 offset:12288
    v_mfma_f32_16x16x32_bf16 v[44:47], a[72:75], v[100:103], v[44:47]
    s_add_u32 m0, s21, 11904
    s_nop 0
    buffer_load_dwordx4 v241, s[8:11], s20 offen offset:384 sc1 lds
    v_mfma_f32_16x16x32_bf16 v[40:43], a[8:11], v[100:103], v[40:43]
    ds_read_b128 v[100:103], v244 offset:14336
    s_waitcnt lgkmcnt(2)
    v_mfma_f32_16x16x32_bf16 v[44:47], a[76:79], v[108:111], v[44:47]
    v_mfma_f32_16x16x32_bf16 v[44:47], a[80:83], v[84:87], v[44:47]
    s_add_u32 m0, s21, 15872
    s_nop 0
    buffer_load_dwordx4 v241, s[8:11], s20 offen offset:512 sc1 lds
    v_mfma_f32_16x16x32_bf16 v[40:43], a[12:15], v[108:111], v[40:43]
    ds_read_b128 v[108:111], v245 offset:14336
    v_mfma_f32_16x16x32_bf16 v[40:43], a[16:19], v[84:87], v[40:43]
    ds_read_b128 v[84:87], v244 offset:18432
    v_mov_b32_e64 v2, s17
    v_mfma_f32_16x16x32_bf16 v[44:47], a[84:87], v[92:95], v[44:47]
    ds_read_b128 v[96:99], v244 offset:12288
    v_mfma_f32_16x16x32_bf16 v[40:43], a[20:23], v[92:95], v[40:43]
    ds_read_b128 v[92:95], v245 offset:18432
    v_mfma_f32_16x16x32_bf16 v[36:39], a[80:83], v[80:83], v[36:39]
    ds_read_b128 v[80:83], v244 offset:16384
    s_waitcnt lgkmcnt(5)
    v_mfma_f32_16x16x32_bf16 v[44:47], a[88:91], v[100:103], v[44:47]
    s_waitcnt lgkmcnt(4)
    v_mfma_f32_16x16x32_bf16 v[44:47], a[92:95], v[108:111], v[44:47]
    s_add_u32 m0, s21, 19840
    s_nop 0
    buffer_load_dwordx4 v241, s[8:11], s20 offen offset:640 sc1 lds
    v_mfma_f32_16x16x32_bf16 v[40:43], a[24:27], v[100:103], v[40:43]
    v_mfma_f32_16x16x32_bf16 v[40:43], a[28:31], v[108:111], v[40:43]
    ds_read_b128 v[108:111], v245 offset:22528
    v_mfma_f32_16x16x32_bf16 v[36:39], a[84:87], v[88:91], v[36:39]
    v_mfma_f32_16x16x32_bf16 v[32:35], a[20:23], v[88:91], v[32:35]
    ds_read_b128 v[88:91], v245 offset:16384
    s_waitcnt lgkmcnt(4)
    v_mfma_f32_16x16x32_bf16 v[32:35], a[24:27], v[96:99], v[32:35]
    v_mfma_f32_16x16x32_bf16 v[36:39], a[88:91], v[96:99], v[36:39]
    ds_read_b128 v[96:99], v244 offset:20480
    v_mfma_f32_16x16x32_bf16 v[32:35], a[28:31], v[104:107], v[32:35]
    ds_read_b128 v[100:103], v244 offset:22528
    v_mfma_f32_16x16x32_bf16 v[40:43], a[32:35], v[84:87], v[40:43]
    s_waitcnt lgkmcnt(4)
    v_mfma_f32_16x16x32_bf16 v[32:35], a[32:35], v[80:83], v[32:35]
    v_mfma_f32_16x16x32_bf16 v[40:43], a[36:39], v[92:95], v[40:43]
    s_add_u32 m0, s21, 23808
    s_nop 0
    buffer_load_dwordx4 v241, s[8:11], s20 offen offset:768 sc1 lds
    v_mfma_f32_16x16x32_bf16 v[36:39], a[92:95], v[104:107], v[36:39]
    ds_read_b128 v[104:107], v245 offset:20480
    v_mfma_f32_16x16x32_bf16 v[36:39], a[96:99], v[80:83], v[36:39]
    ds_read_b128 v[80:83], v244 offset:24576
    v_mfma_f32_16x16x32_bf16 v[44:47], a[96:99], v[84:87], v[44:47]
    ds_read_b128 v[84:87], v244 offset:26624
    s_waitcnt lgkmcnt(5)
    v_mfma_f32_16x16x32_bf16 v[36:39], a[100:103], v[88:91], v[36:39]
    v_mfma_f32_16x16x32_bf16 v[32:35], a[36:39], v[88:91], v[32:35]
    ds_read_b128 v[88:91], v245 offset:24576
    s_waitcnt lgkmcnt(5)
    v_mfma_f32_16x16x32_bf16 v[36:39], a[104:107], v[96:99], v[36:39]
    s_add_u32 m0, s21, 27776
    s_nop 0
    buffer_load_dwordx4 v241, s[8:11], s20 offen offset:896 sc1 lds
    v_mfma_f32_16x16x32_bf16 v[44:47], a[100:103], v[92:95], v[44:47]
    ds_read_b128 v[92:95], v245 offset:26624
    s_waitcnt lgkmcnt(5)
    v_mfma_f32_16x16x32_bf16 v[40:43], a[40:43], v[100:103], v[40:43]
    s_waitcnt vmcnt(8)
    buffer_store_dword v2, off, s[8:11], s29 sc1
    v_mfma_f32_16x16x32_bf16 v[40:43], a[44:47], v[108:111], v[40:43]
    s_nop 0
    v_mfma_f32_16x16x32_bf16 v[32:35], a[40:43], v[96:99], v[32:35]
    s_waitcnt lgkmcnt(4)
    v_mfma_f32_16x16x32_bf16 v[32:35], a[44:47], v[104:107], v[32:35]
    s_mov_b32 s29, s31
    ds_read_b128 v[96:99], v244 offset:28672
    v_mfma_f32_16x16x32_bf16 v[44:47], a[104:107], v[100:103], v[44:47]
    ds_read_b128 v[100:103], v244 offset:30720
    s_waitcnt lgkmcnt(5)
    v_mfma_f32_16x16x32_bf16 v[32:35], a[48:51], v[80:83], v[32:35]
    s_waitcnt lgkmcnt(3)
    v_mfma_f32_16x16x32_bf16 v[32:35], a[52:55], v[88:91], v[32:35]
    v_mfma_f32_16x16x32_bf16 v[36:39], a[108:111], v[104:107], v[36:39]
    ds_read_b128 v[104:107], v245 offset:28672
    v_mfma_f32_16x16x32_bf16 v[44:47], a[108:111], v[108:111], v[44:47]
    buffer_store_dwordx4 v[248:251], v240, s[8:11], s32 offen offset:0 sc1
    v_mfma_f32_16x16x32_bf16 v[36:39], a[112:115], v[80:83], v[36:39]
    ds_read_b128 v[108:111], v245 offset:30720
    v_mfma_f32_16x16x32_bf16 v[44:47], a[112:115], v[84:87], v[44:47]
    v_mfma_f32_16x16x32_bf16 v[40:43], a[48:51], v[84:87], v[40:43]
    ds_read_b128 v[84:87], v244 offset:2048
    s_waitcnt lgkmcnt(4)
    v_mfma_f32_16x16x32_bf16 v[32:35], a[56:59], v[96:99], v[32:35]
    v_mfma_f32_16x16x32_bf16 v[36:39], a[116:119], v[88:91], v[36:39]
    ds_read_b128 v[88:91], v245 offset:0
    v_mfma_f32_16x16x32_bf16 v[44:47], a[116:119], v[92:95], v[44:47]
    s_waitcnt lgkmcnt(3)
    v_mfma_f32_16x16x32_bf16 v[32:35], a[60:63], v[104:107], v[32:35]
    ds_read_b128 v[80:83], v244 offset:0
    v_mfma_f32_16x16x32_bf16 v[40:43], a[52:55], v[92:95], v[40:43]
    buffer_store_dwordx4 v[248:251], v240, s[8:11], s32 offen offset:1024 sc1
    v_mfma_f32_16x16x32_bf16 v[40:43], a[56:59], v[100:103], v[40:43]
    ds_read_b128 v[92:95], v245 offset:2048
    v_mfma_f32_16x16x32_bf16 v[44:47], a[120:123], v[100:103], v[44:47]
    ds_read_b128 v[100:103], v244 offset:6144
    v_mfma_f32_16x16x32_bf16 v[36:39], a[120:123], v[96:99], v[36:39]
    ds_read_b128 v[96:99], v244 offset:4096
    s_waitcnt lgkmcnt(6)
    v_mfma_f32_16x16x32_bf16 v[44:47], a[124:127], v[108:111], v[44:47]
    s_nop 0
    v_mfma_f32_16x16x32_bf16 v[36:39], a[124:127], v[104:107], v[36:39]
    ds_read_b128 v[104:107], v245 offset:4096
    v_mfma_f32_16x16x32_bf16 v[40:43], a[60:63], v[108:111], v[40:43]
    s_waitcnt lgkmcnt(4)
    v_mfma_f32_16x16x32_bf16 v[56:59], v[80:83], a[192:195], 0
    s_nop 0
    v_cvt_pk_bf16_f32 v67, v38, v39
    v_cvt_pk_bf16_f32 v70, v44, v45
    v_mfma_f32_16x16x32_bf16 v[48:51], v[80:83], a[128:131], 0
    ds_read_b128 v[80:83], v244 offset:8192
    v_cvt_pk_bf16_f32 v64, v32, v33
    v_mfma_f32_16x16x32_bf16 v[48:51], v[88:91], a[132:135], v[48:51]
    s_waitcnt lgkmcnt(2)
    v_mfma_f32_16x16x32_bf16 v[48:51], v[96:99], a[136:139], v[48:51]
    s_nop 0
    v_cvt_pk_bf16_f32 v69, v42, v43
    v_mfma_f32_16x16x32_bf16 v[56:59], v[88:91], a[196:199], v[56:59]
    ds_read_b128 v[88:91], v245 offset:8192
    v_cvt_pk_bf16_f32 v65, v34, v35
    v_mfma_f32_16x16x32_bf16 v[56:59], v[96:99], a[200:203], v[56:59]
    ds_read_b128 v[96:99], v244 offset:12288
    v_mfma_f32_16x16x32_bf16 v[52:55], v[84:87], a[128:131], 0
    ds_read_b128 v[108:111], v245 offset:6144
    v_mfma_f32_16x16x32_bf16 v[60:63], v[84:87], a[192:195], 0
    ds_read_b128 v[84:87], v244 offset:10240
    s_waitcnt lgkmcnt(5)
    v_mfma_f32_16x16x32_bf16 v[48:51], v[104:107], a[140:143], v[48:51]
    s_nop 0
    v_cvt_pk_bf16_f32 v68, v40, v41
    s_waitcnt lgkmcnt(4)
    v_mfma_f32_16x16x32_bf16 v[48:51], v[80:83], a[144:147], v[48:51]
    v_cvt_pk_bf16_f32 v66, v36, v37
    s_waitcnt lgkmcnt(3)
    v_mfma_f32_16x16x32_bf16 v[48:51], v[88:91], a[148:151], v[48:51]
    s_nop 0
    v_cvt_pk_bf16_f32 v71, v46, v47
    s_waitcnt lgkmcnt(2)
    v_mfma_f32_16x16x32_bf16 v[48:51], v[96:99], a[152:155], v[48:51]
    buffer_store_dwordx4 v[64:67], v240, s[8:11], s28 offen offset:0 sc1
    v_mfma_f32_16x16x32_bf16 v[56:59], v[104:107], a[204:207], v[56:59]
    ds_read_b128 v[104:107], v245 offset:12288
    v_mfma_f32_16x16x32_bf16 v[56:59], v[80:83], a[208:211], v[56:59]
    buffer_store_dwordx4 v[68:71], v240, s[8:11], s28 offen offset:1024 sc1
    v_mfma_f32_16x16x32_bf16 v[56:59], v[88:91], a[212:215], v[56:59]
    v_mfma_f32_16x16x32_bf16 v[60:63], v[92:95], a[196:199], v[60:63]
    ds_read_b128 v[80:83], v244 offset:16384
    v_mfma_f32_16x16x32_bf16 v[60:63], v[100:103], a[200:203], v[60:63]
    v_mfma_f32_16x16x32_bf16 v[52:55], v[92:95], a[132:135], v[52:55]
    ds_read_b128 v[92:95], v245 offset:10240
    v_mfma_f32_16x16x32_bf16 v[52:55], v[100:103], a[136:139], v[52:55]
    ds_read_b128 v[100:103], v244 offset:14336
    s_waitcnt lgkmcnt(3)
    v_mfma_f32_16x16x32_bf16 v[48:51], v[104:107], a[156:159], v[48:51]
    v_mfma_f32_16x16x32_bf16 v[52:55], v[108:111], a[140:143], v[52:55]
    v_mfma_f32_16x16x32_bf16 v[60:63], v[108:111], a[204:207], v[60:63]
    v_mfma_f32_16x16x32_bf16 v[56:59], v[96:99], a[216:219], v[56:59]
    ds_read_b128 v[108:111], v245 offset:14336
    v_mfma_f32_16x16x32_bf16 v[52:55], v[84:87], a[144:147], v[52:55]
    s_waitcnt lgkmcnt(2)
    v_mfma_f32_16x16x32_bf16 v[52:55], v[92:95], a[148:151], v[52:55]
    v_mfma_f32_16x16x32_bf16 v[60:63], v[84:87], a[208:211], v[60:63]
    ds_read_b128 v[84:87], v244 offset:18432
    v_mfma_f32_16x16x32_bf16 v[48:51], v[80:83], a[160:163], v[48:51]
    ds_read_b128 v[88:91], v245 offset:16384
    s_waitcnt lgkmcnt(3)
    v_mfma_f32_16x16x32_bf16 v[52:55], v[100:103], a[152:155], v[52:55]
    v_mfma_f32_16x16x32_bf16 v[60:63], v[92:95], a[212:215], v[60:63]
    v_mfma_f32_16x16x32_bf16 v[60:63], v[100:103], a[216:219], v[60:63]
    ds_read_b128 v[92:95], v245 offset:18432
    s_waitcnt lgkmcnt(3)
    v_mfma_f32_16x16x32_bf16 v[52:55], v[108:111], a[156:159], v[52:55]
    ds_read_b128 v[100:103], v244 offset:22528
    s_waitcnt lgkmcnt(3)
    v_mfma_f32_16x16x32_bf16 v[52:55], v[84:87], a[160:163], v[52:55]
    ds_read_b128 v[96:99], v244 offset:20480
    v_mfma_f32_16x16x32_bf16 v[56:59], v[104:107], a[220:223], v[56:59]
    s_nop 0
    v_mfma_f32_16x16x32_bf16 v[56:59], v[80:83], a[224:227], v[56:59]
    s_waitcnt lgkmcnt(3)
    v_mfma_f32_16x16x32_bf16 v[56:59], v[88:91], a[228:231], v[56:59]
    s_nop 0
    v_mfma_f32_16x16x32_bf16 v[48:51], v[88:91], a[164:167], v[48:51]
    ds_read_b128 v[88:91], v245 offset:24576
    v_mfma_f32_16x16x32_bf16 v[60:63], v[108:111], a[220:223], v[60:63]
    v_mfma_f32_16x16x32_bf16 v[60:63], v[84:87], a[224:227], v[60:63]
    ds_read_b128 v[104:107], v245 offset:20480
    s_waitcnt lgkmcnt(2)
    v_mfma_f32_16x16x32_bf16 v[48:51], v[96:99], a[168:171], v[48:51]
    ds_read_b128 v[108:111], v245 offset:22528
    v_mfma_f32_16x16x32_bf16 v[56:59], v[96:99], a[232:235], v[56:59]
    s_nop 0
    v_mfma_f32_16x16x32_bf16 v[60:63], v[92:95], a[228:231], v[60:63]
    ds_read_b128 v[84:87], v244 offset:26624
    v_mfma_f32_16x16x32_bf16 v[52:55], v[92:95], a[164:167], v[52:55]
    ds_read_b128 v[92:95], v245 offset:26624
    v_mfma_f32_16x16x32_bf16 v[60:63], v[100:103], a[232:235], v[60:63]
    ds_read_b128 v[80:83], v244 offset:24576
    v_mfma_f32_16x16x32_bf16 v[52:55], v[100:103], a[168:171], v[52:55]
    ds_read_b128 v[100:103], v244 offset:30720
    s_waitcnt lgkmcnt(5)
    v_mfma_f32_16x16x32_bf16 v[48:51], v[104:107], a[172:175], v[48:51]
    v_mfma_f32_16x16x32_bf16 v[56:59], v[104:107], a[236:239], v[56:59]
    ds_read_b128 v[104:107], v245 offset:28672
    s_waitcnt lgkmcnt(5)
    v_mfma_f32_16x16x32_bf16 v[60:63], v[108:111], a[236:239], v[60:63]
    s_add_u32 s17, s17, 1
    v_mfma_f32_16x16x32_bf16 v[52:55], v[108:111], a[172:175], v[52:55]
    ds_read_b128 v[108:111], v245 offset:30720
    s_waitcnt lgkmcnt(5)
    v_mfma_f32_16x16x32_bf16 v[52:55], v[84:87], a[176:179], v[52:55]
    ds_read_b128 v[96:99], v244 offset:28672
    s_waitcnt lgkmcnt(4)
    v_mfma_f32_16x16x32_bf16 v[48:51], v[80:83], a[176:179], v[48:51]
    s_nop 0
    v_mfma_f32_16x16x32_bf16 v[60:63], v[84:87], a[240:243], v[60:63]
    v_mfma_f32_16x16x32_bf16 v[52:55], v[92:95], a[180:183], v[52:55]
    v_mfma_f32_16x16x32_bf16 v[48:51], v[88:91], a[180:183], v[48:51]
    v_xor_b32 v245, 32768, v245
    v_mfma_f32_16x16x32_bf16 v[56:59], v[80:83], a[240:243], v[56:59]
    s_waitcnt lgkmcnt(0)
    v_mfma_f32_16x16x32_bf16 v[48:51], v[96:99], a[184:187], v[48:51]
    v_mfma_f32_16x16x32_bf16 v[48:51], v[104:107], a[188:191], v[48:51]
    s_nop 0
    v_mfma_f32_16x16x32_bf16 v[52:55], v[100:103], a[184:187], v[52:55]
    v_mfma_f32_16x16x32_bf16 v[52:55], v[108:111], a[188:191], v[52:55]
    v_cvt_pk_bf16_f32 v72, v48, v49
    v_mfma_f32_16x16x32_bf16 v[56:59], v[88:91], a[244:247], v[56:59]
    v_mfma_f32_16x16x32_bf16 v[56:59], v[96:99], a[248:251], v[56:59]
    s_add_u32 s32, s32, 262144
    v_cvt_pk_bf16_f32 v74, v52, v53
    v_xor_b32 v244, 32768, v244
    v_mfma_f32_16x16x32_bf16 v[60:63], v[92:95], a[244:247], v[60:63]
    v_mfma_f32_16x16x32_bf16 v[60:63], v[100:103], a[248:251], v[60:63]
    v_cvt_pk_bf16_f32 v73, v50, v51
    v_cvt_pk_bf16_f32 v75, v54, v55
    v_mfma_f32_16x16x32_bf16 v[60:63], v[108:111], a[252:255], v[60:63]
    buffer_store_dwordx4 v[72:75], v240, s[8:11], s28 offen offset:2048 sc1
    v_mfma_f32_16x16x32_bf16 v[56:59], v[104:107], a[252:255], v[56:59]
    s_nop 1
    s_nop 1
    v_cvt_pk_bf16_f32 v79, v62, v63
    v_cvt_pk_bf16_f32 v78, v60, v61
    s_nop 0
    s_nop 0
    v_cvt_pk_bf16_f32 v76, v56, v57
    v_cvt_pk_bf16_f32 v77, v58, v59
    buffer_store_dwordx4 v[76:79], v240, s[8:11], s28 offen offset:3072 sc1
    s_add_u32 s28, s28, 524288
    s_waitcnt vmcnt(7)
    s_cmp_lg_u32 s17, s54
    s_cbranch_scc1 kv_loop0
    s_cmp_eq_u32 s54, 64
    s_cbranch_scc1 kv_end
    s_cmp_eq_u32 s54, 14
    s_cselect_b32 s23, 4, 2
    s_cselect_b32 s35, 2, 3
    s_cselect_b32 s54, 30, 64
    s_lshl_b32 s23, s23, 12
    v_lshlrev_b32 v11, 7, v0
    v_add_u32 v11, s23, v11
    s_mov_b32 s22, 143802368
wa_15:
    buffer_load_dword v12, v11, s[8:11], s22 offen sc1
    s_waitcnt vmcnt(0)
    v_cmp_gt_u32 vcc, s35, v12
    s_cbranch_vccz wa_16
    s_sub_u32 s3, s3, 1
    s_cbranch_scc1 main_timeout
    s_sleep 1
    s_branch wa_15
    s_nop 0
    s_nop 0
    s_nop 0
wa_16:
    s_branch kv_loop0
    s_nop 0
    s_nop 0
    s_nop 0
    s_nop 0
kv_loop1:
    s_barrier
    ds_read_b128 v[96:99], v244 offset:4096
    ds_read_b128 v[80:83], v244 offset:0
    ds_read_b128 v[88:91], v245 offset:0
    buffer_store_dwordx4 v[248:251], v240, s[8:11], s32 offen offset:0 sc1
    buffer_store_dwordx4 v[248:251], v240, s[8:11], s32 offen offset:1024 sc1
    s_waitcnt lgkmcnt(1)
    v_mfma_f32_16x16x32_bf16 v[36:39], a[64:67], v[80:83], 0
    ds_read_b128 v[104:107], v245 offset:4096
    s_add_u32 s20, s20, 32768
    v_mfma_f32_16x16x32_bf16 v[32:35], a[0:3], v[80:83], 0
    ds_read_b128 v[80:83], v244 offset:8192
    s_waitcnt lgkmcnt(2)
    v_mfma_f32_16x16x32_bf16 v[32:35], a[4:7], v[88:91], v[32:35]
    ds_read_b128 v[108:111], v245 offset:6144
    v_mfma_f32_16x16x32_bf16 v[32:35], a[8:11], v[96:99], v[32:35]
    ds_read_b128 v[84:87], v244 offset:2048
    v_mfma_f32_16x16x32_bf16 v[36:39], a[68:71], v[88:91], v[36:39]
    ds_read_b128 v[88:91], v245 offset:8192
    v_mfma_f32_16x16x32_bf16 v[36:39], a[72:75], v[96:99], v[36:39]
    s_waitcnt lgkmcnt(4)
    v_mfma_f32_16x16x32_bf16 v[32:35], a[12:15], v[104:107], v[32:35]
    ds_read_b128 v[96:99], v244 offset:12288
    s_waitcnt lgkmcnt(4)
    v_mfma_f32_16x16x32_bf16 v[32:35], a[16:19], v[80:83], v[32:35]
    s_xor_b32 s21, s21, 32768
    ds_read_b128 v[92:95], v245 offset:2048
    v_mfma_f32_16x16x32_bf16 v[36:39], a[76:79], v[104:107], v[36:39]
    ds_read_b128 v[104:107], v245 offset:12288
    s_waitcnt lgkmcnt(4)
    v_mfma_f32_16x16x32_bf16 v[40:43], a[0:3], v[84:87], 0
    s_waitcnt lgkmcnt(3)
    v_mfma_f32_16x16x32_bf16 v[32:35], a[20:23], v[88:91], v[32:35]
    v_mfma_f32_16x16x32_bf16 v[36:39], a[80:83], v[80:83], v[36:39]
    ds_read_b128 v[100:103], v244 offset:6144
    v_mfma_f32_16x16x32_bf16 v[36:39], a[84:87], v[88:91], v[36:39]
    ds_read_b128 v[88:91], v245 offset:16384
    s_waitcnt lgkmcnt(4)
    v_mfma_f32_16x16x32_bf16 v[32:35], a[24:27], v[96:99], v[32:35]
    s_nop 0
    v_mfma_f32_16x16x32_bf16 v[36:39], a[88:91], v[96:99], v[36:39]
    ds_read_b128 v[96:99], v244 offset:20480
    v_mfma_f32_16x16x32_bf16 v[44:47], a[64:67], v[84:87], 0
    s_waitcnt lgkmcnt(4)
    v_mfma_f32_16x16x32_bf16 v[44:47], a[68:71], v[92:95], v[44:47]
    s_waitcnt lgkmcnt(3)
    v_mfma_f32_16x16x32_bf16 v[36:39], a[92:95], v[104:107], v[36:39]
    ds_read_b128 v[84:87], v244 offset:10240
    v_mfma_f32_16x16x32_bf16 v[40:43], a[4:7], v[92:95], v[40:43]
    ds_read_b128 v[92:95], v245 offset:10240
    v_mfma_f32_16x16x32_bf16 v[32:35], a[28:31], v[104:107], v[32:35]
    s_waitcnt lgkmcnt(4)
    v_mfma_f32_16x16x32_bf16 v[40:43], a[8:11], v[100:103], v[40:43]
    v_mfma_f32_16x16x32_bf16 v[40:43], a[12:15], v[108:111], v[40:43]
    s_nop 0
    v_mov_b32_e64 v2, s17
    v_mfma_f32_16x16x32_bf16 v[44:47], a[72:75], v[100:103], v[44:47]
    ds_read_b128 v[100:103], v244 offset:14336
    v_mfma_f32_16x16x32_bf16 v[44:47], a[76:79], v[108:111], v[44:47]
    ds_read_b128 v[80:83], v244 offset:16384
    s_waitcnt lgkmcnt(3)
    v_mfma_f32_16x16x32_bf16 v[40:43], a[16:19], v[84:87], v[40:43]
    ds_read_b128 v[108:111], v245 offset:14336
    v_mfma_f32_16x16x32_bf16 v[44:47], a[80:83], v[84:87], v[44:47]
    s_waitcnt lgkmcnt(3)
    v_mfma_f32_16x16x32_bf16 v[44:47], a[84:87], v[92:95], v[44:47]
    ds_read_b128 v[84:87], v244 offset:18432
    v_mfma_f32_16x16x32_bf16 v[40:43], a[20:23], v[92:95], v[40:43]
    ds_read_b128 v[92:95], v245 offset:18432
    s_waitcnt lgkmcnt(4)
    v_mfma_f32_16x16x32_bf16 v[44:47], a[88:91], v[100:103], v[44:47]
    s_nop 0
    v_mfma_f32_16x16x32_bf16 v[40:43], a[24:27], v[100:103], v[40:43]
    s_waitcnt lgkmcnt(2)
    v_mfma_f32_16x16x32_bf16 v[44:47], a[92:95], v[108:111], v[44:47]
    ds_read_b128 v[100:103], v244 offset:22528
    v_mfma_f32_16x16x32_bf16 v[40:43], a[28:31], v[108:111], v[40:43]
    ds_read_b128 v[104:107], v245 offset:20480
    s_waitcnt lgkmcnt(3)
    v_mfma_f32_16x16x32_bf16 v[40:43], a[32:35], v[84:87], v[40:43]
    ds_read_b128 v[108:111], v245 offset:22528
    v_mfma_f32_16x16x32_bf16 v[36:39], a[96:99], v[80:83], v[36:39]
    v_mfma_f32_16x16x32_bf16 v[36:39], a[100:103], v[88:91], v[36:39]
    s_waitcnt vmcnt(2)
    buffer_store_dword v2, off, s[8:11], s29 sc1
    v_mfma_f32_16x16x32_bf16 v[32:35], a[32:35], v[80:83], v[32:35]
    s_nop 0
    v_mfma_f32_16x16x32_bf16 v[44:47], a[96:99], v[84:87], v[44:47]
    ds_read_b128 v[84:87], v244 offset:26624
    v_mfma_f32_16x16x32_bf16 v[36:39], a[104:107], v[96:99], v[36:39]
    ds_read_b128 v[80:83], v244 offset:24576
    v_mfma_f32_16x16x32_bf16 v[32:35], a[36:39], v[88:91], v[32:35]
    s_waitcnt lgkmcnt(3)
    v_mfma_f32_16x16x32_bf16 v[36:39], a[108:111], v[104:107], v[36:39]
    ds_read_b128 v[88:91], v245 offset:24576
    v_mfma_f32_16x16x32_bf16 v[44:47], a[100:103], v[92:95], v[44:47]
    s_nop 0
    v_mfma_f32_16x16x32_bf16 v[44:47], a[104:107], v[100:103], v[44:47]
    s_waitcnt lgkmcnt(3)
    v_mfma_f32_16x16x32_bf16 v[44:47], a[108:111], v[108:111], v[44:47]
    v_mfma_f32_16x16x32_bf16 v[40:43], a[36:39], v[92:95], v[40:43]
    v_mfma_f32_16x16x32_bf16 v[32:35], a[40:43], v[96:99], v[32:35]
    ds_read_b128 v[92:95], v245 offset:26624
    v_mfma_f32_16x16x32_bf16 v[32:35], a[44:47], v[104:107], v[32:35]
    ds_read_b128 v[104:107], v245 offset:28672
    s_waitcnt lgkmcnt(4)
    v_mfma_f32_16x16x32_bf16 v[44:47], a[112:115], v[84:87], v[44:47]
    ds_read_b128 v[96:99], v244 offset:28672
    v_mfma_f32_16x16x32_bf16 v[40:43], a[40:43], v[100:103], v[40:43]
    ds_read_b128 v[100:103], v244 offset:30720
    v_mfma_f32_16x16x32_bf16 v[40:43], a[44:47], v[108:111], v[40:43]
    s_waitcnt lgkmcnt(5)
    v_mfma_f32_16x16x32_bf16 v[36:39], a[112:115], v[80:83], v[36:39]
    ds_read_b128 v[108:111], v245 offset:30720
    v_mfma_f32_16x16x32_bf16 v[40:43], a[48:51], v[84:87], v[40:43]
    ds_read_b128 v[84:87], v244 offset:2048
    s_waitcnt lgkmcnt(5)
    v_mfma_f32_16x16x32_bf16 v[44:47], a[116:119], v[92:95], v[44:47]
    v_mfma_f32_16x16x32_bf16 v[40:43], a[52:55], v[92:95], v[40:43]
    ds_read_b128 v[92:95], v245 offset:2048
    v_mfma_f32_16x16x32_bf16 v[36:39], a[116:119], v[88:91], v[36:39]
    s_waitcnt lgkmcnt(3)
    v_mfma_f32_16x16x32_bf16 v[40:43], a[56:59], v[100:103], v[40:43]
    s_add_u32 m0, s21, 0
    s_nop 0
    buffer_load_dwordx4 v241, s[8:11], s20 offen offset:0 sc1 lds
    v_mfma_f32_16x16x32_bf16 v[32:35], a[48:51], v[80:83], v[32:35]
    ds_read_b128 v[80:83], v244 offset:0
    s_waitcnt lgkmcnt(3)
    v_mfma_f32_16x16x32_bf16 v[40:43], a[60:63], v[108:111], v[40:43]
    s_add_u32 m0, s21, 3968
    s_nop 0
    buffer_load_dwordx4 v241, s[8:11], s20 offen offset:128 sc1 lds
    v_mfma_f32_16x16x32_bf16 v[36:39], a[120:123], v[96:99], v[36:39]
    s_add_u32 m0, s21, 7936
    s_nop 0
    buffer_load_dwordx4 v241, s[8:11], s20 offen offset:256 sc1 lds
    v_mfma_f32_16x16x32_bf16 v[44:47], a[120:123], v[100:103], v[44:47]
    ds_read_b128 v[100:103], v244 offset:6144
    s_add_u32 s32, s32, 262144
    v_mfma_f32_16x16x32_bf16 v[44:47], a[124:127], v[108:111], v[44:47]
    ds_read_b128 v[108:111], v245 offset:6144
    v_cvt_pk_bf16_f32 v68, v40, v41
    v_mfma_f32_16x16x32_bf16 v[32:35], a[52:55], v[88:91], v[32:35]
    v_mfma_f32_16x16x32_bf16 v[32:35], a[56:59], v[96:99], v[32:35]
    ds_read_b128 v[96:99], v244 offset:4096
    s_mov_b32 s29, s31
    s_waitcnt lgkmcnt(3)
    v_mfma_f32_16x16x32_bf16 v[48:51], v[80:83], a[128:131], 0
    s_add_u32 m0, s21, 11904
    s_nop 0
    buffer_load_dwordx4 v241, s[8:11], s20 offen offset:384 sc1 lds
    v_mfma_f32_16x16x32_bf16 v[32:35], a[60:63], v[104:107], v[32:35]
    ds_read_b128 v[88:91], v245 offset:0
    v_mfma_f32_16x16x32_bf16 v[36:39], a[124:127], v[104:107], v[36:39]
    s_add_u32 m0, s21, 15872
    s_nop 0
    buffer_load_dwordx4 v241, s[8:11], s20 offen offset:512 sc1 lds
    v_mfma_f32_16x16x32_bf16 v[52:55], v[84:87], a[128:131], 0
    ds_read_b128 v[104:107], v245 offset:4096
    v_mfma_f32_16x16x32_bf16 v[60:63], v[84:87], a[192:195], 0
    ds_read_b128 v[84:87], v244 offset:10240
    v_mfma_f32_16x16x32_bf16 v[60:63], v[92:95], a[196:199], v[60:63]
    v_mfma_f32_16x16x32_bf16 v[56:59], v[80:83], a[192:195], 0
    ds_read_b128 v[80:83], v244 offset:8192
    s_waitcnt lgkmcnt(3)
    v_mfma_f32_16x16x32_bf16 v[56:59], v[88:91], a[196:199], v[56:59]
    s_nop 0
    v_cvt_pk_bf16_f32 v64, v32, v33
    v_mfma_f32_16x16x32_bf16 v[48:51], v[88:91], a[132:135], v[48:51]
    ds_read_b128 v[88:91], v245 offset:8192
    v_mfma_f32_16x16x32_bf16 v[52:55], v[92:95], a[132:135], v[52:55]
    ds_read_b128 v[92:95], v245 offset:10240
    v_mfma_f32_16x16x32_bf16 v[56:59], v[96:99], a[200:203], v[56:59]
    s_waitcnt lgkmcnt(4)
    v_mfma_f32_16x16x32_bf16 v[56:59], v[104:107], a[204:207], v[56:59]
    s_add_u32 m0, s21, 19840
    s_nop 0
    buffer_load_dwordx4 v241, s[8:11], s20 offen offset:640 sc1 lds
    v_mfma_f32_16x16x32_bf16 v[48:51], v[96:99], a[136:139], v[48:51]
    ds_read_b128 v[96:99], v244 offset:12288
    v_cvt_pk_bf16_f32 v70, v44, v45
    v_mfma_f32_16x16x32_bf16 v[52:55], v[100:103], a[136:139], v[52:55]
    v_cvt_pk_bf16_f32 v66, v36, v37
    v_mfma_f32_16x16x32_bf16 v[60:63], v[100:103], a[200:203], v[60:63]
    s_add_u32 m0, s21, 23808
    s_nop 0
    buffer_load_dwordx4 v241, s[8:11], s20 offen offset:768 sc1 lds
    v_mfma_f32_16x16x32_bf16 v[60:63], v[108:111], a[204:207], v[60:63]
    s_nop 0
    v_cvt_pk_bf16_f32 v69, v42, v43
    v_mfma_f32_16x16x32_bf16 v[48:51], v[104:107], a[140:143], v[48:51]
    ds_read_b128 v[104:107], v245 offset:12288
    s_waitcnt lgkmcnt(4)
    v_mfma_f32_16x16x32_bf16 v[48:51], v[80:83], a[144:147], v[48:51]
    s_waitcnt lgkmcnt(3)
    v_mfma_f32_16x16x32_bf16 v[48:51], v[88:91], a[148:151], v[48:51]
    ds_read_b128 v[100:103], v244 offset:14336
    v_cvt_pk_bf16_f32 v65, v34, v35
    v_mfma_f32_16x16x32_bf16 v[56:59], v[80:83], a[208:211], v[56:59]
    s_nop 0
    v_cvt_pk_bf16_f32 v71, v46, v47
    v_mfma_f32_16x16x32_bf16 v[52:55], v[108:111], a[140:143], v[52:55]
    ds_read_b128 v[108:111], v245 offset:14336
    s_waitcnt lgkmcnt(3)
    v_mfma_f32_16x16x32_bf16 v[48:51], v[96:99], a[152:155], v[48:51]
    s_nop 0
    v_cvt_pk_bf16_f32 v67, v38, v39
    v_mfma_f32_16x16x32_bf16 v[52:55], v[84:87], a[144:147], v[52:55]
    s_add_u32 m0, s21, 27776
    s_nop 0
    buffer_load_dwordx4 v241, s[8:11], s20 offen offset:896 sc1 lds
    v_mfma_f32_16x16x32_bf16 v[60:63], v[84:87], a[208:211], v[60:63]
    buffer_store_dwordx4 v[64:67], v240, s[8:11], s28 offen offset:0 sc1
    v_mfma_f32_16x16x32_bf16 v[52:55], v[92:95], a[148:151], v[52:55]
    ds_read_b128 v[84:87], v244 offset:18432
    v_mfma_f32_16x16x32_bf16 v[56:59], v[88:91], a[212:215], v[56:59]
    ds_read_b128 v[88:91], v245 offset:16384
    v_mfma_f32_16x16x32_bf16 v[56:59], v[96:99], a[216:219], v[56:59]
    buffer_store_dwordx4 v[68:71], v240, s[8:11], s28 offen offset:1024 sc1
    v_mfma_f32_16x16x32_bf16 v[60:63], v[92:95], a[212:215], v[60:63]
    ds_read_b128 v[80:83], v244 offset:16384
    s_waitcnt lgkmcnt(5)
    v_mfma_f32_16x16x32_bf16 v[56:59], v[104:107], a[220:223], v[56:59]
    s_waitcnt lgkmcnt(4)
    v_mfma_f32_16x16x32_bf16 v[52:55], v[100:103], a[152:155], v[52:55]
    ds_read_b128 v[96:99], v244 offset:20480
    v_mfma_f32_16x16x32_bf16 v[48:51], v[104:107], a[156:159], v[48:51]
    ds_read_b128 v[104:107], v245 offset:20480
    v_mfma_f32_16x16x32_bf16 v[60:63], v[100:103], a[216:219], v[60:63]
    s_waitcnt lgkmcnt(5)
    v_mfma_f32_16x16x32_bf16 v[60:63], v[108:111], a[220:223], v[60:63]
    s_waitcnt lgkmcnt(2)
    v_mfma_f32_16x16x32_bf16 v[48:51], v[80:83], a[160:163], v[48:51]
    ds_read_b128 v[92:95], v245 offset:18432
    v_mfma_f32_16x16x32_bf16 v[52:55], v[108:111], a[156:159], v[52:55]
    ds_read_b128 v[108:111], v245 offset:22528
    v_mfma_f32_16x16x32_bf16 v[56:59], v[80:83], a[224:227], v[56:59]
    v_mfma_f32_16x16x32_bf16 v[56:59], v[88:91], a[228:231], v[56:59]
    ds_read_b128 v[100:103], v244 offset:22528
    v_mfma_f32_16x16x32_bf16 v[52:55], v[84:87], a[160:163], v[52:55]
    s_nop 0
    v_mfma_f32_16x16x32_bf16 v[60:63], v[84:87], a[224:227], v[60:63]
    s_waitcnt lgkmcnt(2)
    v_mfma_f32_16x16x32_bf16 v[60:63], v[92:95], a[228:231], v[60:63]
    ds_read_b128 v[84:87], v244 offset:26624
    v_mfma_f32_16x16x32_bf16 v[52:55], v[92:95], a[164:167], v[52:55]
    ds_read_b128 v[92:95], v245 offset:26624
    v_mfma_f32_16x16x32_bf16 v[56:59], v[96:99], a[232:235], v[56:59]
    v_mfma_f32_16x16x32_bf16 v[48:51], v[88:91], a[164:167], v[48:51]
    v_mfma_f32_16x16x32_bf16 v[48:51], v[96:99], a[168:171], v[48:51]
    v_mfma_f32_16x16x32_bf16 v[48:51], v[104:107], a[172:175], v[48:51]
    ds_read_b128 v[80:83], v244 offset:24576
    s_waitcnt lgkmcnt(3)
    v_mfma_f32_16x16x32_bf16 v[60:63], v[100:103], a[232:235], v[60:63]
    v_mfma_f32_16x16x32_bf16 v[52:55], v[100:103], a[168:171], v[52:55]
    v_mfma_f32_16x16x32_bf16 v[52:55], v[108:111], a[172:175], v[52:55]
    v_mfma_f32_16x16x32_bf16 v[56:59], v[104:107], a[236:239], v[56:59]
    ds_read_b128 v[88:91], v245 offset:24576
    v_mfma_f32_16x16x32_bf16 v[60:63], v[108:111], a[236:239], v[60:63]
    ds_read_b128 v[104:107], v245 offset:28672
    s_waitcnt lgkmcnt(2)
    v_mfma_f32_16x16x32_bf16 v[48:51], v[80:83], a[176:179], v[48:51]
    ds_read_b128 v[96:99], v244 offset:28672
    v_mfma_f32_16x16x32_bf16 v[60:63], v[84:87], a[240:243], v[60:63]
    ds_read_b128 v[108:111], v245 offset:30720
    s_add_u32 s17, s17, 1
    v_mfma_f32_16x16x32_bf16 v[60:63], v[92:95], a[244:247], v[60:63]
    s_nop 0
    v_xor_b32 v245, 32768, v245
    v_mfma_f32_16x16x32_bf16 v[56:59], v[80:83], a[240:243], v[56:59]
    s_waitcnt lgkmcnt(3)
    v_mfma_f32_16x16x32_bf16 v[56:59], v[88:91], a[244:247], v[56:59]
    ds_read_b128 v[100:103], v244 offset:30720
    v_mfma_f32_16x16x32_bf16 v[48:51], v[88:91], a[180:183], v[48:51]
    s_nop 0
    v_xor_b32 v244, 32768, v244
    s_waitcnt lgkmcnt(2)
    v_mfma_f32_16x16x32_bf16 v[48:51], v[96:99], a[184:187], v[48:51]
    s_waitcnt vmcnt(2)
    v_and_or_b32 v246, s21, v247, v240
    buffer_load_dword v243, off, s[8:11], s31
    v_mfma_f32_16x16x32_bf16 v[56:59], v[96:99], a[248:251], v[56:59]
    ds_read_b128 v[116:119], v246 offset:4096
    ds_read_b128 v[120:123], v246 offset:8192
    v_mfma_f32_16x16x32_bf16 v[52:55], v[84:87], a[176:179], v[52:55]
    ds_read_b128 v[132:135], v246 offset:20480
    ds_read_b128 v[140:143], v246 offset:28672
    v_mfma_f32_16x16x32_bf16 v[56:59], v[104:107], a[252:255], v[56:59]
    ds_read_b128 v[112:115], v246 offset:0
    ds_read_b128 v[128:131], v246 offset:16384
    v_mfma_f32_16x16x32_bf16 v[52:55], v[92:95], a[180:183], v[52:55]
    ds_read_b128 v[124:127], v246 offset:12288
    s_waitcnt lgkmcnt(7)
    v_mfma_f32_16x16x32_bf16 v[60:63], v[100:103], a[248:251], v[60:63]
    ds_read_b128 v[136:139], v246 offset:24576
    v_cvt_pk_bf16_f32 v77, v58, v59
    v_mfma_f32_16x16x32_bf16 v[48:51], v[104:107], a[188:191], v[48:51]
    s_waitcnt lgkmcnt(6)
    v_max3_u32 v120, v120, v121, v122
    v_max3_u32 v116, v116, v117, v118
    v_mfma_f32_16x16x32_bf16 v[60:63], v[108:111], a[252:255], v[60:63]
    s_waitcnt lgkmcnt(4)
    v_max3_u32 v140, v140, v141, v142
    v_max3_u32 v132, v132, v133, v134
    v_mfma_f32_16x16x32_bf16 v[52:55], v[100:103], a[184:187], v[52:55]
    s_waitcnt lgkmcnt(3)
    v_max3_u32 v112, v112, v113, v114
    v_max3_u32 v242, v112, v115, v112
    v_max3_u32 v242, v116, v119, v242
    v_max3_u32 v242, v120, v123, v242
    v_cvt_pk_bf16_f32 v76, v56, v57
    v_cvt_pk_bf16_f32 v73, v50, v51
    v_mfma_f32_16x16x32_bf16 v[52:55], v[108:111], a[188:191], v[52:55]
    s_waitcnt lgkmcnt(0)
    v_max3_u32 v136, v136, v137, v138
    v_cvt_pk_bf16_f32 v79, v62, v63
    v_max3_u32 v124, v124, v125, v126
    v_max3_u32 v242, v124, v127, v242
    v_max3_u32 v128, v128, v129, v130
    v_max3_u32 v242, v128, v131, v242
    v_cvt_pk_bf16_f32 v72, v48, v49
    v_max3_u32 v242, v132, v135, v242
    v_max3_u32 v242, v136, v139, v242
    v_max3_u32 v242, v140, v143, v242
    v_cvt_pk_bf16_f32 v74, v52, v53
    v_cmp_eq_u32 vcc, s19, v242
    v_cvt_pk_bf16_f32 v78, v60, v61
    v_cvt_pk_bf16_f32 v75, v54, v55
    buffer_store_dwordx4 v[72:75], v240, s[8:11], s28 offen offset:2048 sc1
    buffer_store_dwordx4 v[76:79], v240, s[8:11], s28 offen offset:3072 sc1
    s_add_u32 s28, s28, 524288
    s_cmp_eq_u32 s17, 64
    s_cbranch_scc1 kv_end
    s_cbranch_vccz kv_loop1
kv_try:
    s_add_u32 m0, s21, 0
    s_nop 0
    buffer_load_dwordx4 v241, s[8:11], s20 offen offset:0 sc1 lds
    s_add_u32 m0, s21, 3968
    s_nop 0
    buffer_load_dwordx4 v241, s[8:11], s20 offen offset:128 sc1 lds
    s_add_u32 m0, s21, 7936
    s_nop 0
    buffer_load_dwordx4 v241, s[8:11], s20 offen offset:256 sc1 lds
    s_add_u32 m0, s21, 11904
    s_nop 0
    buffer_load_dwordx4 v241, s[8:11], s20 offen offset:384 sc1 lds
    s_add_u32 m0, s21, 15872
    s_nop 0
    buffer_load_dwordx4 v241, s[8:11], s20 offen offset:512 sc1 lds
    s_add_u32 m0, s21, 19840
    s_nop 0
    buffer_load_dwordx4 v241, s[8:11], s20 offen offset:640 sc1 lds
    s_add_u32 m0, s21, 23808
    s_nop 0
    buffer_load_dwordx4 v241, s[8:11], s20 offen offset:768 sc1 lds
    s_add_u32 m0, s21, 27776
    s_nop 0
    buffer_load_dwordx4 v241, s[8:11], s20 offen offset:896 sc1 lds
    s_waitcnt vmcnt(8)
    v_mov_b32_e64 v243, s17
    buffer_store_dword v243, off, s[8:11], s29 sc1
    s_mov_b32 s29, 0x7fff0000
    s_waitcnt vmcnt(1)
    v_and_or_b32 v246, s21, v247, v240
    ds_read_b128 v[112:115], v246 offset:0
    ds_read_b128 v[116:119], v246 offset:4096
    ds_read_b128 v[120:123], v246 offset:8192
    ds_read_b128 v[124:127], v246 offset:12288
    ds_read_b128 v[128:131], v246 offset:16384
    ds_read_b128 v[132:135], v246 offset:20480
    ds_read_b128 v[136:139], v246 offset:24576
    ds_read_b128 v[140:143], v246 offset:28672
    s_waitcnt lgkmcnt(7)
    v_max3_u32 v112, v112, v113, v114
    v_max3_u32 v242, v112, v115, v112
    s_waitcnt lgkmcnt(6)
    v_max3_u32 v116, v116, v117, v118
    v_max3_u32 v242, v116, v119, v242
    s_waitcnt lgkmcnt(5)
    v_max3_u32 v120, v120, v121, v122
    v_max3_u32 v242, v120, v123, v242
    s_waitcnt lgkmcnt(4)
    v_max3_u32 v124, v124, v125, v126
    v_max3_u32 v242, v124, v127, v242
    s_waitcnt lgkmcnt(3)
    v_max3_u32 v128, v128, v129, v130
    v_max3_u32 v242, v128, v131, v242
    s_waitcnt lgkmcnt(2)
    v_max3_u32 v132, v132, v133, v134
    v_max3_u32 v242, v132, v135, v242
    s_waitcnt lgkmcnt(1)
    v_max3_u32 v136, v136, v137, v138
    v_max3_u32 v242, v136, v139, v242
    s_waitcnt lgkmcnt(0)
    v_max3_u32 v140, v140, v141, v142
    v_max3_u32 v242, v140, v143, v242
    v_cmp_eq_u32_e64 vcc, s19, v242
    s_cbranch_vccz kv_loop1
    s_sub_u32 s3, s3, 1
    s_cbranch_scc1 main_timeout
    s_branch kv_try
    s_nop 0
    s_nop 0
    s_nop 0
    s_nop 0
    s_nop 0
    s_nop 0
kv_end:
    s_waitcnt vmcnt(0)
    v_mov_b32 v243, s17
    buffer_store_dword v243, off, s[8:11], s29 sc1
    s_mov_b32 s29, 0x7fff0000
    s_waitcnt vmcnt(0)
    s_endpgm
    s_nop 0
    s_nop 0
    s_nop 0
    s_nop 0
    s_nop 0
    s_nop 0
at_role:
    v_and_b32 v0, 63, v0
    s_and_b32 s22, s14, 3
    s_lshl_b32 s24, s22, 14
    s_lshl_b32 s23, s12, 12
    s_add_u32 s24, s24, s23
    s_lshl_b32 s23, s13, 7
    s_add_u32 s24, s24, s23
    s_add_u32 s24, s24, 143736832
    s_lshl_b32 s55, s22, 12
    s_add_u32 s55, s55, s23
    s_add_u32 s25, s55, 143818752
    s_add_u32 s55, s55, 143802368
    s_cmp_eq_u32 s16, 0
    s_cselect_b32 s55, s25, s55
    s_cselect_b32 s25, s25, s24
    s_and_b32 s50, s14, 3
    s_lshl_b32 s50, s50, 5
    s_add_u32 s50, s50, s13
    s_lshl_b32 s50, s50, 4
    s_load_dwordx2 s[44:45], s[0:1], 0
    s_mov_b32 s46, 2097152
    s_mov_b32 s47, 0x00020000
    v_and_b32 v10, 63, v254
    v_lshlrev_b32 v10, 4, v10
    s_lshl_b32 s48, s50, 10
    s_lshl_b32 s49, s12, 12
    s_add_u32 s48, s48, s49
    s_waitcnt lgkmcnt(0)
    buffer_load_dwordx4 v[112:115], v10, s[44:47], s48 offen offset:0
    buffer_load_dwordx4 v[116:119], v10, s[44:47], s48 offen offset:1024
    buffer_load_dwordx4 v[120:123], v10, s[44:47], s48 offen offset:2048
    buffer_load_dwordx4 v[124:127], v10, s[44:47], s48 offen offset:3072
    v_lshrrev_b32_e64 v26, 4, v0
    v_lshlrev_b32_e64 v17, 2, v26
    v_xor_b32_e64 v17, v17, v0
    v_and_b32_e64 v17, 15, v17
    v_lshlrev_b32 v17, 4, v17
    v_lshl_add_u32 v16, v26, 13, v17
    v_lshl_add_u32 v17, v26, 10, v17
    s_lshl_b32 s40, s13, 8
    s_lshl_b32 s42, s12, 18
    s_add_u32 s40, s40, s42
    s_lshl_b32 s41, s13, 17
    s_lshl_b32 s42, s12, 8
    s_add_u32 s41, s41, s42
    s_lshl_b32 s42, s12, 13
    s_add_u32 s42, s42, 32768
    s_lshl_b32 s39, s12, 15
    s_add_u32 s43, s40, 0
    s_add_u32 m0, s42, 0
    s_nop 0
    buffer_load_dwordx4 v16, s[68:71], s43 offen lds
    s_add_u32 s43, s43, 32768
    s_add_u32 m0, s42, 1024
    s_nop 0
    buffer_load_dwordx4 v16, s[68:71], s43 offen lds
    s_add_u32 s43, s43, 32768
    s_add_u32 m0, s42, 2048
    s_nop 0
    buffer_load_dwordx4 v16, s[68:71], s43 offen lds
    s_add_u32 s43, s43, 32768
    s_add_u32 m0, s42, 3072
    s_nop 0
    buffer_load_dwordx4 v16, s[68:71], s43 offen lds
    s_add_u32 s43, s43, 32768
    s_add_u32 m0, s42, 4096
    s_nop 0
    buffer_load_dwordx4 v16, s[68:71], s43 offen lds
    s_add_u32 s43, s43, 32768
    s_add_u32 m0, s42, 5120
    s_nop 0
    buffer_load_dwordx4 v16, s[68:71], s43 offen lds
    s_add_u32 s43, s43, 32768
    s_add_u32 m0, s42, 6144
    s_nop 0
    buffer_load_dwordx4 v16, s[68:71], s43 offen lds
    s_add_u32 s43, s43, 32768
    s_add_u32 m0, s42, 7168
    s_nop 0
    buffer_load_dwordx4 v16, s[68:71], s43 offen lds
    v_lshrrev_b32 v26, 4, v0
    v_lshlrev_b32_e64 v22, 11, v26
    v_bfe_u32 v26, v0, 2, 2
    v_mul_u32_u24 v26, 320, v26
    v_add_u32 v22, v22, v26
    v_and_b32 v26, 3, v0
    v_lshl_add_u32 v22, v26, 4, v22
    s_lshl_b32 s43, s12, 6
    v_xor_b32 v18, s43, v22
    v_add_u32 v18, 32768, v18
    v_add_u32 v22, s42, v22
    v_xor_b32 v19, 8192, v18
    v_xor_b32 v23, 64, v22
    v_xor_b32 v20, 16384, v18
    v_xor_b32 v24, 128, v22
    v_xor_b32 v21, 24576, v18
    v_xor_b32 v25, 192, v22
    s_waitcnt vmcnt(12)
    v_mov_b32 v3, 0
    s_cmp_lg_u32 s12, 0
    s_cbranch_scc1 rdy_17
    s_mov_b64 exec, 1
    ds_write_b32 v3, v255
    s_mov_b64 exec, -1
    s_waitcnt lgkmcnt(0)
rdy_17:
    s_barrier
    ds_read_b32 v2, v3
    s_waitcnt lgkmcnt(0)
    v_readfirstlane_b32 s22, v2
    s_barrier
    s_bitcmp1_b32 s22, s13
    s_cbranch_scc1 main_late
    v_mov_b32 v1, 0
    buffer_store_dword v1, off, s[8:11], s24 sc1
    buffer_store_dword v1, off, s[8:11], s25 sc1
    s_add_u32 s43, s40, 1048576
    s_add_u32 m0, s42, 32768
    s_nop 0
    buffer_load_dwordx4 v16, s[68:71], s43 offen lds
    s_add_u32 s43, s43, 32768
    s_add_u32 m0, s42, 33792
    s_nop 0
    buffer_load_dwordx4 v16, s[68:71], s43 offen lds
    s_add_u32 s43, s43, 32768
    s_add_u32 m0, s42, 34816
    s_nop 0
    buffer_load_dwordx4 v16, s[68:71], s43 offen lds
    s_add_u32 s43, s43, 32768
    s_add_u32 m0, s42, 35840
    s_nop 0
    buffer_load_dwordx4 v16, s[68:71], s43 offen lds
    s_add_u32 s43, s43, 32768
    s_add_u32 m0, s42, 36864
    s_nop 0
    buffer_load_dwordx4 v16, s[68:71], s43 offen lds
    s_add_u32 s43, s43, 32768
    s_add_u32 m0, s42, 37888
    s_nop 0
    buffer_load_dwordx4 v16, s[68:71], s43 offen lds
    s_add_u32 s43, s43, 32768
    s_add_u32 m0, s42, 38912
    s_nop 0
    buffer_load_dwordx4 v16, s[68:71], s43 offen lds
    s_add_u32 s43, s43, 32768
    s_add_u32 m0, s42, 39936
    s_nop 0
    buffer_load_dwordx4 v16, s[68:71], s43 offen lds
    s_waitcnt vmcnt(8)
    s_barrier
    s_cmp_lg_u32 s12, 0
    s_cbranch_scc1 cnt_18
    s_mov_b64 exec, 1
    s_add_u32 s22, s16, 1
    v_mov_b32_e64 v1, s22
    s_lshl_b32 s22, s16, 4
    buffer_atomic_add v1, off, s[4:7], s22 offset:128
    s_mov_b64 exec, -1
cnt_18:
    s_add_u32 s43, s40, 2097152
    s_add_u32 m0, s42, 65536
    s_nop 0
    buffer_load_dwordx4 v16, s[68:71], s43 offen lds
    s_add_u32 s43, s43, 32768
    s_add_u32 m0, s42, 66560
    s_nop 0
    buffer_load_dwordx4 v16, s[68:71], s43 offen lds
    s_add_u32 s43, s43, 32768
    s_add_u32 m0, s42, 67584
    s_nop 0
    buffer_load_dwordx4 v16, s[68:71], s43 offen lds
    s_add_u32 s43, s43, 32768
    s_add_u32 m0, s42, 68608
    s_nop 0
    buffer_load_dwordx4 v16, s[68:71], s43 offen lds
    s_add_u32 s43, s43, 32768
    s_add_u32 m0, s42, 69632
    s_nop 0
    buffer_load_dwordx4 v16, s[68:71], s43 offen lds
    s_add_u32 s43, s43, 32768
    s_add_u32 m0, s42, 70656
    s_nop 0
    buffer_load_dwordx4 v16, s[68:71], s43 offen lds
    s_add_u32 s43, s43, 32768
    s_add_u32 m0, s42, 71680
    s_nop 0
    buffer_load_dwordx4 v16, s[68:71], s43 offen lds
    s_add_u32 s43, s43, 32768
    s_add_u32 m0, s42, 72704
    s_nop 0
    buffer_load_dwordx4 v16, s[68:71], s43 offen lds
    s_waitcnt vmcnt(16)
    s_barrier
    s_add_u32 s43, s40, 3145728
    s_add_u32 m0, s42, 98304
    s_nop 0
    buffer_load_dwordx4 v16, s[68:71], s43 offen lds
    s_add_u32 s43, s43, 32768
    s_add_u32 m0, s42, 99328
    s_nop 0
    buffer_load_dwordx4 v16, s[68:71], s43 offen lds
    s_add_u32 s43, s43, 32768
    s_add_u32 m0, s42, 100352
    s_nop 0
    buffer_load_dwordx4 v16, s[68:71], s43 offen lds
    s_add_u32 s43, s43, 32768
    s_add_u32 m0, s42, 101376
    s_nop 0
    buffer_load_dwordx4 v16, s[68:71], s43 offen lds
    s_add_u32 s43, s43, 32768
    s_add_u32 m0, s42, 102400
    s_nop 0
    buffer_load_dwordx4 v16, s[68:71], s43 offen lds
    s_add_u32 s43, s43, 32768
    s_add_u32 m0, s42, 103424
    s_nop 0
    buffer_load_dwordx4 v16, s[68:71], s43 offen lds
    s_add_u32 s43, s43, 32768
    s_add_u32 m0, s42, 104448
    s_nop 0
    buffer_load_dwordx4 v16, s[68:71], s43 offen lds
    s_add_u32 s43, s43, 32768
    s_add_u32 m0, s42, 105472
    s_nop 0
    buffer_load_dwordx4 v16, s[68:71], s43 offen lds
    ds_read_b64_tr_b16 a[0:1], v18 offset:0
    ds_read_b64_tr_b16 a[2:3], v18 offset:1024
    ds_read_b64_tr_b16 a[64:65], v18 offset:8
    ds_read_b64_tr_b16 a[66:67], v18 offset:1032
    ds_read_b64_tr_b16 a[4:5], v19 offset:0
    ds_read_b64_tr_b16 a[6:7], v19 offset:1024
    ds_read_b64_tr_b16 a[68:69], v19 offset:8
    ds_read_b64_tr_b16 a[70:71], v19 offset:1032
    ds_read_b64_tr_b16 a[8:9], v20 offset:0
    ds_read_b64_tr_b16 a[10:11], v20 offset:1024
    ds_read_b64_tr_b16 a[72:73], v20 offset:8
    ds_read_b64_tr_b16 a[74:75], v20 offset:1032
    ds_read_b64_tr_b16 a[12:13], v21 offset:0
    ds_read_b64_tr_b16 a[14:15], v21 offset:1024
    ds_read_b64_tr_b16 a[76:77], v21 offset:8
    ds_read_b64_tr_b16 a[78:79], v21 offset:1032
    s_waitcnt lgkmcnt(0)
    s_waitcnt vmcnt(16)
    s_barrier
    s_add_u32 s43, s41, 0
    s_add_u32 m0, s42, 0
    s_nop 0
    buffer_load_dwordx4 v17, s[80:83], s43 offen lds
    s_add_u32 s43, s43, 4096
    s_add_u32 m0, s42, 1024
    s_nop 0
    buffer_load_dwordx4 v17, s[80:83], s43 offen lds
    s_add_u32 s43, s43, 4096
    s_add_u32 m0, s42, 2048
    s_nop 0
    buffer_load_dwordx4 v17, s[80:83], s43 offen lds
    s_add_u32 s43, s43, 4096
    s_add_u32 m0, s42, 3072
    s_nop 0
    buffer_load_dwordx4 v17, s[80:83], s43 offen lds
    s_add_u32 s43, s43, 4096
    s_add_u32 m0, s42, 4096
    s_nop 0
    buffer_load_dwordx4 v17, s[80:83], s43 offen lds
    s_add_u32 s43, s43, 4096
    s_add_u32 m0, s42, 5120
    s_nop 0
    buffer_load_dwordx4 v17, s[80:83], s43 offen lds
    s_add_u32 s43, s43, 4096
    s_add_u32 m0, s42, 6144
    s_nop 0
    buffer_load_dwordx4 v17, s[80:83], s43 offen lds
    s_add_u32 s43, s43, 4096
    s_add_u32 m0, s42, 7168
    s_nop 0
    buffer_load_dwordx4 v17, s[80:83], s43 offen lds
    ds_read_b64_tr_b16 a[16:17], v18 offset:32768
    ds_read_b64_tr_b16 a[18:19], v18 offset:33792
    ds_read_b64_tr_b16 a[80:81], v18 offset:32776
    ds_read_b64_tr_b16 a[82:83], v18 offset:33800
    ds_read_b64_tr_b16 a[20:21], v19 offset:32768
    ds_read_b64_tr_b16 a[22:23], v19 offset:33792
    ds_read_b64_tr_b16 a[84:85], v19 offset:32776
    ds_read_b64_tr_b16 a[86:87], v19 offset:33800
    ds_read_b64_tr_b16 a[24:25], v20 offset:32768
    ds_read_b64_tr_b16 a[26:27], v20 offset:33792
    ds_read_b64_tr_b16 a[88:89], v20 offset:32776
    ds_read_b64_tr_b16 a[90:91], v20 offset:33800
    ds_read_b64_tr_b16 a[28:29], v21 offset:32768
    ds_read_b64_tr_b16 a[30:31], v21 offset:33792
    ds_read_b64_tr_b16 a[92:93], v21 offset:32776
    ds_read_b64_tr_b16 a[94:95], v21 offset:33800
    s_waitcnt lgkmcnt(0)
    s_waitcnt vmcnt(16)
    s_barrier
    s_add_u32 s43, s41, 32768
    s_add_u32 m0, s42, 32768
    s_nop 0
    buffer_load_dwordx4 v17, s[80:83], s43 offen lds
    s_add_u32 s43, s43, 4096
    s_add_u32 m0, s42, 33792
    s_nop 0
    buffer_load_dwordx4 v17, s[80:83], s43 offen lds
    s_add_u32 s43, s43, 4096
    s_add_u32 m0, s42, 34816
    s_nop 0
    buffer_load_dwordx4 v17, s[80:83], s43 offen lds
    s_add_u32 s43, s43, 4096
    s_add_u32 m0, s42, 35840
    s_nop 0
    buffer_load_dwordx4 v17, s[80:83], s43 offen lds
    s_add_u32 s43, s43, 4096
    s_add_u32 m0, s42, 36864
    s_nop 0
    buffer_load_dwordx4 v17, s[80:83], s43 offen lds
    s_add_u32 s43, s43, 4096
    s_add_u32 m0, s42, 37888
    s_nop 0
    buffer_load_dwordx4 v17, s[80:83], s43 offen lds
    s_add_u32 s43, s43, 4096
    s_add_u32 m0, s42, 38912
    s_nop 0
    buffer_load_dwordx4 v17, s[80:83], s43 offen lds
    s_add_u32 s43, s43, 4096
    s_add_u32 m0, s42, 39936
    s_nop 0
    buffer_load_dwordx4 v17, s[80:83], s43 offen lds
    v_add_u32 v18, 65536, v18
    v_add_u32 v19, 65536, v19
    v_add_u32 v20, 65536, v20
    v_add_u32 v21, 65536, v21
    v_add_u32 v22, 65536, v22
    v_add_u32 v23, 65536, v23
    v_add_u32 v24, 65536, v24
    v_add_u32 v25, 65536, v25
    ds_read_b64_tr_b16 a[32:33], v18 offset:0
    ds_read_b64_tr_b16 a[34:35], v18 offset:1024
    ds_read_b64_tr_b16 a[96:97], v18 offset:8
    ds_read_b64_tr_b16 a[98:99], v18 offset:1032
    ds_read_b64_tr_b16 a[36:37], v19 offset:0
    ds_read_b64_tr_b16 a[38:39], v19 offset:1024
    ds_read_b64_tr_b16 a[100:101], v19 offset:8
    ds_read_b64_tr_b16 a[102:103], v19 offset:1032
    ds_read_b64_tr_b16 a[40:41], v20 offset:0
    ds_read_b64_tr_b16 a[42:43], v20 offset:1024
    ds_read_b64_tr_b16 a[104:105], v20 offset:8
    ds_read_b64_tr_b16 a[106:107], v20 offset:1032
    ds_read_b64_tr_b16 a[44:45], v21 offset:0
    ds_read_b64_tr_b16 a[46:47], v21 offset:1024
    ds_read_b64_tr_b16 a[108:109], v21 offset:8
    ds_read_b64_tr_b16 a[110:111], v21 offset:1032
    s_waitcnt lgkmcnt(0)
    s_waitcnt vmcnt(16)
    s_barrier
    s_add_u32 s43, s41, 65536
    s_add_u32 m0, s42, 65536
    s_nop 0
    buffer_load_dwordx4 v17, s[80:83], s43 offen lds
    s_add_u32 s43, s43, 4096
    s_add_u32 m0, s42, 66560
    s_nop 0
    buffer_load_dwordx4 v17, s[80:83], s43 offen lds
    s_add_u32 s43, s43, 4096
    s_add_u32 m0, s42, 67584
    s_nop 0
    buffer_load_dwordx4 v17, s[80:83], s43 offen lds
    s_add_u32 s43, s43, 4096
    s_add_u32 m0, s42, 68608
    s_nop 0
    buffer_load_dwordx4 v17, s[80:83], s43 offen lds
    s_add_u32 s43, s43, 4096
    s_add_u32 m0, s42, 69632
    s_nop 0
    buffer_load_dwordx4 v17, s[80:83], s43 offen lds
    s_add_u32 s43, s43, 4096
    s_add_u32 m0, s42, 70656
    s_nop 0
    buffer_load_dwordx4 v17, s[80:83], s43 offen lds
    s_add_u32 s43, s43, 4096
    s_add_u32 m0, s42, 71680
    s_nop 0
    buffer_load_dwordx4 v17, s[80:83], s43 offen lds
    s_add_u32 s43, s43, 4096
    s_add_u32 m0, s42, 72704
    s_nop 0
    buffer_load_dwordx4 v17, s[80:83], s43 offen lds
    ds_read_b64_tr_b16 a[48:49], v18 offset:32768
    ds_read_b64_tr_b16 a[50:51], v18 offset:33792
    ds_read_b64_tr_b16 a[112:113], v18 offset:32776
    ds_read_b64_tr_b16 a[114:115], v18 offset:33800
    ds_read_b64_tr_b16 a[52:53], v19 offset:32768
    ds_read_b64_tr_b16 a[54:55], v19 offset:33792
    ds_read_b64_tr_b16 a[116:117], v19 offset:32776
    ds_read_b64_tr_b16 a[118:119], v19 offset:33800
    ds_read_b64_tr_b16 a[56:57], v20 offset:32768
    ds_read_b64_tr_b16 a[58:59], v20 offset:33792
    ds_read_b64_tr_b16 a[120:121], v20 offset:32776
    ds_read_b64_tr_b16 a[122:123], v20 offset:33800
    ds_read_b64_tr_b16 a[60:61], v21 offset:32768
    ds_read_b64_tr_b16 a[62:63], v21 offset:33792
    ds_read_b64_tr_b16 a[124:125], v21 offset:32776
    ds_read_b64_tr_b16 a[126:127], v21 offset:33800
    s_waitcnt lgkmcnt(0)
    s_waitcnt vmcnt(16)
    s_barrier
    s_add_u32 s43, s41, 98304
    s_add_u32 m0, s42, 98304
    s_nop 0
    buffer_load_dwordx4 v17, s[80:83], s43 offen lds
    s_add_u32 s43, s43, 4096
    s_add_u32 m0, s42, 99328
    s_nop 0
    buffer_load_dwordx4 v17, s[80:83], s43 offen lds
    s_add_u32 s43, s43, 4096
    s_add_u32 m0, s42, 100352
    s_nop 0
    buffer_load_dwordx4 v17, s[80:83], s43 offen lds
    s_add_u32 s43, s43, 4096
    s_add_u32 m0, s42, 101376
    s_nop 0
    buffer_load_dwordx4 v17, s[80:83], s43 offen lds
    s_add_u32 s43, s43, 4096
    s_add_u32 m0, s42, 102400
    s_nop 0
    buffer_load_dwordx4 v17, s[80:83], s43 offen lds
    s_add_u32 s43, s43, 4096
    s_add_u32 m0, s42, 103424
    s_nop 0
    buffer_load_dwordx4 v17, s[80:83], s43 offen lds
    s_add_u32 s43, s43, 4096
    s_add_u32 m0, s42, 104448
    s_nop 0
    buffer_load_dwordx4 v17, s[80:83], s43 offen lds
    s_add_u32 s43, s43, 4096
    s_add_u32 m0, s42, 105472
    s_nop 0
    buffer_load_dwordx4 v17, s[80:83], s43 offen lds
    v_add_u32 v18, 4294901760, v18
    v_add_u32 v19, 4294901760, v19
    v_add_u32 v20, 4294901760, v20
    v_add_u32 v21, 4294901760, v21
    v_add_u32 v22, 4294901760, v22
    v_add_u32 v23, 4294901760, v23
    v_add_u32 v24, 4294901760, v24
    v_add_u32 v25, 4294901760, v25
    ds_read_b64_tr_b16 a[128:129], v22 offset:0
    ds_read_b64_tr_b16 a[130:131], v22 offset:1024
    ds_read_b64_tr_b16 a[144:145], v22 offset:8
    ds_read_b64_tr_b16 a[146:147], v22 offset:1032
    ds_read_b64_tr_b16 a[160:161], v23 offset:0
    ds_read_b64_tr_b16 a[162:163], v23 offset:1024
    ds_read_b64_tr_b16 a[176:177], v23 offset:8
    ds_read_b64_tr_b16 a[178:179], v23 offset:1032
    ds_read_b64_tr_b16 a[192:193], v24 offset:0
    ds_read_b64_tr_b16 a[194:195], v24 offset:1024
    ds_read_b64_tr_b16 a[208:209], v24 offset:8
    ds_read_b64_tr_b16 a[210:211], v24 offset:1032
    ds_read_b64_tr_b16 a[224:225], v25 offset:0
    ds_read_b64_tr_b16 a[226:227], v25 offset:1024
    ds_read_b64_tr_b16 a[240:241], v25 offset:8
    ds_read_b64_tr_b16 a[242:243], v25 offset:1032
    s_waitcnt lgkmcnt(0)
    s_waitcnt vmcnt(16)
    s_barrier
    ds_read_b64_tr_b16 a[132:133], v22 offset:32768
    ds_read_b64_tr_b16 a[134:135], v22 offset:33792
    ds_read_b64_tr_b16 a[148:149], v22 offset:32776
    ds_read_b64_tr_b16 a[150:151], v22 offset:33800
    ds_read_b64_tr_b16 a[164:165], v23 offset:32768
    ds_read_b64_tr_b16 a[166:167], v23 offset:33792
    ds_read_b64_tr_b16 a[180:181], v23 offset:32776
    ds_read_b64_tr_b16 a[182:183], v23 offset:33800
    ds_read_b64_tr_b16 a[196:197], v24 offset:32768
    ds_read_b64_tr_b16 a[198:199], v24 offset:33792
    ds_read_b64_tr_b16 a[212:213], v24 offset:32776
    ds_read_b64_tr_b16 a[214:215], v24 offset:33800
    ds_read_b64_tr_b16 a[228:229], v25 offset:32768
    ds_read_b64_tr_b16 a[230:231], v25 offset:33792
    ds_read_b64_tr_b16 a[244:245], v25 offset:32776
    ds_read_b64_tr_b16 a[246:247], v25 offset:33800
    s_waitcnt lgkmcnt(0)
    s_waitcnt vmcnt(8)
    s_barrier
    v_add_u32 v18, 65536, v18
    v_add_u32 v19, 65536, v19
    v_add_u32 v20, 65536, v20
    v_add_u32 v21, 65536, v21
    v_add_u32 v22, 65536, v22
    v_add_u32 v23, 65536, v23
    v_add_u32 v24, 65536, v24
    v_add_u32 v25, 65536, v25
    ds_read_b64_tr_b16 a[136:137], v22 offset:0
    ds_read_b64_tr_b16 a[138:139], v22 offset:1024
    ds_read_b64_tr_b16 a[152:153], v22 offset:8
    ds_read_b64_tr_b16 a[154:155], v22 offset:1032
    ds_read_b64_tr_b16 a[168:169], v23 offset:0
    ds_read_b64_tr_b16 a[170:171], v23 offset:1024
    ds_read_b64_tr_b16 a[184:185], v23 offset:8
    ds_read_b64_tr_b16 a[186:187], v23 offset:1032
    ds_read_b64_tr_b16 a[200:201], v24 offset:0
    ds_read_b64_tr_b16 a[202:203], v24 offset:1024
    ds_read_b64_tr_b16 a[216:217], v24 offset:8
    ds_read_b64_tr_b16 a[218:219], v24 offset:1032
    ds_read_b64_tr_b16 a[232:233], v25 offset:0
    ds_read_b64_tr_b16 a[234:235], v25 offset:1024
    ds_read_b64_tr_b16 a[248:249], v25 offset:8
    ds_read_b64_tr_b16 a[250:251], v25 offset:1032
    s_waitcnt lgkmcnt(0)
    s_waitcnt vmcnt(0)
    s_barrier
    ds_read_b64_tr_b16 a[140:141], v22 offset:32768
    ds_read_b64_tr_b16 a[142:143], v22 offset:33792
    ds_read_b64_tr_b16 a[156:157], v22 offset:32776
    ds_read_b64_tr_b16 a[158:159], v22 offset:33800
    ds_read_b64_tr_b16 a[172:173], v23 offset:32768
    ds_read_b64_tr_b16 a[174:175], v23 offset:33792
    ds_read_b64_tr_b16 a[188:189], v23 offset:32776
    ds_read_b64_tr_b16 a[190:191], v23 offset:33800
    ds_read_b64_tr_b16 a[204:205], v24 offset:32768
    ds_read_b64_tr_b16 a[206:207], v24 offset:33792
    ds_read_b64_tr_b16 a[220:221], v24 offset:32776
    ds_read_b64_tr_b16 a[222:223], v24 offset:33800
    ds_read_b64_tr_b16 a[236:237], v25 offset:32768
    ds_read_b64_tr_b16 a[238:239], v25 offset:33792
    ds_read_b64_tr_b16 a[252:253], v25 offset:32776
    ds_read_b64_tr_b16 a[254:255], v25 offset:33800
    s_waitcnt lgkmcnt(0)
    s_barrier
    s_add_u32 s53, s16, 2
    s_add_u32 s52, s16, 1
    s_cmp_eq_u32 s14, 4
    s_cbranch_scc1 at_mark
    v_bfe_u32 v11, v254, 1, 4
    v_lshlrev_b32 v11, 7, v11
    v_bfe_u32 v12, v254, 5, 2
    v_lshl_add_u32 v11, v12, 12, v11
    v_lshrrev_b32 v12, 7, v254
    v_lshl_add_u32 v11, v12, 11, v11
    s_cmp_eq_u32 s16, 0
    s_cbranch_scc1 at_rows
    v_lshrrev_b32 v11, 2, v254
    v_lshlrev_b32_e64 v11, 7, v11
    v_add_u32 v11, 8192, v11
at_rows:
    v_and_b32 v33, 0xffff0000, v112
    v_and_b32 v73, 0xffff0000, v116
    v_and_b32 v145, 0xffff0000, v120
    v_and_b32 v185, 0xffff0000, v124
    v_lshlrev_b32 v32, 16, v112
    v_lshlrev_b32 v72, 16, v116
    v_lshlrev_b32 v144, 16, v120
    v_lshlrev_b32 v184, 16, v124
    v_and_b32 v35, 0xffff0000, v113
    v_and_b32 v75, 0xffff0000, v117
    v_and_b32 v147, 0xffff0000, v121
    v_and_b32 v187, 0xffff0000, v125
    v_lshlrev_b32 v34, 16, v113
    v_lshlrev_b32 v74, 16, v117
    v_lshlrev_b32 v146, 16, v121
    v_lshlrev_b32 v186, 16, v125
    v_and_b32 v37, 0xffff0000, v114
    v_and_b32 v77, 0xffff0000, v118
    v_and_b32 v149, 0xffff0000, v122
    v_and_b32 v189, 0xffff0000, v126
    v_lshlrev_b32 v36, 16, v114
    v_lshlrev_b32 v76, 16, v118
    v_lshlrev_b32 v148, 16, v122
    v_lshlrev_b32 v188, 16, v126
    v_and_b32 v39, 0xffff0000, v115
    v_and_b32 v79, 0xffff0000, v119
    v_and_b32 v151, 0xffff0000, v123
    v_and_b32 v191, 0xffff0000, v127
    v_lshlrev_b32 v38, 16, v115
    v_lshlrev_b32 v78, 16, v119
    v_lshlrev_b32 v150, 16, v123
    v_lshlrev_b32 v190, 16, v127
    v_pk_add_f32 v[48:49], v[32:33], v[34:35]
    v_pk_add_f32 v[88:89], v[72:73], v[74:75]
    v_pk_add_f32 v[160:161], v[144:145], v[146:147]
    v_pk_add_f32 v[200:201], v[184:185], v[186:187]
    v_pk_mul_f32 v[52:53], v[32:33], v[32:33]
    v_pk_mul_f32 v[92:93], v[72:73], v[72:73]
    v_pk_mul_f32 v[164:165], v[144:145], v[144:145]
    v_pk_mul_f32 v[204:205], v[184:185], v[184:185]
    v_pk_add_f32 v[50:51], v[36:37], v[38:39]
    v_pk_add_f32 v[90:91], v[76:77], v[78:79]
    v_pk_add_f32 v[162:163], v[148:149], v[150:151]
    v_pk_add_f32 v[202:203], v[188:189], v[190:191]
    v_pk_mul_f32 v[54:55], v[34:35], v[34:35]
    v_pk_mul_f32 v[94:95], v[74:75], v[74:75]
    v_pk_mul_f32 v[166:167], v[146:147], v[146:147]
    v_pk_mul_f32 v[206:207], v[186:187], v[186:187]
    v_pk_fma_f32 v[52:53], v[36:37], v[36:37], v[52:53]
    v_pk_fma_f32 v[92:93], v[76:77], v[76:77], v[92:93]
    v_pk_fma_f32 v[164:165], v[148:149], v[148:149], v[164:165]
    v_pk_fma_f32 v[204:205], v[188:189], v[188:189], v[204:205]
    v_pk_fma_f32 v[54:55], v[38:39], v[38:39], v[54:55]
    v_pk_fma_f32 v[94:95], v[78:79], v[78:79], v[94:95]
    v_pk_fma_f32 v[166:167], v[150:151], v[150:151], v[166:167]
    v_pk_fma_f32 v[206:207], v[190:191], v[190:191], v[206:207]
    v_pk_add_f32 v[48:49], v[48:49], v[50:51]
    v_pk_add_f32 v[88:89], v[88:89], v[90:91]
    v_pk_add_f32 v[160:161], v[160:161], v[162:163]
    v_pk_add_f32 v[200:201], v[200:201], v[202:203]
    v_pk_add_f32 v[52:53], v[52:53], v[54:55]
    v_pk_add_f32 v[92:93], v[92:93], v[94:95]
    v_pk_add_f32 v[164:165], v[164:165], v[166:167]
    v_pk_add_f32 v[204:205], v[204:205], v[206:207]
    v_add_f32 v64, v48, v49
    v_add_f32 v104, v88, v89
    v_add_f32 v176, v160, v161
    v_add_f32 v216, v200, v201
    v_add_f32 v66, v52, v53
    v_add_f32 v106, v92, v93
    v_add_f32 v178, v164, v165
    v_add_f32 v218, v204, v205
    v_add_f32_dpp v64, v64, v64 row_ror:1 row_mask:0xf bank_mask:0xf
    v_add_f32_dpp v104, v104, v104 row_ror:1 row_mask:0xf bank_mask:0xf
    v_add_f32_dpp v176, v176, v176 row_ror:1 row_mask:0xf bank_mask:0xf
    v_add_f32_dpp v216, v216, v216 row_ror:1 row_mask:0xf bank_mask:0xf
    v_add_f32_dpp v66, v66, v66 row_ror:1 row_mask:0xf bank_mask:0xf
    v_add_f32_dpp v106, v106, v106 row_ror:1 row_mask:0xf bank_mask:0xf
    v_add_f32_dpp v178, v178, v178 row_ror:1 row_mask:0xf bank_mask:0xf
    v_add_f32_dpp v218, v218, v218 row_ror:1 row_mask:0xf bank_mask:0xf
    v_add_f32_dpp v64, v64, v64 row_ror:2 row_mask:0xf bank_mask:0xf
    v_add_f32_dpp v104, v104, v104 row_ror:2 row_mask:0xf bank_mask:0xf
    v_add_f32_dpp v176, v176, v176 row_ror:2 row_mask:0xf bank_mask:0xf
    v_add_f32_dpp v216, v216, v216 row_ror:2 row_mask:0xf bank_mask:0xf
    v_add_f32_dpp v66, v66, v66 row_ror:2 row_mask:0xf bank_mask:0xf
    v_add_f32_dpp v106, v106, v106 row_ror:2 row_mask:0xf bank_mask:0xf
    v_add_f32_dpp v178, v178, v178 row_ror:2 row_mask:0xf bank_mask:0xf
    v_add_f32_dpp v218, v218, v218 row_ror:2 row_mask:0xf bank_mask:0xf
    v_add_f32_dpp v64, v64, v64 row_ror:4 row_mask:0xf bank_mask:0xf
    v_add_f32_dpp v104, v104, v104 row_ror:4 row_mask:0xf bank_mask:0xf
    v_add_f32_dpp v176, v176, v176 row_ror:4 row_mask:0xf bank_mask:0xf
    v_add_f32_dpp v216, v216, v216 row_ror:4 row_mask:0xf bank_mask:0xf
    v_add_f32_dpp v66, v66, v66 row_ror:4 row_mask:0xf bank_mask:0xf
    v_add_f32_dpp v106, v106, v106 row_ror:4 row_mask:0xf bank_mask:0xf
    v_add_f32_dpp v178, v178, v178 row_ror:4 row_mask:0xf bank_mask:0xf
    v_add_f32_dpp v218, v218, v218 row_ror:4 row_mask:0xf bank_mask:0xf
    v_add_f32_dpp v64, v64, v64 row_ror:8 row_mask:0xf bank_mask:0xf
    v_add_f32_dpp v104, v104, v104 row_ror:8 row_mask:0xf bank_mask:0xf
    v_add_f32_dpp v176, v176, v176 row_ror:8 row_mask:0xf bank_mask:0xf
    v_add_f32_dpp v216, v216, v216 row_ror:8 row_mask:0xf bank_mask:0xf
    v_add_f32_dpp v66, v66, v66 row_ror:8 row_mask:0xf bank_mask:0xf
    v_add_f32_dpp v106, v106, v106 row_ror:8 row_mask:0xf bank_mask:0xf
    v_add_f32_dpp v178, v178, v178 row_ror:8 row_mask:0xf bank_mask:0xf
    v_add_f32_dpp v218, v218, v218 row_ror:8 row_mask:0xf bank_mask:0xf
    v_mov_b32 v65, v64
    v_mov_b32 v105, v104
    v_mov_b32 v177, v176
    v_mov_b32 v217, v216
    v_mov_b32 v67, v66
    v_mov_b32 v107, v106
    v_mov_b32 v179, v178
    v_mov_b32 v219, v218
    v_permlane16_swap_b32 v64, v65
    v_permlane16_swap_b32 v104, v105
    v_permlane16_swap_b32 v176, v177
    v_permlane16_swap_b32 v216, v217
    v_permlane16_swap_b32 v66, v67
    v_permlane16_swap_b32 v106, v107
    v_permlane16_swap_b32 v178, v179
    v_permlane16_swap_b32 v218, v219
    v_add_f32 v64, v64, v65
    v_add_f32 v104, v104, v105
    v_add_f32 v176, v176, v177
    v_add_f32 v216, v216, v217
    v_add_f32 v66, v66, v67
    v_add_f32 v106, v106, v107
    v_add_f32 v178, v178, v179
    v_add_f32 v218, v218, v219
    v_mov_b32 v65, v64
    v_mov_b32 v105, v104
    v_mov_b32 v177, v176
    v_mov_b32 v217, v216
    v_mov_b32 v67, v66
    v_mov_b32 v107, v106
    v_mov_b32 v179, v178
    v_mov_b32 v219, v218
    v_permlane32_swap_b32 v64, v65
    v_permlane32_swap_b32 v104, v105
    v_permlane32_swap_b32 v176, v177
    v_permlane32_swap_b32 v216, v217
    v_permlane32_swap_b32 v66, v67
    v_permlane32_swap_b32 v106, v107
    v_permlane32_swap_b32 v178, v179
    v_permlane32_swap_b32 v218, v219
    v_add_f32 v64, v64, v65
    v_add_f32 v104, v104, v105
    v_add_f32 v176, v176, v177
    v_add_f32 v216, v216, v217
    v_add_f32 v66, v66, v67
    v_add_f32 v106, v106, v107
    v_add_f32 v178, v178, v179
    v_add_f32 v218, v218, v219
    v_mul_f32 v64, 0x3b000000, v64
    v_mul_f32 v104, 0x3b000000, v104
    v_mul_f32 v176, 0x3b000000, v176
    v_mul_f32 v216, 0x3b000000, v216
    v_mul_f32 v66, 0x3b000000, v66
    v_mul_f32 v106, 0x3b000000, v106
    v_mul_f32 v178, 0x3b000000, v178
    v_mul_f32 v218, 0x3b000000, v218
    v_fma_f32 v66, -v64, v64, v66
    v_fma_f32 v106, -v104, v104, v106
    v_fma_f32 v178, -v176, v176, v178
    v_fma_f32 v218, -v216, v216, v218
    v_max_f32 v66, 0, v66
    v_max_f32 v106, 0, v106
    v_max_f32 v178, 0, v178
    v_max_f32 v218, 0, v218
    v_add_f32 v66, 0x3727c5ac, v66
    v_add_f32 v106, 0x3727c5ac, v106
    v_add_f32 v178, 0x3727c5ac, v178
    v_add_f32 v218, 0x3727c5ac, v218
    v_rsq_f32 v66, v66
    v_rsq_f32 v106, v106
    v_rsq_f32_e64 v178, v178
    v_rsq_f32_e64 v218, v218
    v_pk_add_f32 v[48:49], v[32:33], v[64:65] op_sel_hi:[1,0] neg_lo:[0,1] neg_hi:[0,1]
    v_pk_add_f32 v[88:89], v[72:73], v[104:105] op_sel_hi:[1,0] neg_lo:[0,1] neg_hi:[0,1]
    v_pk_add_f32 v[160:161], v[144:145], v[176:177] op_sel_hi:[1,0] neg_lo:[0,1] neg_hi:[0,1]
    v_pk_add_f32 v[200:201], v[184:185], v[216:217] op_sel_hi:[1,0] neg_lo:[0,1] neg_hi:[0,1]
    v_pk_add_f32 v[50:51], v[34:35], v[64:65] op_sel_hi:[1,0] neg_lo:[0,1] neg_hi:[0,1]
    v_pk_add_f32 v[90:91], v[74:75], v[104:105] op_sel_hi:[1,0] neg_lo:[0,1] neg_hi:[0,1]
    v_pk_add_f32 v[162:163], v[146:147], v[176:177] op_sel_hi:[1,0] neg_lo:[0,1] neg_hi:[0,1]
    v_pk_add_f32 v[202:203], v[186:187], v[216:217] op_sel_hi:[1,0] neg_lo:[0,1] neg_hi:[0,1]
    v_pk_add_f32 v[52:53], v[36:37], v[64:65] op_sel_hi:[1,0] neg_lo:[0,1] neg_hi:[0,1]
    v_pk_add_f32 v[92:93], v[76:77], v[104:105] op_sel_hi:[1,0] neg_lo:[0,1] neg_hi:[0,1]
    v_pk_add_f32 v[164:165], v[148:149], v[176:177] op_sel_hi:[1,0] neg_lo:[0,1] neg_hi:[0,1]
    v_pk_add_f32 v[204:205], v[188:189], v[216:217] op_sel_hi:[1,0] neg_lo:[0,1] neg_hi:[0,1]
    v_pk_add_f32 v[54:55], v[38:39], v[64:65] op_sel_hi:[1,0] neg_lo:[0,1] neg_hi:[0,1]
    v_pk_add_f32 v[94:95], v[78:79], v[104:105] op_sel_hi:[1,0] neg_lo:[0,1] neg_hi:[0,1]
    v_pk_add_f32 v[166:167], v[150:151], v[176:177] op_sel_hi:[1,0] neg_lo:[0,1] neg_hi:[0,1]
    v_pk_add_f32 v[206:207], v[190:191], v[216:217] op_sel_hi:[1,0] neg_lo:[0,1] neg_hi:[0,1]
    v_pk_mul_f32 v[48:49], v[48:49], v[66:67] op_sel_hi:[1,0]
    v_pk_mul_f32 v[88:89], v[88:89], v[106:107] op_sel_hi:[1,0]
    v_pk_mul_f32 v[160:161], v[160:161], v[178:179] op_sel_hi:[1,0]
    v_pk_mul_f32 v[200:201], v[200:201], v[218:219] op_sel_hi:[1,0]
    v_pk_mul_f32 v[50:51], v[50:51], v[66:67] op_sel_hi:[1,0]
    v_pk_mul_f32 v[90:91], v[90:91], v[106:107] op_sel_hi:[1,0]
    v_pk_mul_f32 v[162:163], v[162:163], v[178:179] op_sel_hi:[1,0]
    v_pk_mul_f32 v[202:203], v[202:203], v[218:219] op_sel_hi:[1,0]
    v_pk_mul_f32 v[52:53], v[52:53], v[66:67] op_sel_hi:[1,0]
    v_pk_mul_f32 v[92:93], v[92:93], v[106:107] op_sel_hi:[1,0]
    v_pk_mul_f32 v[164:165], v[164:165], v[178:179] op_sel_hi:[1,0]
    v_pk_mul_f32 v[204:205], v[204:205], v[218:219] op_sel_hi:[1,0]
    v_pk_mul_f32 v[54:55], v[54:55], v[66:67] op_sel_hi:[1,0]
    v_pk_mul_f32 v[94:95], v[94:95], v[106:107] op_sel_hi:[1,0]
    v_pk_mul_f32 v[166:167], v[166:167], v[178:179] op_sel_hi:[1,0]
    v_pk_mul_f32 v[206:207], v[206:207], v[218:219] op_sel_hi:[1,0]
    s_mul_i32 s23, s16, 0
wr_19:
    buffer_load_dwordx4 v[16:19], off, s[4:7], s23 offset:128 sc1
    s_waitcnt vmcnt(0)
    v_mov_b32_e64 v16, v19
    v_cmp_gt_u32 vcc, 0x80, v16
    s_cbranch_vccz wr_20
    s_sub_u32 s3, s3, 1
    s_cbranch_scc1 main_timeout
    s_sleep 4
    s_branch wr_19
    s_nop 0
    s_nop 0
    s_nop 0
    s_nop 0
wr_20:
    s_mov_b32 s22, 143802368
wa_22:
    buffer_load_dword v12, v11, s[8:11], s22 offen sc1
    s_waitcnt vmcnt(0)
    v_cmp_gt_u32_e64 vcc, s52, v12
    s_cbranch_vccz wa_23
    s_sub_u32 s3, s3, 1
    s_cbranch_scc1 main_timeout
    s_sleep 1
    s_branch wa_22
    s_nop 0
    s_nop 0
    s_nop 0
wa_23:
    v_lshlrev_b32 v3, 13, v254
    s_lshl_b32 s50, s50, 1
    s_add_u32 s50, s50, 127926272
    s_add_u32 s51, s50, 4096
    s_mov_b32 s22, 0x05040100
    s_mov_b32 s23, 0x07060302
    v_lshlrev_b32 v5, 2, v254
    v_add_u32 v5, 0, v5
    buffer_load_dwordx4 v[16:19], v3, s[8:11], s50 offen offset:0 sc1
    buffer_load_dwordx4 v[24:27], v3, s[8:11], s51 offen offset:0 sc1
    buffer_load_dwordx4 v[20:23], v3, s[8:11], s50 offen offset:16 sc1
    buffer_load_dwordx4 v[28:31], v3, s[8:11], s51 offen offset:16 sc1
    s_waitcnt vmcnt(2)
    v_perm_b32 v6, v24, v16, s22
    ds_write_b32 v5, v6 offset:0
    v_perm_b32 v7, v24, v16, s23
    ds_write_b32 v5, v7 offset:1024
    v_perm_b32 v6, v25, v17, s22
    ds_write_b32 v5, v6 offset:2048
    v_perm_b32 v7, v25, v17, s23
    ds_write_b32 v5, v7 offset:3072
    v_perm_b32 v6, v26, v18, s22
    ds_write_b32 v5, v6 offset:4096
    v_perm_b32 v7, v26, v18, s23
    ds_write_b32 v5, v7 offset:5120
    v_perm_b32 v6, v27, v19, s22
    ds_write_b32 v5, v6 offset:6144
    v_perm_b32 v7, v27, v19, s23
    ds_write_b32 v5, v7 offset:7168
    s_waitcnt vmcnt(0)
    v_perm_b32 v6, v28, v20, s22
    ds_write_b32 v5, v6 offset:8192
    v_perm_b32 v7, v28, v20, s23
    ds_write_b32 v5, v7 offset:9216
    v_perm_b32 v6, v29, v21, s22
    ds_write_b32 v5, v6 offset:10240
    v_perm_b32 v7, v29, v21, s23
    ds_write_b32 v5, v7 offset:11264
    v_perm_b32 v6, v30, v22, s22
    ds_write_b32 v5, v6 offset:12288
    v_perm_b32 v7, v30, v22, s23
    ds_write_b32 v5, v7 offset:13312
    v_perm_b32 v6, v31, v23, s22
    ds_write_b32 v5, v6 offset:14336
    v_perm_b32 v7, v31, v23, s23
    ds_write_b32 v5, v7 offset:15360
    v_add_u32_e64 v5, s49, v10
    v_add_u32_e64 v5, 0, v5
    s_add_u32 s50, s48, 130023424
    s_add_u32 s51, s48, 132120576
    s_add_u32 s49, s48, 136314880
    s_waitcnt lgkmcnt(0)
    s_barrier
    ds_read_b128 v[128:131], v5 offset:0
    ds_read_b128 v[132:135], v5 offset:1024
    ds_read_b128 v[136:139], v5 offset:2048
    ds_read_b128 v[140:143], v5 offset:3072
    s_waitcnt lgkmcnt(3)
    v_and_b32 v41, 0xffff0000, v128
    s_waitcnt lgkmcnt(2)
    v_and_b32 v81, 0xffff0000, v132
    s_waitcnt lgkmcnt(1)
    v_and_b32 v153, 0xffff0000, v136
    s_waitcnt lgkmcnt(0)
    v_and_b32 v193, 0xffff0000, v140
    v_lshlrev_b32 v40, 16, v128
    v_lshlrev_b32 v80, 16, v132
    v_lshlrev_b32 v152, 16, v136
    v_lshlrev_b32 v192, 16, v140
    v_and_b32 v43, 0xffff0000, v129
    v_and_b32 v83, 0xffff0000, v133
    v_and_b32 v155, 0xffff0000, v137
    v_and_b32 v195, 0xffff0000, v141
    v_lshlrev_b32 v42, 16, v129
    v_lshlrev_b32 v82, 16, v133
    v_lshlrev_b32 v154, 16, v137
    v_lshlrev_b32 v194, 16, v141
    v_and_b32 v45, 0xffff0000, v130
    v_and_b32 v85, 0xffff0000, v134
    v_and_b32 v157, 0xffff0000, v138
    v_and_b32 v197, 0xffff0000, v142
    v_lshlrev_b32 v44, 16, v130
    v_lshlrev_b32 v84, 16, v134
    v_lshlrev_b32 v156, 16, v138
    v_lshlrev_b32 v196, 16, v142
    v_and_b32 v47, 0xffff0000, v131
    v_and_b32 v87, 0xffff0000, v135
    v_and_b32 v159, 0xffff0000, v139
    v_and_b32 v199, 0xffff0000, v143
    v_lshlrev_b32 v46, 16, v131
    v_lshlrev_b32 v86, 16, v135
    v_lshlrev_b32 v158, 16, v139
    v_lshlrev_b32 v198, 16, v143
    v_pk_fma_f32 v[32:33], v[48:49], v[40:41], v[32:33]
    v_pk_fma_f32 v[72:73], v[88:89], v[80:81], v[72:73]
    v_pk_fma_f32 v[144:145], v[160:161], v[152:153], v[144:145]
    v_pk_fma_f32 v[184:185], v[200:201], v[192:193], v[184:185]
    v_pk_fma_f32 v[34:35], v[50:51], v[42:43], v[34:35]
    v_pk_fma_f32 v[74:75], v[90:91], v[82:83], v[74:75]
    v_pk_fma_f32 v[146:147], v[162:163], v[154:155], v[146:147]
    v_pk_fma_f32 v[186:187], v[202:203], v[194:195], v[186:187]
    v_pk_fma_f32 v[36:37], v[52:53], v[44:45], v[36:37]
    v_pk_fma_f32 v[76:77], v[92:93], v[84:85], v[76:77]
    v_pk_fma_f32 v[148:149], v[164:165], v[156:157], v[148:149]
    v_pk_fma_f32 v[188:189], v[204:205], v[196:197], v[188:189]
    v_pk_fma_f32 v[38:39], v[54:55], v[46:47], v[38:39]
    v_pk_fma_f32 v[78:79], v[94:95], v[86:87], v[78:79]
    v_pk_fma_f32 v[150:151], v[166:167], v[158:159], v[150:151]
    v_pk_fma_f32 v[190:191], v[206:207], v[198:199], v[190:191]
    v_cvt_pk_bf16_f32 v56, v32, v33
    v_cvt_pk_bf16_f32 v96, v72, v73
    v_cvt_pk_bf16_f32 v168, v144, v145
    v_cvt_pk_bf16_f32 v208, v184, v185
    v_cvt_pk_bf16_f32 v57, v34, v35
    v_cvt_pk_bf16_f32 v97, v74, v75
    v_cvt_pk_bf16_f32 v169, v146, v147
    v_cvt_pk_bf16_f32 v209, v186, v187
    v_cvt_pk_bf16_f32 v58, v36, v37
    v_cvt_pk_bf16_f32 v98, v76, v77
    v_cvt_pk_bf16_f32 v170, v148, v149
    v_cvt_pk_bf16_f32 v210, v188, v189
    v_cvt_pk_bf16_f32 v59, v38, v39
    v_cvt_pk_bf16_f32 v99, v78, v79
    v_cvt_pk_bf16_f32 v171, v150, v151
    v_cvt_pk_bf16_f32 v211, v190, v191
    v_and_b32 v33, 0xffff0000, v56
    v_and_b32 v73, 0xffff0000, v96
    v_and_b32 v145, 0xffff0000, v168
    v_and_b32 v185, 0xffff0000, v208
    v_lshlrev_b32 v32, 16, v56
    v_lshlrev_b32 v72, 16, v96
    v_lshlrev_b32 v144, 16, v168
    v_lshlrev_b32 v184, 16, v208
    v_and_b32 v35, 0xffff0000, v57
    v_and_b32 v75, 0xffff0000, v97
    v_and_b32 v147, 0xffff0000, v169
    v_and_b32 v187, 0xffff0000, v209
    v_lshlrev_b32 v34, 16, v57
    v_lshlrev_b32 v74, 16, v97
    v_lshlrev_b32 v146, 16, v169
    v_lshlrev_b32 v186, 16, v209
    v_and_b32 v37, 0xffff0000, v58
    v_and_b32 v77, 0xffff0000, v98
    v_and_b32 v149, 0xffff0000, v170
    v_and_b32 v189, 0xffff0000, v210
    v_lshlrev_b32 v36, 16, v58
    v_lshlrev_b32 v76, 16, v98
    v_lshlrev_b32 v148, 16, v170
    v_lshlrev_b32 v188, 16, v210
    v_and_b32 v39, 0xffff0000, v59
    v_and_b32 v79, 0xffff0000, v99
    v_and_b32 v151, 0xffff0000, v171
    v_and_b32 v191, 0xffff0000, v211
    v_lshlrev_b32 v38, 16, v59
    v_lshlrev_b32 v78, 16, v99
    v_lshlrev_b32 v150, 16, v171
    v_lshlrev_b32 v190, 16, v211
    v_pk_add_f32 v[48:49], v[32:33], v[34:35]
    v_pk_add_f32 v[88:89], v[72:73], v[74:75]
    v_pk_add_f32 v[160:161], v[144:145], v[146:147]
    v_pk_add_f32 v[200:201], v[184:185], v[186:187]
    v_pk_mul_f32 v[52:53], v[32:33], v[32:33]
    v_pk_mul_f32 v[92:93], v[72:73], v[72:73]
    v_pk_mul_f32 v[164:165], v[144:145], v[144:145]
    v_pk_mul_f32 v[204:205], v[184:185], v[184:185]
    v_pk_add_f32 v[50:51], v[36:37], v[38:39]
    v_pk_add_f32 v[90:91], v[76:77], v[78:79]
    v_pk_add_f32 v[162:163], v[148:149], v[150:151]
    v_pk_add_f32 v[202:203], v[188:189], v[190:191]
    v_pk_mul_f32 v[54:55], v[34:35], v[34:35]
    v_pk_mul_f32 v[94:95], v[74:75], v[74:75]
    v_pk_mul_f32 v[166:167], v[146:147], v[146:147]
    v_pk_mul_f32 v[206:207], v[186:187], v[186:187]
    v_pk_fma_f32 v[52:53], v[36:37], v[36:37], v[52:53]
    v_pk_fma_f32 v[92:93], v[76:77], v[76:77], v[92:93]
    v_pk_fma_f32 v[164:165], v[148:149], v[148:149], v[164:165]
    v_pk_fma_f32 v[204:205], v[188:189], v[188:189], v[204:205]
    v_pk_fma_f32 v[54:55], v[38:39], v[38:39], v[54:55]
    v_pk_fma_f32 v[94:95], v[78:79], v[78:79], v[94:95]
    v_pk_fma_f32 v[166:167], v[150:151], v[150:151], v[166:167]
    v_pk_fma_f32 v[206:207], v[190:191], v[190:191], v[206:207]
    v_pk_add_f32 v[48:49], v[48:49], v[50:51]
    v_pk_add_f32 v[88:89], v[88:89], v[90:91]
    v_pk_add_f32 v[160:161], v[160:161], v[162:163]
    v_pk_add_f32 v[200:201], v[200:201], v[202:203]
    v_pk_add_f32 v[52:53], v[52:53], v[54:55]
    v_pk_add_f32 v[92:93], v[92:93], v[94:95]
    v_pk_add_f32 v[164:165], v[164:165], v[166:167]
    v_pk_add_f32 v[204:205], v[204:205], v[206:207]
    v_add_f32 v64, v48, v49
    v_add_f32 v104, v88, v89
    v_add_f32 v176, v160, v161
    v_add_f32 v216, v200, v201
    v_add_f32 v66, v52, v53
    v_add_f32 v106, v92, v93
    v_add_f32 v178, v164, v165
    v_add_f32 v218, v204, v205
    v_add_f32_dpp v64, v64, v64 row_ror:1 row_mask:0xf bank_mask:0xf
    v_add_f32_dpp v104, v104, v104 row_ror:1 row_mask:0xf bank_mask:0xf
    v_add_f32_dpp v176, v176, v176 row_ror:1 row_mask:0xf bank_mask:0xf
    v_add_f32_dpp v216, v216, v216 row_ror:1 row_mask:0xf bank_mask:0xf
    v_add_f32_dpp v66, v66, v66 row_ror:1 row_mask:0xf bank_mask:0xf
    v_add_f32_dpp v106, v106, v106 row_ror:1 row_mask:0xf bank_mask:0xf
    v_add_f32_dpp v178, v178, v178 row_ror:1 row_mask:0xf bank_mask:0xf
    v_add_f32_dpp v218, v218, v218 row_ror:1 row_mask:0xf bank_mask:0xf
    v_add_f32_dpp v64, v64, v64 row_ror:2 row_mask:0xf bank_mask:0xf
    v_add_f32_dpp v104, v104, v104 row_ror:2 row_mask:0xf bank_mask:0xf
    v_add_f32_dpp v176, v176, v176 row_ror:2 row_mask:0xf bank_mask:0xf
    v_add_f32_dpp v216, v216, v216 row_ror:2 row_mask:0xf bank_mask:0xf
    v_add_f32_dpp v66, v66, v66 row_ror:2 row_mask:0xf bank_mask:0xf
    v_add_f32_dpp v106, v106, v106 row_ror:2 row_mask:0xf bank_mask:0xf
    v_add_f32_dpp v178, v178, v178 row_ror:2 row_mask:0xf bank_mask:0xf
    v_add_f32_dpp v218, v218, v218 row_ror:2 row_mask:0xf bank_mask:0xf
    v_add_f32_dpp v64, v64, v64 row_ror:4 row_mask:0xf bank_mask:0xf
    v_add_f32_dpp v104, v104, v104 row_ror:4 row_mask:0xf bank_mask:0xf
    v_add_f32_dpp v176, v176, v176 row_ror:4 row_mask:0xf bank_mask:0xf
    v_add_f32_dpp v216, v216, v216 row_ror:4 row_mask:0xf bank_mask:0xf
    v_add_f32_dpp v66, v66, v66 row_ror:4 row_mask:0xf bank_mask:0xf
    v_add_f32_dpp v106, v106, v106 row_ror:4 row_mask:0xf bank_mask:0xf
    v_add_f32_dpp v178, v178, v178 row_ror:4 row_mask:0xf bank_mask:0xf
    v_add_f32_dpp v218, v218, v218 row_ror:4 row_mask:0xf bank_mask:0xf
    v_add_f32_dpp v64, v64, v64 row_ror:8 row_mask:0xf bank_mask:0xf
    v_add_f32_dpp v104, v104, v104 row_ror:8 row_mask:0xf bank_mask:0xf
    v_add_f32_dpp v176, v176, v176 row_ror:8 row_mask:0xf bank_mask:0xf
    v_add_f32_dpp v216, v216, v216 row_ror:8 row_mask:0xf bank_mask:0xf
    v_add_f32_dpp v66, v66, v66 row_ror:8 row_mask:0xf bank_mask:0xf
    v_add_f32_dpp v106, v106, v106 row_ror:8 row_mask:0xf bank_mask:0xf
    v_add_f32_dpp v178, v178, v178 row_ror:8 row_mask:0xf bank_mask:0xf
    v_add_f32_dpp v218, v218, v218 row_ror:8 row_mask:0xf bank_mask:0xf
    v_mov_b32 v65, v64
    v_mov_b32 v105, v104
    v_mov_b32 v177, v176
    v_mov_b32 v217, v216
    v_mov_b32 v67, v66
    v_mov_b32 v107, v106
    v_mov_b32 v179, v178
    v_mov_b32 v219, v218
    v_permlane16_swap_b32 v64, v65
    v_permlane16_swap_b32 v104, v105
    v_permlane16_swap_b32 v176, v177
    v_permlane16_swap_b32 v216, v217
    v_permlane16_swap_b32 v66, v67
    v_permlane16_swap_b32 v106, v107
    v_permlane16_swap_b32 v178, v179
    v_permlane16_swap_b32 v218, v219
    v_add_f32 v64, v64, v65
    v_add_f32 v104, v104, v105
    v_add_f32 v176, v176, v177
    v_add_f32 v216, v216, v217
    v_add_f32 v66, v66, v67
    v_add_f32 v106, v106, v107
    v_add_f32 v178, v178, v179
    v_add_f32 v218, v218, v219
    v_mov_b32 v65, v64
    v_mov_b32 v105, v104
    v_mov_b32 v177, v176
    v_mov_b32 v217, v216
    v_mov_b32 v67, v66
    v_mov_b32 v107, v106
    v_mov_b32 v179, v178
    v_mov_b32 v219, v218
    v_permlane32_swap_b32 v64, v65
    v_permlane32_swap_b32 v104, v105
    v_permlane32_swap_b32 v176, v177
    v_permlane32_swap_b32 v216, v217
    v_permlane32_swap_b32 v66, v67
    v_permlane32_swap_b32 v106, v107
    v_permlane32_swap_b32 v178, v179
    v_permlane32_swap_b32 v218, v219
    v_add_f32 v64, v64, v65
    v_add_f32 v104, v104, v105
    v_add_f32 v176, v176, v177
    v_add_f32 v216, v216, v217
    v_add_f32 v66, v66, v67
    v_add_f32 v106, v106, v107
    v_add_f32 v178, v178, v179
    v_add_f32 v218, v218, v219
    v_mul_f32 v64, 0x3b000000, v64
    v_mul_f32 v104, 0x3b000000, v104
    v_mul_f32 v176, 0x3b000000, v176
    v_mul_f32 v216, 0x3b000000, v216
    v_mul_f32 v66, 0x3b000000, v66
    v_mul_f32 v106, 0x3b000000, v106
    v_mul_f32 v178, 0x3b000000, v178
    v_mul_f32 v218, 0x3b000000, v218
    v_fma_f32 v66, -v64, v64, v66
    v_fma_f32 v106, -v104, v104, v106
    v_fma_f32 v178, -v176, v176, v178
    v_fma_f32 v218, -v216, v216, v218
    v_max_f32 v66, 0, v66
    v_max_f32 v106, 0, v106
    v_max_f32 v178, 0, v178
    v_max_f32 v218, 0, v218
    v_add_f32 v66, 0x3727c5ac, v66
    v_add_f32 v106, 0x3727c5ac, v106
    v_add_f32 v178, 0x3727c5ac, v178
    v_add_f32 v218, 0x3727c5ac, v218
    v_rsq_f32 v66, v66
    v_rsq_f32 v106, v106
    v_rsq_f32_e64 v178, v178
    v_rsq_f32_e64 v218, v218
    v_pk_add_f32 v[48:49], v[32:33], v[64:65] op_sel_hi:[1,0] neg_lo:[0,1] neg_hi:[0,1]
    v_pk_add_f32 v[88:89], v[72:73], v[104:105] op_sel_hi:[1,0] neg_lo:[0,1] neg_hi:[0,1]
    v_pk_add_f32 v[160:161], v[144:145], v[176:177] op_sel_hi:[1,0] neg_lo:[0,1] neg_hi:[0,1]
    v_pk_add_f32 v[200:201], v[184:185], v[216:217] op_sel_hi:[1,0] neg_lo:[0,1] neg_hi:[0,1]
    v_pk_add_f32 v[50:51], v[34:35], v[64:65] op_sel_hi:[1,0] neg_lo:[0,1] neg_hi:[0,1]
    v_pk_add_f32 v[90:91], v[74:75], v[104:105] op_sel_hi:[1,0] neg_lo:[0,1] neg_hi:[0,1]
    v_pk_add_f32 v[162:163], v[146:147], v[176:177] op_sel_hi:[1,0] neg_lo:[0,1] neg_hi:[0,1]
    v_pk_add_f32 v[202:203], v[186:187], v[216:217] op_sel_hi:[1,0] neg_lo:[0,1] neg_hi:[0,1]
    v_pk_add_f32 v[52:53], v[36:37], v[64:65] op_sel_hi:[1,0] neg_lo:[0,1] neg_hi:[0,1]
    v_pk_add_f32 v[92:93], v[76:77], v[104:105] op_sel_hi:[1,0] neg_lo:[0,1] neg_hi:[0,1]
    v_pk_add_f32 v[164:165], v[148:149], v[176:177] op_sel_hi:[1,0] neg_lo:[0,1] neg_hi:[0,1]
    v_pk_add_f32 v[204:205], v[188:189], v[216:217] op_sel_hi:[1,0] neg_lo:[0,1] neg_hi:[0,1]
    v_pk_add_f32 v[54:55], v[38:39], v[64:65] op_sel_hi:[1,0] neg_lo:[0,1] neg_hi:[0,1]
    v_pk_add_f32 v[94:95], v[78:79], v[104:105] op_sel_hi:[1,0] neg_lo:[0,1] neg_hi:[0,1]
    v_pk_add_f32 v[166:167], v[150:151], v[176:177] op_sel_hi:[1,0] neg_lo:[0,1] neg_hi:[0,1]
    v_pk_add_f32 v[206:207], v[190:191], v[216:217] op_sel_hi:[1,0] neg_lo:[0,1] neg_hi:[0,1]
    v_pk_mul_f32 v[48:49], v[48:49], v[66:67] op_sel_hi:[1,0]
    v_pk_mul_f32 v[88:89], v[88:89], v[106:107] op_sel_hi:[1,0]
    v_pk_mul_f32 v[160:161], v[160:161], v[178:179] op_sel_hi:[1,0]
    v_pk_mul_f32 v[200:201], v[200:201], v[218:219] op_sel_hi:[1,0]
    v_pk_mul_f32 v[50:51], v[50:51], v[66:67] op_sel_hi:[1,0]
    v_pk_mul_f32 v[90:91], v[90:91], v[106:107] op_sel_hi:[1,0]
    v_pk_mul_f32 v[162:163], v[162:163], v[178:179] op_sel_hi:[1,0]
    v_pk_mul_f32 v[202:203], v[202:203], v[218:219] op_sel_hi:[1,0]
    v_pk_mul_f32 v[52:53], v[52:53], v[66:67] op_sel_hi:[1,0]
    v_pk_mul_f32 v[92:93], v[92:93], v[106:107] op_sel_hi:[1,0]
    v_pk_mul_f32 v[164:165], v[164:165], v[178:179] op_sel_hi:[1,0]
    v_pk_mul_f32 v[204:205], v[204:205], v[218:219] op_sel_hi:[1,0]
    v_pk_mul_f32 v[54:55], v[54:55], v[66:67] op_sel_hi:[1,0]
    v_pk_mul_f32 v[94:95], v[94:95], v[106:107] op_sel_hi:[1,0]
    v_pk_mul_f32 v[166:167], v[166:167], v[178:179] op_sel_hi:[1,0]
    v_pk_mul_f32 v[206:207], v[206:207], v[218:219] op_sel_hi:[1,0]
    v_cvt_pk_bf16_f32 v60, v48, v49
    v_cvt_pk_bf16_f32 v100, v88, v89
    v_cvt_pk_bf16_f32 v172, v160, v161
    v_cvt_pk_bf16_f32 v212, v200, v201
    v_cvt_pk_bf16_f32 v61, v50, v51
    v_cvt_pk_bf16_f32 v101, v90, v91
    v_cvt_pk_bf16_f32 v173, v162, v163
    v_cvt_pk_bf16_f32 v213, v202, v203
    v_cvt_pk_bf16_f32 v62, v52, v53
    v_cvt_pk_bf16_f32 v102, v92, v93
    v_cvt_pk_bf16_f32 v174, v164, v165
    v_cvt_pk_bf16_f32 v214, v204, v205
    v_cvt_pk_bf16_f32 v63, v54, v55
    v_cvt_pk_bf16_f32 v103, v94, v95
    v_cvt_pk_bf16_f32 v175, v166, v167
    v_cvt_pk_bf16_f32 v215, v206, v207
    buffer_store_dwordx4 v[60:63], v10, s[8:11], s49 offen offset:0 sc1
    buffer_store_dwordx4 v[100:103], v10, s[8:11], s49 offen offset:1024 sc1
    buffer_store_dwordx4 v[172:175], v10, s[8:11], s49 offen offset:2048 sc1
    buffer_store_dwordx4 v[212:215], v10, s[8:11], s49 offen offset:3072 sc1
    buffer_store_dwordx4 v[128:131], v10, s[8:11], s50 offen offset:0 sc1
    buffer_store_dwordx4 v[56:59], v10, s[8:11], s51 offen offset:0 sc1
    buffer_store_dwordx4 v[132:135], v10, s[8:11], s50 offen offset:1024 sc1
    buffer_store_dwordx4 v[96:99], v10, s[8:11], s51 offen offset:1024 sc1
    buffer_store_dwordx4 v[136:139], v10, s[8:11], s50 offen offset:2048 sc1
    buffer_store_dwordx4 v[168:171], v10, s[8:11], s51 offen offset:2048 sc1
    buffer_store_dwordx4 v[140:143], v10, s[8:11], s50 offen offset:3072 sc1
    buffer_store_dwordx4 v[208:211], v10, s[8:11], s51 offen offset:3072 sc1
    s_cmp_lg_u32 s16, 0
    s_cbranch_scc1 at_rest
at_mark:
    s_and_b32 s22, s14, 1
    s_lshl_b32 s22, s22, 15
    s_lshl_b32 s23, s13, 10
    s_add_u32 s22, s22, s23
    s_lshl_b32 s23, s12, 19
    s_add_u32 s22, s22, s23
    v_mov_b32 v16, s19
    v_mov_b32 v17, s19
    v_mov_b32 v18, s19
    v_mov_b32 v19, s19
    s_add_u32 s23, s22, 138412032
    buffer_store_dwordx4 v[16:19], v10, s[8:11], s23 offen sc1
    s_add_u32 s23, s22, 134217728
    buffer_store_dwordx4 v[16:19], v10, s[8:11], s23 offen sc1
    s_add_u32 s23, s22, 138477568
    buffer_store_dwordx4 v[16:19], v10, s[8:11], s23 offen sc1
    s_add_u32 s23, s22, 134283264
    buffer_store_dwordx4 v[16:19], v10, s[8:11], s23 offen sc1
    s_add_u32 s23, s22, 138543104
    buffer_store_dwordx4 v[16:19], v10, s[8:11], s23 offen sc1
    s_add_u32 s23, s22, 134348800
    buffer_store_dwordx4 v[16:19], v10, s[8:11], s23 offen sc1
    s_add_u32 s23, s22, 138608640
    buffer_store_dwordx4 v[16:19], v10, s[8:11], s23 offen sc1
    s_add_u32 s23, s22, 134414336
    buffer_store_dwordx4 v[16:19], v10, s[8:11], s23 offen sc1
    s_add_u32 s23, s22, 138674176
    buffer_store_dwordx4 v[16:19], v10, s[8:11], s23 offen sc1
    s_add_u32 s23, s22, 134479872
    buffer_store_dwordx4 v[16:19], v10, s[8:11], s23 offen sc1
    s_add_u32 s23, s22, 138739712
    buffer_store_dwordx4 v[16:19], v10, s[8:11], s23 offen sc1
    s_add_u32 s23, s22, 134545408
    buffer_store_dwordx4 v[16:19], v10, s[8:11], s23 offen sc1
    s_add_u32 s23, s22, 138805248
    buffer_store_dwordx4 v[16:19], v10, s[8:11], s23 offen sc1
    s_add_u32 s23, s22, 134610944
    buffer_store_dwordx4 v[16:19], v10, s[8:11], s23 offen sc1
    s_add_u32 s23, s22, 138870784
    buffer_store_dwordx4 v[16:19], v10, s[8:11], s23 offen sc1
    s_add_u32 s23, s22, 134676480
    buffer_store_dwordx4 v[16:19], v10, s[8:11], s23 offen sc1
at_rest:
    s_and_b32 s22, s14, 3
    s_lshl_b32 s22, s22, 21
    s_lshl_b32 s23, s13, 15
    s_add_u32 s22, s22, s23
    s_lshl_b32 s23, s12, 8
    s_add_u32 s22, s22, s23
    s_add_u32 s22, s22, 117440512
    v_lshrrev_b32_e64 v12, 1, v0
    v_lshlrev_b32_e64 v12, 10, v12
    v_and_b32 v13, 1, v0
    v_lshl_add_u32 v12, v13, 7, v12
    buffer_load_dword v13, v12, s[8:11], s22 offen sc1
    s_waitcnt vmcnt(0)
    s_barrier
    s_cmp_lg_u32 s12, 0
    s_cbranch_scc1 ann_24
    v_mov_b32_e64 v1, s53
    buffer_store_dword v1, off, s[8:11], s55 sc1
ann_24:
    s_mul_i32 s23, s16, 8
wr_25:
    buffer_load_dwordx4 v[16:19], off, s[4:7], s23 offset:128 sc1
    s_waitcnt vmcnt(0)
    s_cmp_eq_u32 s16, 0
    s_cselect_b64 vcc, -1, 0
    v_cndmask_b32 v18, v18, v19, vcc
    v_min_u32_e64 v16, v16, v18
    v_cmp_gt_u32 vcc, 0x80, v16
    s_cbranch_vccz wr_26
    s_sub_u32 s3, s3, 1
    s_cbranch_scc1 main_timeout
    s_sleep 4
    s_branch wr_25
    s_nop 0
    s_nop 0
    s_nop 0
wr_26:
    buffer_load_dword v17, off, s[4:7], 0 offset:132 sc1
    s_waitcnt vmcnt(0)
wr_27:
    v_readfirstlane_b32 s22, v17
    s_nop 0
    s_bitcmp0_b32 s22, s14
    s_cselect_b32 s15, 1, 0
    v_lshlrev_b32 v1, 4, v0
    v_and_b32 v4, 31, v0
    v_lshlrev_b32 v4, 7, v4
    s_and_b32 s17, s14, 1
    s_and_b32 s33, s12, 1
    s_lshr_b32 s34, s12, 1
    v_lshrrev_b32 v5, 5, v0
    v_lshlrev_b32_e64 v2, 13, v5
    v_bfe_u32 v5, v0, 3, 2
    v_lshl_add_u32 v2, v5, 10, v2
    v_lshrrev_b32 v5, 3, v0
    v_and_b32 v5, 6, v5
    v_xor_b32 v5, v5, v0
    v_and_b32 v5, 7, v5
    v_lshl_add_u32 v2, v5, 4, v2
    v_and_b32 v252, 15, v0
    v_lshlrev_b32 v252, 7, v252
    v_lshrrev_b32 v5, 4, v0
    v_and_b32 v253, 6, v0
    v_xor_b32_e64 v5, v5, v253
    v_lshl_add_u32 v252, v5, 4, v252
    v_xor_b32 v253, 64, v252
    s_lshl_b32 s22, s12, 11
    s_add_u32 s22, s22, 32768
    v_add_u32 v8, s22, v1
    s_lshl_b32 s22, s33, 10
    s_add_u32 s23, s22, 32768
    v_add_u32 v9, s23, v1
    s_lshl_b32 s23, s34, 12
    s_add_u32 s22, s22, s23
    s_add_u32 s22, s22, 40960
    v_add_u32 v10, s22, v1
    v_add_u32 v7, 40960, v1
    v_add_u32 v11, 65536, v1
    s_lshl_b32 s23, s34, 13
    v_add_u32 v3, s23, v11
    s_lshl_b32 s23, s34, 12
    v_add_u32 v254, s23, v11
    v_and_b32 v6, 15, v0
    v_lshlrev_b32 v12, 4, v6
    v_lshrrev_b32 v5, 4, v0
    v_lshl_add_u32 v12, v5, 18, v12
    s_lshl_b32 s22, s13, 10
    s_lshl_b32 s23, s12, 8
    s_add_u32 s22, s22, s23
    v_add_u32 v12, s22, v12
    v_and_b32 v6, 15, v0
    v_lshlrev_b32 v13, 4, v6
    v_lshl_add_u32 v13, v5, 10, v13
    s_lshl_b32 s22, s13, 15
    s_add_u32 s22, s22, s23
    v_add_u32 v13, s22, v13
    v_bfe_u32 v14, v0, 2, 2
    v_lshlrev_b32 v14, 5, v14
    v_lshl_add_u32 v14, v5, 8, v14
    v_and_b32 v15, 3, v0
    v_lshl_add_u32 v14, v15, 2, v14
    s_lshl_b32 s22, s12, 9
    s_add_u32 s22, s22, 49152
    v_add_u32 v14, s22, v14
    v_lshlrev_b32 v15, 5, v0
    v_add_u32 v15, 49152, v15
    v_mov_b32 v16, 0
    v_mov_b32 v112, 0x3f80
    v_cmp_eq_u32 vcc, 0, v6
    s_nop 1
    v_cndmask_b32 v16, v16, v112, vcc
    v_mov_b32 v112, 0x3f800000
    v_cmp_eq_u32 vcc, 1, v6
    s_nop 1
    v_cndmask_b32 v16, v16, v112, vcc
    v_mov_b32 v17, 0
    v_mov_b32 v112, 0x3f80
    v_cmp_eq_u32 vcc, 2, v6
    s_nop 1
    v_cndmask_b32 v17, v17, v112, vcc
    v_mov_b32 v112, 0x3f800000
    v_cmp_eq_u32 vcc, 3, v6
    s_nop 1
    v_cndmask_b32 v17, v17, v112, vcc
    v_mov_b32 v18, 0
    v_mov_b32 v112, 0x3f80
    v_cmp_eq_u32 vcc, 4, v6
    s_nop 1
    v_cndmask_b32 v18, v18, v112, vcc
    v_mov_b32 v112, 0x3f800000
    v_cmp_eq_u32 vcc, 5, v6
    s_nop 1
    v_cndmask_b32 v18, v18, v112, vcc
    v_mov_b32 v19, 0
    v_mov_b32 v112, 0x3f80
    v_cmp_eq_u32 vcc, 6, v6
    s_nop 1
    v_cndmask_b32 v19, v19, v112, vcc
    v_mov_b32 v112, 0x3f800000
    v_cmp_eq_u32 vcc, 7, v6
    s_nop 0
    s_nop 0
    v_cndmask_b32 v19, v19, v112, vcc
    v_bfe_u32 v6, v0, 2, 2
    v_lshlrev_b32 v6, 3, v6
    v_and_b32 v112, 3, v0
    v_add_u32 v6, v6, v112
    s_lshl_b32 s22, s33, 2
    v_add_u32 v6, s22, v6
    v_lshlrev_b32 v5, 3, v5
    v_sub_u32 v6, v6, v5
    v_mov_b32 v112, 0xf149f2ca
    v_cmp_gt_i32 vcc, 0, v6
    s_nop 1
    v_cndmask_b32 v20, 0, v112, vcc
    v_cmp_gt_i32 vcc, 1, v6
    s_nop 1
    v_cndmask_b32 v21, 0, v112, vcc
    v_cmp_gt_i32 vcc, 2, v6
    s_nop 1
    v_cndmask_b32 v22, 0, v112, vcc
    v_cmp_gt_i32 vcc, 3, v6
    s_nop 1
    v_cndmask_b32 v23, 0, v112, vcc
    v_cmp_gt_i32 vcc, 4, v6
    s_nop 1
    v_cndmask_b32 v24, 0, v112, vcc
    v_cmp_gt_i32 vcc, 5, v6
    s_nop 1
    v_cndmask_b32 v25, 0, v112, vcc
    v_cmp_gt_i32 vcc, 6, v6
    s_nop 1
    v_cndmask_b32 v26, 0, v112, vcc
    v_cmp_gt_i32 vcc, 7, v6
    s_nop 1
    v_cndmask_b32 v27, 0, v112, vcc
    v_mov_b32 v100, 0
    v_mov_b32_e64 v104, 0
    v_mov_b32_e64 v101, 0
    v_mov_b32_e64 v105, 0
    v_mov_b32_e64 v102, 0
    v_mov_b32_e64 v106, 0
    v_mov_b32_e64 v103, 0
    v_mov_b32_e64 v107, 0
    s_lshl_b32 s20, s16, 21
    s_add_u32 s20, s20, 136314880
    s_lshr_b32 s23, s12, 1
    s_lshl_b32 s23, s23, 12
    s_add_u32 s20, s20, s23
    s_and_b32 s23, s12, 1
    s_lshl_b32 s23, s23, 14
    s_add_u32 s20, s20, s23
    s_lshl_b32 s21, s12, 10
    s_lshl_b32 s23, s12, 1
    s_add_u32 s23, s23, s13
    s_and_b32 s23, s23, 0
    s_lshl_b32 s23, s23, 7
    s_add_u32 s20, s20, s23
    s_lshl_b32 s23, s23, 5
    s_add_u32 s21, s21, s23
    s_lshl_b32 s23, s17, 15
    s_add_u32 s20, s20, s23
    s_lshl_b32 s39, s13, 10
    s_add_u32 s39, s39, s23
    s_sub_u32 s39, s39, 65536
    s_lshl_b32 s24, s16, 13
    s_add_u32 s24, s24, 143720448
    s_lshl_b32 s23, s17, 12
    s_add_u32 s24, s24, s23
    s_mul_i32 s22, s16, 16777216
    s_mul_i32 s23, s13, 8192
    s_add_u32 s22, s22, s23
    s_mul_i32 s23, s17, 262144
    s_add_u32 s22, s22, s23
    s_lshl_b32 s23, s12, 11
    s_add_u32 s22, s22, s23
    s_add_u32 s33, s23, 81920
    s_lshl_b32 s29, s23, 1
    s_add_u32 s29, s29, 65536
    s_add_u32 s30, s22, 75497472
    s_lshl_b32 s28, s22, 1
    s_add_u32 s28, s28, 0
    s_lshl_b32 s22, s16, 14
    s_lshl_b32 s23, s13, 9
    s_add_u32 s22, s22, s23
    s_lshl_b32 s23, s12, 7
    s_add_u32 s22, s22, s23
    s_add_u32 s31, s22, 143654912
    s_add_u32 s32, s22, 143687680
    s_and_b32 s22, s14, 3
    s_lshl_b32 s35, s22, 21
    s_add_u32 s35, s35, 117440512
    s_lshl_b32 s36, s22, 14
    s_lshl_b32 s23, s12, 12
    s_add_u32 s36, s36, s23
    s_add_u32 s36, s36, 143736832
    s_lshl_b32 s23, s13, 7
    s_add_u32 s37, s36, s23
    s_mov_b32 s38, 0
    s_mov_b32 s49, s17
    s_mov_b32 s48, 0
    s_mov_b32 s50, 0
    s_mov_b32 s51, 0
    s_mov_b32 s52, 0
    s_mov_b32 s53, 0
    v_mov_b32 v110, 0
    s_bfe_u32 s34, s13, 0x10002
    s_xor_b32 s34, s34, 1
    s_and_b32 s34, s34, 1
    v_add_u32_e64 v255, s33, v1
at_kv0:
    buffer_load_dword v109, off, s[8:11], s31 sc1
    s_waitcnt vmcnt(0)
    v_cmp_ge_u32_e64 vcc, s49, v109
    s_cbranch_vccz at_kv0go
    s_sub_u32 s3, s3, 1
    s_cbranch_scc1 main_timeout
    s_sleep 4
    s_branch at_kv0
    s_nop 0
    s_nop 0
    s_nop 0
    s_nop 0
    s_nop 0
    s_nop 0
at_kv0go:
    s_add_u32 m0, s21, 0
    s_nop 0
    buffer_load_dwordx4 v2, s[8:11], s20 offen offset:0 sc1 lds
    s_add_u32 m0, s21, 3968
    s_nop 0
    buffer_load_dwordx4 v2, s[8:11], s20 offen offset:128 sc1 lds
    s_add_u32 m0, s21, 7936
    s_nop 0
    buffer_load_dwordx4 v2, s[8:11], s20 offen offset:256 sc1 lds
    s_add_u32 m0, s21, 11904
    s_nop 0
    buffer_load_dwordx4 v2, s[8:11], s20 offen offset:384 sc1 lds
    s_add_u32 m0, s21, 15872
    s_nop 0
    buffer_load_dwordx4 v2, s[8:11], s20 offen offset:512 sc1 lds
    s_add_u32 m0, s21, 19840
    s_nop 0
    buffer_load_dwordx4 v2, s[8:11], s20 offen offset:640 sc1 lds
    s_add_u32 m0, s21, 23808
    s_nop 0
    buffer_load_dwordx4 v2, s[8:11], s20 offen offset:768 sc1 lds
    s_add_u32 m0, s21, 27776
    s_nop 0
    buffer_load_dwordx4 v2, s[8:11], s20 offen offset:896 sc1 lds
    s_mov_b32 m0, s29
    s_nop 0
    buffer_load_dwordx4 v1, s[8:11], s28 offen offset:0 sc1 lds
    s_mov_b32 m0, s29
    s_nop 0
    buffer_load_dwordx4 v1, s[8:11], s28 offen offset:1024 sc1 lds
    s_mov_b32 m0, s29
    s_nop 0
    buffer_load_dwordx4 v1, s[8:11], s28 offen offset:2048 sc1 lds
    s_mov_b32 m0, s29
    s_nop 0
    buffer_load_dwordx4 v1, s[8:11], s28 offen offset:3072 sc1 lds
    s_waitcnt vmcnt(0)
    s_barrier
    ds_read_b128 v[180:183], v252 offset:2048
    ds_read_b128 v[188:191], v253 offset:2048
    ds_read_b128 v[176:179], v252 offset:0
    ds_read_b128 v[192:195], v252 offset:4096
    ds_read_b128 v[184:187], v253 offset:0
    ds_read_b128 v[52:55], v11 offset:0
    ds_read_b128 v[204:207], v253 offset:6144
    ds_read_b128 v[200:203], v253 offset:4096
    ds_read_b128 v[68:71], v11 offset:8192
    ds_read_b128 v[72:75], v11 offset:9216
    s_waitcnt lgkmcnt(9)
    v_mfma_f32_16x16x32_bf16 v[216:219], a[0:3], v[180:183], 0
    s_waitcnt lgkmcnt(8)
    v_mfma_f32_16x16x32_bf16 v[216:219], a[4:7], v[188:191], v[216:219]
    ds_read_b128 v[196:199], v252 offset:6144
    s_waitcnt lgkmcnt(8)
    v_mfma_f32_16x16x32_bf16 v[208:211], a[0:3], v[176:179], 0
    s_nop 0
    v_mfma_f32_16x16x32_bf16 v[212:215], a[64:67], v[176:179], 0
    ds_read_b128 v[176:179], v252 offset:8192
    v_mfma_f32_16x16x32_bf16 v[220:223], a[64:67], v[180:183], 0
    v_mfma_f32_16x16x32_bf16 v[220:223], a[68:71], v[188:191], v[220:223]
    ds_read_b128 v[180:183], v252 offset:10240
    s_waitcnt lgkmcnt(8)
    v_mfma_f32_16x16x32_bf16 v[208:211], a[4:7], v[184:187], v[208:211]
    ds_read_b128 v[92:95], v3 offset:6144
    v_mfma_f32_16x16x32_bf16 v[208:211], a[8:11], v[192:195], v[208:211]
    s_waitcnt lgkmcnt(6)
    v_mfma_f32_16x16x32_bf16 v[208:211], a[12:15], v[200:203], v[208:211]
    ds_read_b128 v[188:191], v253 offset:10240
    v_mfma_f32_16x16x32_bf16 v[212:215], a[68:71], v[184:187], v[212:215]
    v_mfma_f32_16x16x32_bf16 v[212:215], a[72:75], v[192:195], v[212:215]
    ds_read_b128 v[184:187], v253 offset:8192
    s_waitcnt lgkmcnt(5)
    v_mfma_f32_16x16x32_bf16 v[216:219], a[8:11], v[196:199], v[216:219]
    ds_read_b128 v[192:195], v252 offset:12288
    v_mfma_f32_16x16x32_bf16 v[220:223], a[72:75], v[196:199], v[220:223]
    s_nop 0
    v_mfma_f32_16x16x32_bf16 v[212:215], a[76:79], v[200:203], v[212:215]
    s_waitcnt lgkmcnt(5)
    v_mfma_f32_16x16x32_bf16 v[212:215], a[80:83], v[176:179], v[212:215]
    ds_read_b128 v[200:203], v253 offset:12288
    v_mfma_f32_16x16x32_bf16 v[220:223], a[76:79], v[204:207], v[220:223]
    ds_read_b128 v[88:91], v3 offset:3072
    s_waitcnt lgkmcnt(3)
    v_mfma_f32_16x16x32_bf16 v[212:215], a[84:87], v[184:187], v[212:215]
    ds_read_b128 v[196:199], v252 offset:14336
    v_mfma_f32_16x16x32_bf16 v[216:219], a[12:15], v[204:207], v[216:219]
    ds_read_b128 v[204:207], v253 offset:14336
    v_mfma_f32_16x16x32_bf16 v[208:211], a[16:19], v[176:179], v[208:211]
    v_mfma_f32_16x16x32_bf16 v[208:211], a[20:23], v[184:187], v[208:211]
    ds_read_b128 v[184:187], v253 offset:16384
    v_mfma_f32_16x16x32_bf16 v[220:223], a[80:83], v[180:183], v[220:223]
    v_mfma_f32_16x16x32_bf16 v[216:219], a[16:19], v[180:183], v[216:219]
    s_nop 0
    v_mfma_f32_16x16x32_bf16 v[220:223], a[84:87], v[188:191], v[220:223]
    ds_read_b128 v[180:183], v252 offset:18432
    s_waitcnt lgkmcnt(3)
    v_mfma_f32_16x16x32_bf16 v[220:223], a[88:91], v[196:199], v[220:223]
    ds_read_b128 v[176:179], v252 offset:16384
    v_mfma_f32_16x16x32_bf16 v[216:219], a[20:23], v[188:191], v[216:219]
    ds_read_b128 v[188:191], v253 offset:18432
    v_mfma_f32_16x16x32_bf16 v[212:215], a[88:91], v[192:195], v[212:215]
    v_mfma_f32_16x16x32_bf16 v[208:211], a[24:27], v[192:195], v[208:211]
    ds_read_b128 v[192:195], v252 offset:20480
    v_mfma_f32_16x16x32_bf16 v[216:219], a[24:27], v[196:199], v[216:219]
    ds_read_b128 v[196:199], v252 offset:22528
    v_mfma_f32_16x16x32_bf16 v[208:211], a[28:31], v[200:203], v[208:211]
    ds_read_b128 v[64:67], v11 offset:5120
    s_waitcnt lgkmcnt(4)
    v_mfma_f32_16x16x32_bf16 v[208:211], a[32:35], v[176:179], v[208:211]
    v_mfma_f32_16x16x32_bf16 v[216:219], a[28:31], v[204:207], v[216:219]
    s_nop 0
    v_mfma_f32_16x16x32_bf16 v[220:223], a[92:95], v[204:207], v[220:223]
    v_mfma_f32_16x16x32_bf16 v[220:223], a[96:99], v[180:183], v[220:223]
    ds_read_b128 v[204:207], v253 offset:22528
    v_mfma_f32_16x16x32_bf16 v[212:215], a[92:95], v[200:203], v[212:215]
    ds_read_b128 v[200:203], v253 offset:20480
    s_waitcnt lgkmcnt(5)
    v_mfma_f32_16x16x32_bf16 v[220:223], a[100:103], v[188:191], v[220:223]
    s_nop 0
    v_mfma_f32_16x16x32_bf16 v[212:215], a[96:99], v[176:179], v[212:215]
    ds_read_b128 v[176:179], v252 offset:24576
    v_mfma_f32_16x16x32_bf16 v[212:215], a[100:103], v[184:187], v[212:215]
    ds_read_b128 v[56:59], v11 offset:1024
    v_mfma_f32_16x16x32_bf16 v[208:211], a[36:39], v[184:187], v[208:211]
    ds_read_b128 v[184:187], v253 offset:24576
    s_waitcnt lgkmcnt(7)
    v_mfma_f32_16x16x32_bf16 v[208:211], a[40:43], v[192:195], v[208:211]
    ds_read_b128 v[84:87], v3 offset:2048
    s_waitcnt lgkmcnt(7)
    v_mfma_f32_16x16x32_bf16 v[220:223], a[104:107], v[196:199], v[220:223]
    v_mfma_f32_16x16x32_bf16 v[216:219], a[32:35], v[180:183], v[216:219]
    v_mfma_f32_16x16x32_bf16 v[212:215], a[104:107], v[192:195], v[212:215]
    ds_read_b128 v[192:195], v252 offset:28672
    v_mfma_f32_16x16x32_bf16 v[216:219], a[36:39], v[188:191], v[216:219]
    ds_read_b128 v[188:191], v253 offset:26624
    v_mfma_f32_16x16x32_bf16 v[216:219], a[40:43], v[196:199], v[216:219]
    ds_read_b128 v[80:83], v11 offset:13312
    s_waitcnt lgkmcnt(7)
    v_mfma_f32_16x16x32_bf16 v[208:211], a[44:47], v[200:203], v[208:211]
    s_waitcnt lgkmcnt(6)
    v_mfma_f32_16x16x32_bf16 v[208:211], a[48:51], v[176:179], v[208:211]
    ds_read_b128 v[180:183], v252 offset:26624
    v_mfma_f32_16x16x32_bf16 v[212:215], a[108:111], v[200:203], v[212:215]
    s_waitcnt lgkmcnt(5)
    v_mfma_f32_16x16x32_bf16 v[208:211], a[52:55], v[184:187], v[208:211]
    ds_read_b128 v[200:203], v253 offset:28672
    v_mfma_f32_16x16x32_bf16 v[212:215], a[112:115], v[176:179], v[212:215]
    v_mfma_f32_16x16x32_bf16 v[212:215], a[116:119], v[184:187], v[212:215]
    s_waitcnt lgkmcnt(4)
    v_mfma_f32_16x16x32_bf16 v[212:215], a[120:123], v[192:195], v[212:215]
    ds_read_b128 v[196:199], v252 offset:30720
    v_mfma_f32_16x16x32_bf16 v[216:219], a[44:47], v[204:207], v[216:219]
    s_waitcnt lgkmcnt(2)
    v_mfma_f32_16x16x32_bf16 v[216:219], a[48:51], v[180:183], v[216:219]
    s_waitcnt lgkmcnt(1)
    v_mfma_f32_16x16x32_bf16 v[212:215], a[124:127], v[200:203], v[212:215]
    v_mfma_f32_16x16x32_bf16 v[220:223], a[108:111], v[204:207], v[220:223]
    ds_read_b128 v[204:207], v253 offset:30720
    v_mfma_f32_16x16x32_bf16 v[208:211], a[56:59], v[192:195], v[208:211]
    v_mfma_f32_16x16x32_bf16 v[208:211], a[60:63], v[200:203], v[208:211]
    s_nop 0
    v_cvt_pk_bf16_f32 v226, v212, v213
    v_cvt_pk_bf16_f32 v227, v214, v215
    v_mfma_f32_16x16x32_bf16 v[216:219], a[52:55], v[188:191], v[216:219]
    s_nop 0
    v_mfma_f32_16x16x32_bf16 v[220:223], a[112:115], v[180:183], v[220:223]
    s_nop 0
    v_cvt_pk_bf16_f32 v224, v208, v209
    v_mfma_f32_16x16x32_bf16 v[220:223], a[116:119], v[188:191], v[220:223]
    s_waitcnt lgkmcnt(1)
    v_mfma_f32_16x16x32_bf16 v[220:223], a[120:123], v[196:199], v[220:223]
    ds_read_b128 v[76:79], v11 offset:12288
    v_cvt_pk_bf16_f32 v225, v210, v211
    v_mfma_f32_16x16x32_bf16 v[216:219], a[56:59], v[196:199], v[216:219]
    s_waitcnt lgkmcnt(1)
    v_mfma_f32_16x16x32_bf16 v[216:219], a[60:63], v[204:207], v[216:219]
    ds_write_b128 v8, v[224:227] offset:0
    v_mfma_f32_16x16x32_bf16 v[220:223], a[124:127], v[204:207], v[220:223]
    s_nop 3
    v_cvt_pk_bf16_f32 v228, v216, v217
    v_cvt_pk_bf16_f32 v229, v218, v219
    s_nop 0
    s_nop 0
    v_cvt_pk_bf16_f32 v230, v220, v221
    v_cvt_pk_bf16_f32 v231, v222, v223
    ds_write_b128 v8, v[228:231] offset:1024
    ds_read_b128 v[96:99], v3 offset:7168
    s_waitcnt lgkmcnt(1)
    s_barrier
    ds_read_b128 v[28:31], v9 offset:0
    ds_read_b128 v[60:63], v11 offset:4096
    ds_read_b128 v[36:39], v9 offset:4096
    ds_read_b128 v[40:43], v9 offset:6144
    ds_read_b128 v[32:35], v9 offset:2048
    s_waitcnt lgkmcnt(4)
    v_mfma_f32_16x16x32_bf16 v[48:51], v[56:59], v[28:31], v[24:27]
    v_mfma_f32_16x16x32_bf16 v[44:47], v[52:55], v[28:31], v[20:23]
    s_waitcnt lgkmcnt(0)
    v_mfma_f32_16x16x32_bf16 v[44:47], v[60:63], v[32:35], v[44:47]
    v_mfma_f32_16x16x32_bf16 v[44:47], v[68:71], v[36:39], v[44:47]
    v_mfma_f32_16x16x32_bf16 v[48:51], v[64:67], v[32:35], v[48:51]
    v_mfma_f32_16x16x32_bf16 v[48:51], v[72:75], v[36:39], v[48:51]
    v_mfma_f32_16x16x32_bf16 v[44:47], v[76:79], v[40:43], v[44:47]
    v_mfma_f32_16x16x32_bf16 v[48:51], v[80:83], v[40:43], v[48:51]
    s_nop 3
    v_max3_f32 v112, v44, v45, v46
    s_nop 2
    v_max3_f32 v112, v112, v50, v51
    v_max3_f32 v113, v47, v48, v49
    v_max_f32 v112, v112, v113
    v_mov_b32 v113, v112
    s_nop 1
    v_permlane16_swap_b32 v112, v113
    v_max_f32 v112, v112, v113
    v_mov_b32 v113, v112
    s_nop 1
    v_permlane32_swap_b32 v112, v113
    v_max_f32 v112, v112, v113
    v_mul_f32 v112, s18, v112
    v_pk_fma_f32 v[44:45], v[44:45], s[18:19], v[112:113] op_sel_hi:[1,0,0] neg_lo:[0,0,1] neg_hi:[0,0,1]
    v_pk_fma_f32 v[48:49], v[48:49], s[18:19], v[112:113] op_sel_hi:[1,0,0] neg_lo:[0,0,1] neg_hi:[0,0,1]
    v_pk_fma_f32 v[46:47], v[46:47], s[18:19], v[112:113] op_sel_hi:[1,0,0] neg_lo:[0,0,1] neg_hi:[0,0,1]
    v_exp_f32 v48, v48
    v_exp_f32 v49, v49
    v_exp_f32 v44, v44
    v_exp_f32 v47, v47
    v_exp_f32 v45, v45
    v_pk_fma_f32 v[50:51], v[50:51], s[18:19], v[112:113] op_sel_hi:[1,0,0] neg_lo:[0,0,1] neg_hi:[0,0,1]
    v_exp_f32 v46, v46
    v_exp_f32 v51, v51
    v_cvt_pk_bf16_f32 v69, v46, v47
    v_exp_f32 v50, v50
    v_cvt_pk_bf16_f32 v68, v44, v45
    v_cvt_pk_bf16_f32 v71, v50, v51
    v_cvt_pk_bf16_f32 v70, v48, v49
    v_pk_add_f32 v[44:45], v[44:45], v[46:47]
    v_pk_add_f32 v[48:49], v[48:49], v[50:51]
    v_pk_add_f32 v[44:45], v[44:45], v[48:49]
    v_mfma_f32_16x16x32_bf16 v[52:55], v[84:87], v[68:71], 0
    v_add_f32 v114, v44, v45
    v_mov_b32 v113, v114
    v_mfma_f32_16x16x32_bf16 v[56:59], v[88:91], v[68:71], 0
    s_nop 0
    v_permlane16_swap_b32 v114, v113
    v_add_f32_e64 v114, v114, v113
    v_mov_b32_e64 v113, v114
    v_mfma_f32_16x16x32_bf16 v[60:63], v[92:95], v[68:71], 0
    s_nop 0
    v_permlane32_swap_b32 v114, v113
    v_add_f32_e64 v114, v114, v113
    v_mfma_f32_16x16x32_bf16 v[64:67], v[96:99], v[68:71], 0
    s_waitcnt lgkmcnt(0)
    s_mov_b32 s22, 143806464
wa_28:
    buffer_load_dword v108, v4, s[8:11], s22 offen sc1
    s_waitcnt vmcnt(0)
    v_cmp_gt_u32_e64 vcc, 3, v108
    s_cbranch_vccz wa_29
    s_sub_u32 s3, s3, 1
    s_cbranch_scc1 main_timeout
    s_sleep 1
    s_branch wa_28
    s_nop 0
    s_nop 0
    s_nop 0
    s_nop 0
    s_nop 0
wa_29:
    v_mov_b32_e64 v108, 0
    s_mov_b32 s25, s31
    s_lshl_b32 s42, s12, 1
    s_add_u32 s42, s42, s13
    s_and_b32 s42, s42, 0
    s_lshl_b32 s42, s42, 12
    s_add_u32 s42, s42, s35
    s_cmp_eq_u32 s15, 0
    s_cselect_b32 s53, 0x7fff0000, s37
    s_cselect_b32 s48, s37, 0x7fff0000
at_loop:
    s_cmp_eq_u32 s52, 1
    s_cbranch_scc1 at_kmcheck
at_kmpoll:
    buffer_load_dword v110, off, s[8:11], s30 sc1
    buffer_load_dword v115, off, s[8:11], s25 sc1
    s_waitcnt vmcnt(0)
    s_add_u32 s22, s49, 2
    s_min_u32 s22, s22, 63
    v_max_u32_e64 v108, v108, v115
    v_cmp_ge_u32 s[50:51], s22, v108
    v_cmp_eq_u32_e64 vcc, s19, v110
    s_nop 0
    s_or_b64 vcc, vcc, s[50:51]
    s_cbranch_vccz at_kmgo
    s_sub_u32 s3, s3, 1
    s_cbranch_scc1 main_timeout
    s_sleep 2
    s_branch at_kmpoll
    s_nop 0
    s_nop 0
at_kmgo:
    s_sub_u32 s3, s3, 1
    s_cbranch_scc1 main_timeout
    buffer_load_dwordx4 v[116:119], v1, s[8:11], s30 offen offset:0 sc1
    buffer_load_dwordx4 v[120:123], v1, s[8:11], s30 offen offset:1024 sc1
    s_waitcnt vmcnt(0)
at_kmcheck:
    v_max3_u32 v110, v116, v117, v118
    v_max3_u32 v109, v119, v120, v121
    v_max3_u32 v110, v110, v122, v123
    v_max_u32 v110, v110, v109
    v_cmp_eq_u32 vcc, s19, v110
    ds_write_b128 v255, v[116:119] offset:0
    ds_write_b128 v255, v[120:123] offset:1024
    s_cbranch_vccnz at_kmgo
at_kmdone:
    s_add_u32 s49, s49, 2
    v_readfirstlane_b32 s23, v108
    s_add_u32 s22, s49, 2
    s_min_u32 s22, s22, 63
    s_cmp_ge_u32 s22, s23
    s_cselect_b32 s25, s31, 0x7fff0000
    s_cmp_lt_u32 s49, 64
    s_cselect_b32 s22, 0x10000, 0x40000000
    s_cselect_b32 s23, 1048576, 0x40000000
    s_add_u32 s20, s20, s22
    s_add_u32 s28, s28, s23
    s_add_u32 s39, s39, 65536
    s_add_u32 s30, s30, 524288
    s_cmp_lt_u32 s49, 64
    s_cselect_b32 s30, s30, 0x7fff0000
    s_mov_b32 s52, 0
    s_lshl_b32 s26, s16, 21
    s_add_u32 s26, s26, s39
    s_add_u32 s26, s26, 132120576
    s_add_u32 s27, s39, 130023424
    s_cmp_eq_u32 s12, 0
    s_cselect_b32 s26, s26, 0x7fff0000
    s_cbranch_scc0 at_noy
    s_cmp_eq_u32 s16, 0
at_noy:
    s_cselect_b32 s27, s27, 0x7fff0000
    s_waitcnt lgkmcnt(0)
    s_barrier
    s_cmp_eq_u32 s15, 0
    s_cbranch_scc1 at_b_slow
    ds_read_b128 v[116:119], v11 offset:16384
    ds_read_b128 v[120:123], v11 offset:18432
    buffer_load_dword v111, v4, s[8:11], s36 offen sc1
    ds_read_b128 v[124:127], v11 offset:20480
    ds_read_b128 v[136:139], v254 offset:19456
    ds_read_b128 v[128:131], v11 offset:22528
    s_mov_b32 m0, s29
    s_nop 0
    buffer_load_dwordx4 v1, s[8:11], s28 offen offset:0 sc1 lds
    s_mov_b32 m0, s29
    s_nop 0
    buffer_load_dwordx4 v1, s[8:11], s28 offen offset:1024 sc1 lds
    s_waitcnt lgkmcnt(4)
    v_mfma_f32_16x16x32_bf16 v[140:143], v[116:119], v[28:31], 0
    s_waitcnt lgkmcnt(3)
    v_mfma_f32_16x16x32_bf16 v[140:143], v[120:123], v[32:35], v[140:143]
    s_mov_b32 m0, s29
    s_nop 0
    buffer_load_dwordx4 v1, s[8:11], s28 offen offset:2048 sc1 lds
    s_waitcnt lgkmcnt(2)
    v_mfma_f32_16x16x32_bf16 v[140:143], v[124:127], v[36:39], v[140:143]
    s_waitcnt lgkmcnt(0)
    v_mfma_f32_16x16x32_bf16 v[140:143], v[128:131], v[40:43], v[140:143]
    s_nop 3
    s_nop 3
    v_max3_f32 v150, v140, v141, v142
    ds_read_b128 v[132:135], v254 offset:17408
    v_max_f32 v150, v150, v143
    v_mov_b32 v113, v150
    s_nop 1
    v_permlane16_swap_b32 v150, v113
    v_max_f32 v150, v150, v113
    v_mul_f32 v150, s18, v150
    v_max_f32 v150, v150, v112
    v_pk_fma_f32 v[140:141], v[140:141], s[18:19], v[150:151] op_sel_hi:[1,0,0] neg_lo:[0,0,1] neg_hi:[0,0,1]
    v_pk_fma_f32 v[142:143], v[142:143], s[18:19], v[150:151] op_sel_hi:[1,0,0] neg_lo:[0,0,1] neg_hi:[0,0,1]
    v_exp_f32 v141, v141
    v_exp_f32 v140, v140
    v_exp_f32 v143, v143
    v_exp_f32 v142, v142
    v_sub_f32 v112, v112, v150
    v_pk_add_f32 v[150:151], v[140:141], v[142:143]
    v_add_f32 v150, v150, v151
    v_mov_b32 v113, v150
    v_exp_f32 v112, v112
    s_nop 0
    v_permlane16_swap_b32 v150, v113
    v_add_f32 v150, v150, v113
    v_fma_f32 v114, v114, v112, v150
    v_rcp_f32 v114, v114
    s_nop 0
    v_mul_f32_e64 v112, v112, v114
    v_pk_mul_f32 v[140:141], v[140:141], v[114:115] op_sel_hi:[1,0]
    v_pk_mul_f32 v[62:63], v[62:63], v[112:113] op_sel_hi:[1,0]
    v_pk_mul_f32 v[54:55], v[54:55], v[112:113] op_sel_hi:[1,0]
    v_pk_mul_f32 v[60:61], v[60:61], v[112:113] op_sel_hi:[1,0]
    v_pk_mul_f32 v[142:143], v[142:143], v[114:115] op_sel_hi:[1,0]
    v_pk_mul_f32 v[52:53], v[52:53], v[112:113] op_sel_hi:[1,0]
    v_cvt_pk_bf16_f32 v149, v142, v143
    v_pk_mul_f32 v[64:65], v[64:65], v[112:113] op_sel_hi:[1,0]
    v_pk_mul_f32 v[66:67], v[66:67], v[112:113] op_sel_hi:[1,0]
    v_cvt_pk_bf16_f32 v148, v140, v141
    v_pk_mul_f32 v[56:57], v[56:57], v[112:113] op_sel_hi:[1,0]
    v_pk_mul_f32 v[58:59], v[58:59], v[112:113] op_sel_hi:[1,0]
    v_mfma_f32_16x16x16_bf16 v[64:67], v[138:139], v[148:149], v[64:67]
    s_waitcnt lgkmcnt(0)
    v_mfma_f32_16x16x16_bf16 v[56:59], v[134:135], v[148:149], v[56:59]
    s_mov_b32 m0, s29
    s_nop 0
    buffer_load_dwordx4 v1, s[8:11], s28 offen offset:3072 sc1 lds
    v_mfma_f32_16x16x16_bf16 v[60:63], v[136:137], v[148:149], v[60:63]
    s_nop 0
    v_mfma_f32_16x16x16_bf16 v[52:55], v[132:133], v[148:149], v[52:55]
    v_cvt_pk_bf16_f32 v174, v64, v65
    v_cvt_pk_bf16_f32 v171, v58, v59
    s_nop 0
    s_nop 0
    v_cvt_pk_bf16_f32 v173, v62, v63
    v_cvt_pk_bf16_f32 v170, v56, v57
    v_cvt_pk_bf16_f32 v175, v66, v67
    v_cvt_pk_bf16_f32 v172, v60, v61
    v_cvt_pk_bf16_f32 v168, v52, v53
    v_cvt_pk_bf16_f32 v169, v54, v55
    ds_write_b128 v10, v[172:175] offset:2048
    ds_write_b128 v10, v[168:171] offset:0
    s_add_u32 m0, s21, 0
    s_nop 0
    buffer_load_dwordx4 v2, s[8:11], s20 offen offset:0 sc1 lds
    s_add_u32 m0, s21, 3968
    s_nop 0
    buffer_load_dwordx4 v2, s[8:11], s20 offen offset:128 sc1 lds
    s_waitcnt lgkmcnt(0)
    s_barrier
    ds_read_b128 v[140:143], v7 offset:0
    s_add_u32 m0, s21, 7936
    s_nop 0
    buffer_load_dwordx4 v2, s[8:11], s20 offen offset:256 sc1 lds
    ds_read_b128 v[156:159], v7 offset:4096
    ds_read_b128 v[148:151], v7 offset:2048
    s_waitcnt lgkmcnt(2)
    v_mfma_f32_16x16x32_bf16 v[196:199], v[140:143], a[224:227], 0
    v_mfma_f32_16x16x32_bf16 v[176:179], v[140:143], a[144:147], 0
    v_mfma_f32_16x16x32_bf16 v[184:187], v[140:143], a[176:179], 0
    ds_read_b128 v[164:167], v7 offset:6144
    s_waitcnt lgkmcnt(1)
    v_mfma_f32_16x16x32_bf16 v[184:187], v[148:151], a[180:183], v[184:187]
    v_mfma_f32_16x16x32_bf16 v[200:203], v[140:143], a[240:243], 0
    v_mfma_f32_16x16x32_bf16 v[196:199], v[148:151], a[228:231], v[196:199]
    ds_read_b128 v[168:171], v7 offset:7168
    v_mfma_f32_16x16x32_bf16 v[184:187], v[156:159], a[184:187], v[184:187]
    s_add_u32 m0, s21, 11904
    s_nop 0
    buffer_load_dwordx4 v2, s[8:11], s20 offen offset:384 sc1 lds
    v_mfma_f32_16x16x32_bf16 v[188:191], v[140:143], a[192:195], 0
    s_add_u32 m0, s21, 15872
    s_nop 0
    buffer_load_dwordx4 v2, s[8:11], s20 offen offset:512 sc1 lds
    v_mfma_f32_16x16x32_bf16 v[172:175], v[140:143], a[128:131], 0
    s_add_u32 m0, s21, 19840
    s_nop 0
    buffer_load_dwordx4 v2, s[8:11], s20 offen offset:640 sc1 lds
    v_mfma_f32_16x16x32_bf16 v[176:179], v[148:151], a[148:151], v[176:179]
    s_nop 0
    v_mfma_f32_16x16x32_bf16 v[176:179], v[156:159], a[152:155], v[176:179]
    s_waitcnt lgkmcnt(1)
    v_mfma_f32_16x16x32_bf16 v[176:179], v[164:167], a[156:159], v[176:179]
    s_nop 0
    v_mfma_f32_16x16x32_bf16 v[172:175], v[148:151], a[132:135], v[172:175]
    ds_read_b128 v[152:155], v7 offset:3072
    s_waitcnt vmcnt(10)
    v_cmp_gt_u32_e64 vcc, s38, v111
    v_mfma_f32_16x16x32_bf16 v[192:195], v[140:143], a[208:211], 0
    s_nop 0
    v_mfma_f32_16x16x32_bf16 v[184:187], v[164:167], a[188:191], v[184:187]
    ds_read_b128 v[144:147], v7 offset:1024
    v_mfma_f32_16x16x32_bf16 v[188:191], v[148:151], a[196:199], v[188:191]
    v_mfma_f32_16x16x32_bf16 v[188:191], v[156:159], a[200:203], v[188:191]
    s_add_u32 m0, s21, 23808
    s_nop 0
    buffer_load_dwordx4 v2, s[8:11], s20 offen offset:768 sc1 lds
    v_mfma_f32_16x16x32_bf16 v[188:191], v[164:167], a[204:207], v[188:191]
    s_add_u32 m0, s21, 27776
    s_nop 0
    buffer_load_dwordx4 v2, s[8:11], s20 offen offset:896 sc1 lds
    v_mfma_f32_16x16x32_bf16 v[172:175], v[156:159], a[136:139], v[172:175]
    v_mfma_f32_16x16x32_bf16 v[172:175], v[164:167], a[140:143], v[172:175]
    v_mfma_f32_16x16x32_bf16 v[192:195], v[148:151], a[212:215], v[192:195]
    v_mfma_f32_16x16x32_bf16 v[192:195], v[156:159], a[216:219], v[192:195]
    s_nop 0
    v_mfma_f32_16x16x32_bf16 v[200:203], v[148:151], a[244:247], v[200:203]
    s_nop 0
    v_cvt_pk_bf16_f32 v236, v172, v176
    v_mfma_f32_16x16x32_bf16 v[192:195], v[164:167], a[220:223], v[192:195]
    ds_read_b128 v[160:163], v7 offset:5120
    v_cvt_pk_bf16_f32 v240, v173, v177
    v_mfma_f32_16x16x32_bf16 v[180:183], v[140:143], a[160:163], 0
    v_cvt_pk_bf16_f32 v244, v174, v178
    v_mfma_f32_16x16x32_bf16 v[196:199], v[156:159], a[232:235], v[196:199]
    buffer_load_dwordx4 v[100:103], v1, s[8:11], s26 offen sc1
    v_mfma_f32_16x16x32_bf16 v[196:199], v[164:167], a[236:239], v[196:199]
    buffer_load_dwordx4 v[104:107], v1, s[8:11], s27 offen sc1
    v_mfma_f32_16x16x32_bf16 v[180:183], v[148:151], a[164:167], v[180:183]
    s_nop 0
    v_mfma_f32_16x16x32_bf16 v[180:183], v[156:159], a[168:171], v[180:183]
    s_nop 0
    v_mfma_f32_16x16x32_bf16 v[200:203], v[156:159], a[248:251], v[200:203]
    s_nop 0
    v_cvt_pk_bf16_f32 v238, v188, v192
    v_mfma_f32_16x16x32_bf16 v[200:203], v[164:167], a[252:255], v[200:203]
    s_nop 0
    v_cvt_pk_bf16_f32 v248, v175, v179
    v_mfma_f32_16x16x32_bf16 v[180:183], v[164:167], a[172:175], v[180:183]
    s_waitcnt lgkmcnt(1)
    v_mfma_f32_16x16x32_bf16 v[224:227], v[144:147], a[208:211], 0
    s_nop 0
    v_cvt_pk_bf16_f32 v243, v197, v201
    v_cvt_pk_bf16_f32 v242, v189, v193
    v_mfma_f32_16x16x32_bf16 v[212:215], v[144:147], a[160:163], 0
    v_cvt_pk_bf16_f32 v246, v190, v194
    v_cvt_pk_bf16_f32 v237, v180, v184
    v_mfma_f32_16x16x32_bf16 v[212:215], v[152:155], a[164:167], v[212:215]
    v_cvt_pk_bf16_f32 v249, v183, v187
    v_cvt_pk_bf16_f32 v245, v182, v186
    v_mfma_f32_16x16x32_bf16 v[220:223], v[144:147], a[192:195], 0
    v_mfma_f32_16x16x32_bf16 v[224:227], v[152:155], a[212:215], v[224:227]
    s_nop 0
    v_cvt_pk_bf16_f32 v247, v198, v202
    s_waitcnt lgkmcnt(0)
    v_mfma_f32_16x16x32_bf16 v[224:227], v[160:163], a[216:219], v[224:227]
    v_cvt_pk_bf16_f32 v239, v196, v200
    v_cvt_pk_bf16_f32 v241, v181, v185
    v_mfma_f32_16x16x32_bf16 v[220:223], v[152:155], a[196:199], v[220:223]
    s_cbranch_vccnz at_war_fast
at_warok_fast:
    s_add_u32 s23, s35, 0
    buffer_store_dwordx4 v[236:239], v12, s[8:11], s23 offen
    v_mfma_f32_16x16x32_bf16 v[220:223], v[160:163], a[200:203], v[220:223]
    s_add_u32 s23, s35, 32768
    buffer_store_dwordx4 v[240:243], v12, s[8:11], s23 offen
    v_mfma_f32_16x16x32_bf16 v[212:215], v[160:163], a[168:171], v[212:215]
    s_add_u32 s23, s35, 65536
    buffer_store_dwordx4 v[244:247], v12, s[8:11], s23 offen
    v_mfma_f32_16x16x32_bf16 v[232:235], v[144:147], a[240:243], 0
    v_mfma_f32_16x16x32_bf16 v[232:235], v[152:155], a[244:247], v[232:235]
    v_mfma_f32_16x16x32_bf16 v[212:215], v[168:171], a[172:175], v[212:215]
    v_cvt_pk_bf16_f32 v251, v199, v203
    v_mfma_f32_16x16x32_bf16 v[216:219], v[144:147], a[176:179], 0
    v_mfma_f32_16x16x32_bf16 v[216:219], v[152:155], a[180:183], v[216:219]
    v_mfma_f32_16x16x32_bf16 v[216:219], v[160:163], a[184:187], v[216:219]
    v_cvt_pk_bf16_f32 v250, v191, v195
    v_mfma_f32_16x16x32_bf16 v[228:231], v[144:147], a[224:227], 0
    s_add_u32 s23, s35, 98304
    buffer_store_dwordx4 v[248:251], v12, s[8:11], s23 offen
    v_mfma_f32_16x16x32_bf16 v[216:219], v[168:171], a[188:191], v[216:219]
    v_mfma_f32_16x16x32_bf16 v[228:231], v[152:155], a[228:231], v[228:231]
    v_mfma_f32_16x16x32_bf16 v[228:231], v[160:163], a[232:235], v[228:231]
    v_mfma_f32_16x16x32_bf16 v[220:223], v[168:171], a[204:207], v[220:223]
    v_cvt_pk_bf16_f32 v241, v213, v217
    v_mfma_f32_16x16x32_bf16 v[232:235], v[160:163], a[248:251], v[232:235]
    v_mfma_f32_16x16x32_bf16 v[232:235], v[168:171], a[252:255], v[232:235]
    v_mfma_f32_16x16x32_bf16 v[228:231], v[168:171], a[236:239], v[228:231]
    v_mfma_f32_16x16x32_bf16 v[208:211], v[144:147], a[144:147], 0
    v_cvt_pk_bf16_f32 v249, v215, v219
    v_cvt_pk_bf16_f32 v245, v214, v218
    v_mfma_f32_16x16x32_bf16 v[224:227], v[168:171], a[220:223], v[224:227]
    v_cvt_pk_bf16_f32 v251, v231, v235
    v_mfma_f32_16x16x32_bf16 v[208:211], v[152:155], a[148:151], v[208:211]
    v_cvt_pk_bf16_f32 v237, v212, v216
    v_mfma_f32_16x16x32_bf16 v[208:211], v[160:163], a[152:155], v[208:211]
    v_cvt_pk_bf16_f32 v243, v229, v233
    v_cvt_pk_bf16_f32 v238, v220, v224
    v_mfma_f32_16x16x32_bf16 v[204:207], v[144:147], a[128:131], 0
    v_cvt_pk_bf16_f32 v250, v223, v227
    v_cvt_pk_bf16_f32 v242, v221, v225
    v_mfma_f32_16x16x32_bf16 v[204:207], v[152:155], a[132:135], v[204:207]
    v_mfma_f32_16x16x32_bf16 v[204:207], v[160:163], a[136:139], v[204:207]
    v_cvt_pk_bf16_f32 v246, v222, v226
    v_mfma_f32_16x16x32_bf16 v[208:211], v[168:171], a[156:159], v[208:211]
    v_cvt_pk_bf16_f32 v239, v228, v232
    v_cvt_pk_bf16_f32 v247, v230, v234
    v_mfma_f32_16x16x32_bf16 v[204:207], v[168:171], a[140:143], v[204:207]
    s_nop 3
    s_nop 3
    v_cvt_pk_bf16_f32 v248, v207, v211
    v_cvt_pk_bf16_f32 v244, v206, v210
    v_cvt_pk_bf16_f32 v240, v205, v209
    v_cvt_pk_bf16_f32 v236, v204, v208
    s_add_u32 s23, s35, 131072
    buffer_store_dwordx4 v[236:239], v12, s[8:11], s23 offen
    s_add_u32 s23, s35, 163840
    buffer_store_dwordx4 v[240:243], v12, s[8:11], s23 offen
    s_add_u32 s23, s35, 196608
    buffer_store_dwordx4 v[244:247], v12, s[8:11], s23 offen
    s_add_u32 s23, s35, 229376
    buffer_store_dwordx4 v[248:251], v12, s[8:11], s23 offen
    s_add_u32 s22, s38, 2
    s_add_u32 s38, s38, 3
    v_mov_b32_e64 v6, s22
    v_subrev_u32_e64 v5, 1, v6
    s_sub_u32 s27, s22, s34
    s_cmp_lt_u32 s49, 64
    s_cbranch_scc1 at_more_fast
    s_waitcnt vmcnt(4)
    buffer_store_dword v5, off, s[8:11], s37
    s_waitcnt vmcnt(1)
    buffer_store_dword v6, off, s[8:11], s37
    s_branch at_appoll
at_more_fast:
    s_waitcnt vmcnt(8)
    s_barrier
    ds_read_b128 v[176:179], v252 offset:0
    ds_read_b128 v[184:187], v253 offset:0
    ds_read_b128 v[192:195], v252 offset:4096
    ds_read_b128 v[180:183], v252 offset:2048
    buffer_load_dword v110, off, s[8:11], s30 sc1
    buffer_load_dword v115, off, s[8:11], s25 sc1
    ds_read_b128 v[92:95], v3 offset:6144
    ds_read_b128 v[188:191], v253 offset:2048
    ds_read_b128 v[196:199], v252 offset:6144
    ds_read_b128 v[52:55], v11 offset:0
    s_waitcnt lgkmcnt(7)
    v_mfma_f32_16x16x32_bf16 v[208:211], a[0:3], v[176:179], 0
    ds_read_b128 v[200:203], v253 offset:4096
    v_mfma_f32_16x16x32_bf16 v[212:215], a[64:67], v[176:179], 0
    ds_read_b128 v[176:179], v252 offset:8192
    s_waitcnt lgkmcnt(8)
    v_mfma_f32_16x16x32_bf16 v[212:215], a[68:71], v[184:187], v[212:215]
    s_waitcnt vmcnt(6)
    buffer_store_dword v5, off, s[8:11], s37
    v_mfma_f32_16x16x32_bf16 v[208:211], a[4:7], v[184:187], v[208:211]
    ds_read_b128 v[184:187], v253 offset:8192
    s_waitcnt lgkmcnt(7)
    v_mfma_f32_16x16x32_bf16 v[216:219], a[0:3], v[180:183], 0
    v_mfma_f32_16x16x32_bf16 v[208:211], a[8:11], v[192:195], v[208:211]
    v_mfma_f32_16x16x32_bf16 v[212:215], a[72:75], v[192:195], v[212:215]
    ds_read_b128 v[192:195], v252 offset:12288
    s_waitcnt lgkmcnt(3)
    v_mfma_f32_16x16x32_bf16 v[212:215], a[76:79], v[200:203], v[212:215]
    s_waitcnt lgkmcnt(2)
    v_mfma_f32_16x16x32_bf16 v[212:215], a[80:83], v[176:179], v[212:215]
    ds_read_b128 v[76:79], v11 offset:12288
    v_mfma_f32_16x16x32_bf16 v[208:211], a[12:15], v[200:203], v[208:211]
    ds_read_b128 v[200:203], v253 offset:12288
    v_mfma_f32_16x16x32_bf16 v[208:211], a[16:19], v[176:179], v[208:211]
    v_mfma_f32_16x16x32_bf16 v[220:223], a[64:67], v[180:183], 0
    s_waitcnt lgkmcnt(3)
    v_mfma_f32_16x16x32_bf16 v[212:215], a[84:87], v[184:187], v[212:215]
    ds_read_b128 v[180:183], v252 offset:10240
    s_waitcnt lgkmcnt(3)
    v_mfma_f32_16x16x32_bf16 v[212:215], a[88:91], v[192:195], v[212:215]
    ds_read_b128 v[204:207], v253 offset:6144
    v_mfma_f32_16x16x32_bf16 v[208:211], a[20:23], v[184:187], v[208:211]
    ds_read_b128 v[176:179], v252 offset:16384
    v_mfma_f32_16x16x32_bf16 v[220:223], a[68:71], v[188:191], v[220:223]
    v_mfma_f32_16x16x32_bf16 v[220:223], a[72:75], v[196:199], v[220:223]
    ds_read_b128 v[184:187], v253 offset:16384
    v_mfma_f32_16x16x32_bf16 v[208:211], a[24:27], v[192:195], v[208:211]
    ds_read_b128 v[192:195], v252 offset:20480
    s_waitcnt lgkmcnt(5)
    v_mfma_f32_16x16x32_bf16 v[208:211], a[28:31], v[200:203], v[208:211]
    s_nop 0
    v_mfma_f32_16x16x32_bf16 v[212:215], a[92:95], v[200:203], v[212:215]
    s_waitcnt lgkmcnt(2)
    v_mfma_f32_16x16x32_bf16 v[212:215], a[96:99], v[176:179], v[212:215]
    ds_read_b128 v[200:203], v253 offset:20480
    v_mfma_f32_16x16x32_bf16 v[208:211], a[32:35], v[176:179], v[208:211]
    s_waitcnt vmcnt(3)
    buffer_store_dword v6, off, s[8:11], s37
    v_mfma_f32_16x16x32_bf16 v[216:219], a[4:7], v[188:191], v[216:219]
    s_waitcnt lgkmcnt(2)
    v_mfma_f32_16x16x32_bf16 v[208:211], a[36:39], v[184:187], v[208:211]
    ds_read_b128 v[188:191], v253 offset:10240
    v_mfma_f32_16x16x32_bf16 v[212:215], a[100:103], v[184:187], v[212:215]
    ds_read_b128 v[184:187], v253 offset:24576
    v_mfma_f32_16x16x32_bf16 v[216:219], a[8:11], v[196:199], v[216:219]
    ds_read_b128 v[196:199], v252 offset:14336
    s_waitcnt lgkmcnt(4)
    v_mfma_f32_16x16x32_bf16 v[212:215], a[104:107], v[192:195], v[212:215]
    ds_read_b128 v[176:179], v252 offset:24576
    v_mfma_f32_16x16x32_bf16 v[220:223], a[76:79], v[204:207], v[220:223]
    ds_read_b128 v[64:67], v11 offset:5120
    v_mfma_f32_16x16x32_bf16 v[220:223], a[80:83], v[180:183], v[220:223]
    ds_read_b128 v[56:59], v11 offset:1024
    v_mfma_f32_16x16x32_bf16 v[216:219], a[12:15], v[204:207], v[216:219]
    ds_read_b128 v[204:207], v253 offset:14336
    v_mfma_f32_16x16x32_bf16 v[216:219], a[16:19], v[180:183], v[216:219]
    ds_read_b128 v[180:183], v252 offset:18432
    v_mfma_f32_16x16x32_bf16 v[208:211], a[40:43], v[192:195], v[208:211]
    s_waitcnt lgkmcnt(8)
    v_mfma_f32_16x16x32_bf16 v[208:211], a[44:47], v[200:203], v[208:211]
    s_waitcnt lgkmcnt(7)
    v_mfma_f32_16x16x32_bf16 v[216:219], a[20:23], v[188:191], v[216:219]
    ds_read_b128 v[68:71], v11 offset:8192
    v_mfma_f32_16x16x32_bf16 v[220:223], a[84:87], v[188:191], v[220:223]
    s_waitcnt lgkmcnt(6)
    v_mfma_f32_16x16x32_bf16 v[220:223], a[88:91], v[196:199], v[220:223]
    ds_read_b128 v[72:75], v11 offset:9216
    v_mfma_f32_16x16x32_bf16 v[216:219], a[24:27], v[196:199], v[216:219]
    ds_read_b128 v[196:199], v252 offset:22528
    v_mfma_f32_16x16x32_bf16 v[212:215], a[108:111], v[200:203], v[212:215]
    ds_read_b128 v[200:203], v253 offset:28672
    s_waitcnt lgkmcnt(8)
    v_mfma_f32_16x16x32_bf16 v[212:215], a[112:115], v[176:179], v[212:215]
    buffer_load_dword v111, v4, s[8:11], s36 offen sc1
    v_mfma_f32_16x16x32_bf16 v[208:211], a[48:51], v[176:179], v[208:211]
    ds_read_b128 v[192:195], v252 offset:28672
    v_mfma_f32_16x16x32_bf16 v[208:211], a[52:55], v[184:187], v[208:211]
    ds_read_b128 v[188:191], v253 offset:18432
    v_mfma_f32_16x16x32_bf16 v[212:215], a[116:119], v[184:187], v[212:215]
    ds_read_b128 v[88:91], v3 offset:3072
    s_waitcnt lgkmcnt(8)
    v_mfma_f32_16x16x32_bf16 v[216:219], a[28:31], v[204:207], v[216:219]
    s_nop 0
    v_mfma_f32_16x16x32_bf16 v[220:223], a[92:95], v[204:207], v[220:223]
    ds_read_b128 v[204:207], v253 offset:22528
    s_waitcnt lgkmcnt(8)
    v_mfma_f32_16x16x32_bf16 v[216:219], a[32:35], v[180:183], v[216:219]
    ds_read_b128 v[84:87], v3 offset:2048
    v_mfma_f32_16x16x32_bf16 v[220:223], a[96:99], v[180:183], v[220:223]
    s_waitcnt lgkmcnt(3)
    v_mfma_f32_16x16x32_bf16 v[220:223], a[100:103], v[188:191], v[220:223]
    v_mfma_f32_16x16x32_bf16 v[220:223], a[104:107], v[196:199], v[220:223]
    ds_read_b128 v[180:183], v252 offset:26624
    v_mfma_f32_16x16x32_bf16 v[208:211], a[56:59], v[192:195], v[208:211]
    v_mfma_f32_16x16x32_bf16 v[208:211], a[60:63], v[200:203], v[208:211]
    v_mfma_f32_16x16x32_bf16 v[212:215], a[120:123], v[192:195], v[212:215]
    v_mfma_f32_16x16x32_bf16 v[212:215], a[124:127], v[200:203], v[212:215]
    ds_read_b128 v[60:63], v11 offset:4096
    v_mfma_f32_16x16x32_bf16 v[216:219], a[36:39], v[188:191], v[216:219]
    ds_read_b128 v[188:191], v253 offset:26624
    v_mfma_f32_16x16x32_bf16 v[216:219], a[40:43], v[196:199], v[216:219]
    ds_read_b128 v[196:199], v252 offset:30720
    s_waitcnt lgkmcnt(5)
    v_mfma_f32_16x16x32_bf16 v[216:219], a[44:47], v[204:207], v[216:219]
    v_cvt_pk_bf16_f32 v226, v212, v213
    s_waitcnt lgkmcnt(3)
    v_mfma_f32_16x16x32_bf16 v[216:219], a[48:51], v[180:183], v[216:219]
    v_cvt_pk_bf16_f32 v227, v214, v215
    v_cvt_pk_bf16_f32 v225, v210, v211
    v_mfma_f32_16x16x32_bf16 v[220:223], a[108:111], v[204:207], v[220:223]
    ds_read_b128 v[204:207], v253 offset:30720
    v_mfma_f32_16x16x32_bf16 v[220:223], a[112:115], v[180:183], v[220:223]
    s_waitcnt lgkmcnt(2)
    v_mfma_f32_16x16x32_bf16 v[220:223], a[116:119], v[188:191], v[220:223]
    s_waitcnt lgkmcnt(1)
    v_mfma_f32_16x16x32_bf16 v[220:223], a[120:123], v[196:199], v[220:223]
    ds_read_b128 v[80:83], v11 offset:13312
    v_cvt_pk_bf16_f32 v224, v208, v209
    v_mfma_f32_16x16x32_bf16 v[216:219], a[52:55], v[188:191], v[216:219]
    ds_write_b128 v8, v[224:227] offset:0
    v_mfma_f32_16x16x32_bf16 v[216:219], a[56:59], v[196:199], v[216:219]
    s_waitcnt lgkmcnt(2)
    v_mfma_f32_16x16x32_bf16 v[216:219], a[60:63], v[204:207], v[216:219]
    ds_read_b128 v[96:99], v3 offset:7168
    v_mfma_f32_16x16x32_bf16 v[220:223], a[124:127], v[204:207], v[220:223]
    s_nop 3
    v_cvt_pk_bf16_f32 v229, v218, v219
    v_cvt_pk_bf16_f32 v228, v216, v217
    s_nop 0
    s_nop 0
    v_cvt_pk_bf16_f32 v230, v220, v221
    v_cvt_pk_bf16_f32 v231, v222, v223
    ds_write_b128 v8, v[228:231] offset:1024
    s_branch at_r
    s_nop 0
    s_nop 0
    s_nop 0
    s_nop 0
    s_nop 0
at_b_slow:
    ds_read_b128 v[116:119], v11 offset:16384
    ds_read_b128 v[120:123], v11 offset:18432
    buffer_load_dword v111, v4, s[8:11], s36 offen sc1
    ds_read_b128 v[124:127], v11 offset:20480
    ds_read_b128 v[136:139], v254 offset:19456
    ds_read_b128 v[128:131], v11 offset:22528
    s_mov_b32 m0, s29
    s_nop 0
    buffer_load_dwordx4 v1, s[8:11], s28 offen offset:0 sc1 lds
    s_mov_b32 m0, s29
    s_nop 0
    buffer_load_dwordx4 v1, s[8:11], s28 offen offset:1024 sc1 lds
    s_waitcnt lgkmcnt(4)
    v_mfma_f32_16x16x32_bf16 v[140:143], v[116:119], v[28:31], 0
    s_waitcnt lgkmcnt(3)
    v_mfma_f32_16x16x32_bf16 v[140:143], v[120:123], v[32:35], v[140:143]
    s_mov_b32 m0, s29
    s_nop 0
    buffer_load_dwordx4 v1, s[8:11], s28 offen offset:2048 sc1 lds
    s_waitcnt lgkmcnt(2)
    v_mfma_f32_16x16x32_bf16 v[140:143], v[124:127], v[36:39], v[140:143]
    s_waitcnt lgkmcnt(0)
    v_mfma_f32_16x16x32_bf16 v[140:143], v[128:131], v[40:43], v[140:143]
    s_nop 7
    v_max3_f32 v150, v140, v141, v142
    ds_read_b128 v[132:135], v254 offset:17408
    v_max_f32 v150, v150, v143
    v_mov_b32 v113, v150
    s_nop 1
    v_permlane16_swap_b32 v150, v113
    v_max_f32 v150, v150, v113
    v_mul_f32 v150, s18, v150
    v_max_f32 v150, v150, v112
    v_pk_fma_f32 v[140:141], v[140:141], s[18:19], v[150:151] op_sel_hi:[1,0,0] neg_lo:[0,0,1] neg_hi:[0,0,1]
    v_pk_fma_f32 v[142:143], v[142:143], s[18:19], v[150:151] op_sel_hi:[1,0,0] neg_lo:[0,0,1] neg_hi:[0,0,1]
    v_exp_f32 v141, v141
    v_exp_f32 v140, v140
    v_exp_f32 v143, v143
    v_exp_f32 v142, v142
    v_sub_f32 v112, v112, v150
    v_pk_add_f32 v[150:151], v[140:141], v[142:143]
    v_add_f32 v150, v150, v151
    v_mov_b32 v113, v150
    v_exp_f32 v112, v112
    s_nop 0
    v_permlane16_swap_b32 v150, v113
    v_add_f32 v150, v150, v113
    v_fma_f32 v114, v114, v112, v150
    v_rcp_f32 v114, v114
    s_nop 0
    v_mul_f32 v112, v112, v114
    v_pk_mul_f32 v[140:141], v[140:141], v[114:115] op_sel_hi:[1,0]
    v_pk_mul_f32 v[62:63], v[62:63], v[112:113] op_sel_hi:[1,0]
    v_pk_mul_f32 v[54:55], v[54:55], v[112:113] op_sel_hi:[1,0]
    v_pk_mul_f32 v[60:61], v[60:61], v[112:113] op_sel_hi:[1,0]
    v_pk_mul_f32 v[142:143], v[142:143], v[114:115] op_sel_hi:[1,0]
    v_pk_mul_f32 v[52:53], v[52:53], v[112:113] op_sel_hi:[1,0]
    v_cvt_pk_bf16_f32 v149, v142, v143
    v_pk_mul_f32 v[64:65], v[64:65], v[112:113] op_sel_hi:[1,0]
    v_pk_mul_f32 v[66:67], v[66:67], v[112:113] op_sel_hi:[1,0]
    v_cvt_pk_bf16_f32 v148, v140, v141
    v_pk_mul_f32 v[56:57], v[56:57], v[112:113] op_sel_hi:[1,0]
    v_pk_mul_f32 v[58:59], v[58:59], v[112:113] op_sel_hi:[1,0]
    v_mfma_f32_16x16x16_bf16 v[64:67], v[138:139], v[148:149], v[64:67]
    s_waitcnt lgkmcnt(0)
    v_mfma_f32_16x16x16_bf16 v[56:59], v[134:135], v[148:149], v[56:59]
    s_mov_b32 m0, s29
    s_nop 0
    buffer_load_dwordx4 v1, s[8:11], s28 offen offset:3072 sc1 lds
    v_mfma_f32_16x16x16_bf16 v[60:63], v[136:137], v[148:149], v[60:63]
    s_nop 0
    v_mfma_f32_16x16x16_bf16 v[52:55], v[132:133], v[148:149], v[52:55]
    v_cvt_pk_bf16_f32 v174, v64, v65
    v_cvt_pk_bf16_f32 v171, v58, v59
    s_nop 0
    s_nop 0
    v_cvt_pk_bf16_f32 v173, v62, v63
    v_cvt_pk_bf16_f32 v170, v56, v57
    v_cvt_pk_bf16_f32 v175, v66, v67
    v_cvt_pk_bf16_f32 v172, v60, v61
    v_cvt_pk_bf16_f32 v168, v52, v53
    v_cvt_pk_bf16_f32 v169, v54, v55
    ds_write_b128 v10, v[172:175] offset:2048
    ds_write_b128 v10, v[168:171] offset:0
    s_add_u32 m0, s21, 0
    s_nop 0
    buffer_load_dwordx4 v2, s[8:11], s20 offen offset:0 sc1 lds
    s_add_u32 m0, s21, 3968
    s_nop 0
    buffer_load_dwordx4 v2, s[8:11], s20 offen offset:128 sc1 lds
    s_waitcnt lgkmcnt(0)
    s_barrier
    ds_read_b128 v[140:143], v7 offset:0
    s_add_u32 m0, s21, 7936
    s_nop 0
    buffer_load_dwordx4 v2, s[8:11], s20 offen offset:256 sc1 lds
    ds_read_b128 v[156:159], v7 offset:4096
    ds_read_b128 v[148:151], v7 offset:2048
    s_waitcnt lgkmcnt(2)
    v_mfma_f32_16x16x32_bf16 v[196:199], v[140:143], a[224:227], 0
    v_mfma_f32_16x16x32_bf16 v[176:179], v[140:143], a[144:147], 0
    v_mfma_f32_16x16x32_bf16 v[184:187], v[140:143], a[176:179], 0
    ds_read_b128 v[164:167], v7 offset:6144
    s_waitcnt lgkmcnt(1)
    v_mfma_f32_16x16x32_bf16 v[184:187], v[148:151], a[180:183], v[184:187]
    v_mfma_f32_16x16x32_bf16 v[200:203], v[140:143], a[240:243], 0
    v_mfma_f32_16x16x32_bf16 v[196:199], v[148:151], a[228:231], v[196:199]
    ds_read_b128 v[168:171], v7 offset:7168
    v_mfma_f32_16x16x32_bf16 v[184:187], v[156:159], a[184:187], v[184:187]
    s_add_u32 m0, s21, 11904
    s_nop 0
    buffer_load_dwordx4 v2, s[8:11], s20 offen offset:384 sc1 lds
    v_mfma_f32_16x16x32_bf16 v[188:191], v[140:143], a[192:195], 0
    s_add_u32 m0, s21, 15872
    s_nop 0
    buffer_load_dwordx4 v2, s[8:11], s20 offen offset:512 sc1 lds
    v_mfma_f32_16x16x32_bf16 v[172:175], v[140:143], a[128:131], 0
    s_add_u32 m0, s21, 19840
    s_nop 0
    buffer_load_dwordx4 v2, s[8:11], s20 offen offset:640 sc1 lds
    v_mfma_f32_16x16x32_bf16 v[176:179], v[148:151], a[148:151], v[176:179]
    s_nop 0
    v_mfma_f32_16x16x32_bf16 v[176:179], v[156:159], a[152:155], v[176:179]
    s_waitcnt lgkmcnt(1)
    v_mfma_f32_16x16x32_bf16 v[176:179], v[164:167], a[156:159], v[176:179]
    s_nop 0
    v_mfma_f32_16x16x32_bf16 v[172:175], v[148:151], a[132:135], v[172:175]
    ds_read_b128 v[152:155], v7 offset:3072
    s_waitcnt vmcnt(10)
    v_cmp_gt_u32_e64 vcc, s38, v111
    v_mfma_f32_16x16x32_bf16 v[192:195], v[140:143], a[208:211], 0
    s_nop 0
    v_mfma_f32_16x16x32_bf16 v[184:187], v[164:167], a[188:191], v[184:187]
    ds_read_b128 v[144:147], v7 offset:1024
    v_mfma_f32_16x16x32_bf16 v[188:191], v[148:151], a[196:199], v[188:191]
    v_mfma_f32_16x16x32_bf16 v[188:191], v[156:159], a[200:203], v[188:191]
    s_add_u32 m0, s21, 23808
    s_nop 0
    buffer_load_dwordx4 v2, s[8:11], s20 offen offset:768 sc1 lds
    v_mfma_f32_16x16x32_bf16 v[188:191], v[164:167], a[204:207], v[188:191]
    s_add_u32 m0, s21, 27776
    s_nop 0
    buffer_load_dwordx4 v2, s[8:11], s20 offen offset:896 sc1 lds
    v_mfma_f32_16x16x32_bf16 v[172:175], v[156:159], a[136:139], v[172:175]
    v_mfma_f32_16x16x32_bf16 v[172:175], v[164:167], a[140:143], v[172:175]
    v_mfma_f32_16x16x32_bf16 v[192:195], v[148:151], a[212:215], v[192:195]
    v_mfma_f32_16x16x32_bf16 v[192:195], v[156:159], a[216:219], v[192:195]
    s_nop 0
    v_mfma_f32_16x16x32_bf16 v[200:203], v[148:151], a[244:247], v[200:203]
    s_nop 0
    v_cvt_pk_bf16_f32 v236, v172, v176
    v_mfma_f32_16x16x32_bf16 v[192:195], v[164:167], a[220:223], v[192:195]
    ds_read_b128 v[160:163], v7 offset:5120
    v_cvt_pk_bf16_f32 v240, v173, v177
    v_mfma_f32_16x16x32_bf16 v[180:183], v[140:143], a[160:163], 0
    v_cvt_pk_bf16_f32 v244, v174, v178
    v_mfma_f32_16x16x32_bf16 v[196:199], v[156:159], a[232:235], v[196:199]
    buffer_load_dwordx4 v[100:103], v1, s[8:11], s26 offen sc1
    v_mfma_f32_16x16x32_bf16 v[196:199], v[164:167], a[236:239], v[196:199]
    buffer_load_dwordx4 v[104:107], v1, s[8:11], s27 offen sc1
    v_mfma_f32_16x16x32_bf16 v[180:183], v[148:151], a[164:167], v[180:183]
    s_nop 0
    v_mfma_f32_16x16x32_bf16 v[180:183], v[156:159], a[168:171], v[180:183]
    s_nop 0
    v_mfma_f32_16x16x32_bf16 v[200:203], v[156:159], a[248:251], v[200:203]
    s_nop 0
    v_cvt_pk_bf16_f32 v238, v188, v192
    v_mfma_f32_16x16x32_bf16 v[200:203], v[164:167], a[252:255], v[200:203]
    s_nop 0
    v_cvt_pk_bf16_f32 v248, v175, v179
    v_mfma_f32_16x16x32_bf16 v[180:183], v[164:167], a[172:175], v[180:183]
    s_waitcnt lgkmcnt(1)
    v_mfma_f32_16x16x32_bf16 v[224:227], v[144:147], a[208:211], 0
    s_nop 0
    v_cvt_pk_bf16_f32 v243, v197, v201
    v_cvt_pk_bf16_f32 v242, v189, v193
    v_mfma_f32_16x16x32_bf16 v[212:215], v[144:147], a[160:163], 0
    v_cvt_pk_bf16_f32 v246, v190, v194
    v_cvt_pk_bf16_f32 v237, v180, v184
    v_mfma_f32_16x16x32_bf16 v[212:215], v[152:155], a[164:167], v[212:215]
    v_cvt_pk_bf16_f32 v249, v183, v187
    v_cvt_pk_bf16_f32 v245, v182, v186
    v_mfma_f32_16x16x32_bf16 v[220:223], v[144:147], a[192:195], 0
    v_mfma_f32_16x16x32_bf16 v[224:227], v[152:155], a[212:215], v[224:227]
    s_nop 0
    v_cvt_pk_bf16_f32 v247, v198, v202
    s_waitcnt lgkmcnt(0)
    v_mfma_f32_16x16x32_bf16 v[224:227], v[160:163], a[216:219], v[224:227]
    v_cvt_pk_bf16_f32 v239, v196, v200
    v_cvt_pk_bf16_f32 v241, v181, v185
    v_mfma_f32_16x16x32_bf16 v[220:223], v[152:155], a[196:199], v[220:223]
    s_cbranch_vccnz at_war_slow
at_warok_slow:
    s_add_u32 s23, s35, 0
    buffer_store_dwordx4 v[236:239], v12, s[8:11], s23 offen sc1
    v_mfma_f32_16x16x32_bf16 v[220:223], v[160:163], a[200:203], v[220:223]
    s_add_u32 s23, s35, 32768
    buffer_store_dwordx4 v[240:243], v12, s[8:11], s23 offen sc1
    v_mfma_f32_16x16x32_bf16 v[212:215], v[160:163], a[168:171], v[212:215]
    s_add_u32 s23, s35, 65536
    buffer_store_dwordx4 v[244:247], v12, s[8:11], s23 offen sc1
    v_mfma_f32_16x16x32_bf16 v[232:235], v[144:147], a[240:243], 0
    v_mfma_f32_16x16x32_bf16 v[232:235], v[152:155], a[244:247], v[232:235]
    v_mfma_f32_16x16x32_bf16 v[212:215], v[168:171], a[172:175], v[212:215]
    v_cvt_pk_bf16_f32 v251, v199, v203
    v_mfma_f32_16x16x32_bf16 v[216:219], v[144:147], a[176:179], 0
    v_mfma_f32_16x16x32_bf16 v[216:219], v[152:155], a[180:183], v[216:219]
    v_mfma_f32_16x16x32_bf16 v[216:219], v[160:163], a[184:187], v[216:219]
    v_cvt_pk_bf16_f32 v250, v191, v195
    v_mfma_f32_16x16x32_bf16 v[228:231], v[144:147], a[224:227], 0
    s_add_u32 s23, s35, 98304
    buffer_store_dwordx4 v[248:251], v12, s[8:11], s23 offen sc1
    v_mfma_f32_16x16x32_bf16 v[216:219], v[168:171], a[188:191], v[216:219]
    v_mfma_f32_16x16x32_bf16 v[228:231], v[152:155], a[228:231], v[228:231]
    v_mfma_f32_16x16x32_bf16 v[228:231], v[160:163], a[232:235], v[228:231]
    v_mfma_f32_16x16x32_bf16 v[220:223], v[168:171], a[204:207], v[220:223]
    v_cvt_pk_bf16_f32 v241, v213, v217
    v_mfma_f32_16x16x32_bf16 v[232:235], v[160:163], a[248:251], v[232:235]
    v_mfma_f32_16x16x32_bf16 v[232:235], v[168:171], a[252:255], v[232:235]
    v_mfma_f32_16x16x32_bf16 v[228:231], v[168:171], a[236:239], v[228:231]
    v_mfma_f32_16x16x32_bf16 v[208:211], v[144:147], a[144:147], 0
    v_cvt_pk_bf16_f32 v249, v215, v219
    v_cvt_pk_bf16_f32 v245, v214, v218
    v_mfma_f32_16x16x32_bf16 v[224:227], v[168:171], a[220:223], v[224:227]
    v_cvt_pk_bf16_f32 v251, v231, v235
    v_mfma_f32_16x16x32_bf16 v[208:211], v[152:155], a[148:151], v[208:211]
    v_cvt_pk_bf16_f32 v237, v212, v216
    v_mfma_f32_16x16x32_bf16 v[208:211], v[160:163], a[152:155], v[208:211]
    v_cvt_pk_bf16_f32 v243, v229, v233
    v_cvt_pk_bf16_f32 v238, v220, v224
    v_mfma_f32_16x16x32_bf16 v[204:207], v[144:147], a[128:131], 0
    v_cvt_pk_bf16_f32 v250, v223, v227
    v_cvt_pk_bf16_f32 v242, v221, v225
    v_mfma_f32_16x16x32_bf16 v[204:207], v[152:155], a[132:135], v[204:207]
    v_mfma_f32_16x16x32_bf16 v[204:207], v[160:163], a[136:139], v[204:207]
    v_cvt_pk_bf16_f32 v246, v222, v226
    v_mfma_f32_16x16x32_bf16 v[208:211], v[168:171], a[156:159], v[208:211]
    v_cvt_pk_bf16_f32 v239, v228, v232
    v_cvt_pk_bf16_f32 v247, v230, v234
    v_mfma_f32_16x16x32_bf16 v[204:207], v[168:171], a[140:143], v[204:207]
    s_nop 3
    s_nop 3
    v_cvt_pk_bf16_f32 v248, v207, v211
    v_cvt_pk_bf16_f32 v244, v206, v210
    v_cvt_pk_bf16_f32 v240, v205, v209
    v_cvt_pk_bf16_f32 v236, v204, v208
    s_add_u32 s23, s35, 131072
    buffer_store_dwordx4 v[236:239], v12, s[8:11], s23 offen sc1
    s_add_u32 s23, s35, 163840
    buffer_store_dwordx4 v[240:243], v12, s[8:11], s23 offen sc1
    s_add_u32 s23, s35, 196608
    buffer_store_dwordx4 v[244:247], v12, s[8:11], s23 offen sc1
    s_add_u32 s23, s35, 229376
    buffer_store_dwordx4 v[248:251], v12, s[8:11], s23 offen sc1
    s_add_u32 s22, s38, 2
    s_add_u32 s38, s38, 3
    v_mov_b32_e64 v6, s22
    v_subrev_u32_e64 v5, 1, v6
    s_sub_u32 s27, s22, s34
    s_cmp_lt_u32 s49, 64
    s_cbranch_scc1 at_more_slow
    s_waitcnt vmcnt(4)
    buffer_store_dword v5, off, s[8:11], s37 sc1
    s_waitcnt vmcnt(1)
    buffer_store_dword v6, off, s[8:11], s37 sc1
    s_branch at_appoll
at_more_slow:
    s_waitcnt vmcnt(8)
    s_barrier
    ds_read_b128 v[176:179], v252 offset:0
    ds_read_b128 v[184:187], v253 offset:0
    ds_read_b128 v[192:195], v252 offset:4096
    ds_read_b128 v[180:183], v252 offset:2048
    buffer_load_dword v110, off, s[8:11], s30 sc1
    buffer_load_dword v115, off, s[8:11], s25 sc1
    ds_read_b128 v[92:95], v3 offset:6144
    ds_read_b128 v[188:191], v253 offset:2048
    ds_read_b128 v[196:199], v252 offset:6144
    ds_read_b128 v[52:55], v11 offset:0
    s_waitcnt lgkmcnt(7)
    v_mfma_f32_16x16x32_bf16 v[208:211], a[0:3], v[176:179], 0
    ds_read_b128 v[200:203], v253 offset:4096
    v_mfma_f32_16x16x32_bf16 v[212:215], a[64:67], v[176:179], 0
    ds_read_b128 v[176:179], v252 offset:8192
    s_waitcnt lgkmcnt(8)
    v_mfma_f32_16x16x32_bf16 v[212:215], a[68:71], v[184:187], v[212:215]
    s_waitcnt vmcnt(6)
    buffer_store_dword v5, off, s[8:11], s37 sc1
    v_mfma_f32_16x16x32_bf16 v[208:211], a[4:7], v[184:187], v[208:211]
    ds_read_b128 v[184:187], v253 offset:8192
    s_waitcnt lgkmcnt(7)
    v_mfma_f32_16x16x32_bf16 v[216:219], a[0:3], v[180:183], 0
    v_mfma_f32_16x16x32_bf16 v[208:211], a[8:11], v[192:195], v[208:211]
    v_mfma_f32_16x16x32_bf16 v[212:215], a[72:75], v[192:195], v[212:215]
    ds_read_b128 v[192:195], v252 offset:12288
    s_waitcnt lgkmcnt(3)
    v_mfma_f32_16x16x32_bf16 v[212:215], a[76:79], v[200:203], v[212:215]
    s_waitcnt lgkmcnt(2)
    v_mfma_f32_16x16x32_bf16 v[212:215], a[80:83], v[176:179], v[212:215]
    ds_read_b128 v[76:79], v11 offset:12288
    v_mfma_f32_16x16x32_bf16 v[208:211], a[12:15], v[200:203], v[208:211]
    ds_read_b128 v[200:203], v253 offset:12288
    v_mfma_f32_16x16x32_bf16 v[208:211], a[16:19], v[176:179], v[208:211]
    v_mfma_f32_16x16x32_bf16 v[220:223], a[64:67], v[180:183], 0
    s_waitcnt lgkmcnt(3)
    v_mfma_f32_16x16x32_bf16 v[212:215], a[84:87], v[184:187], v[212:215]
    ds_read_b128 v[180:183], v252 offset:10240
    s_waitcnt lgkmcnt(3)
    v_mfma_f32_16x16x32_bf16 v[212:215], a[88:91], v[192:195], v[212:215]
    ds_read_b128 v[204:207], v253 offset:6144
    v_mfma_f32_16x16x32_bf16 v[208:211], a[20:23], v[184:187], v[208:211]
    ds_read_b128 v[176:179], v252 offset:16384
    v_mfma_f32_16x16x32_bf16 v[220:223], a[68:71], v[188:191], v[220:223]
    v_mfma_f32_16x16x32_bf16 v[220:223], a[72:75], v[196:199], v[220:223]
    ds_read_b128 v[184:187], v253 offset:16384
    v_mfma_f32_16x16x32_bf16 v[208:211], a[24:27], v[192:195], v[208:211]
    ds_read_b128 v[192:195], v252 offset:20480
    s_waitcnt lgkmcnt(5)
    v_mfma_f32_16x16x32_bf16 v[208:211], a[28:31], v[200:203], v[208:211]
    s_nop 0
    v_mfma_f32_16x16x32_bf16 v[212:215], a[92:95], v[200:203], v[212:215]
    s_waitcnt lgkmcnt(2)
    v_mfma_f32_16x16x32_bf16 v[212:215], a[96:99], v[176:179], v[212:215]
    ds_read_b128 v[200:203], v253 offset:20480
    v_mfma_f32_16x16x32_bf16 v[208:211], a[32:35], v[176:179], v[208:211]
    s_waitcnt vmcnt(3)
    buffer_store_dword v6, off, s[8:11], s37 sc1
    v_mfma_f32_16x16x32_bf16 v[216:219], a[4:7], v[188:191], v[216:219]
    s_waitcnt lgkmcnt(2)
    v_mfma_f32_16x16x32_bf16 v[208:211], a[36:39], v[184:187], v[208:211]
    ds_read_b128 v[188:191], v253 offset:10240
    v_mfma_f32_16x16x32_bf16 v[212:215], a[100:103], v[184:187], v[212:215]
    ds_read_b128 v[184:187], v253 offset:24576
    v_mfma_f32_16x16x32_bf16 v[216:219], a[8:11], v[196:199], v[216:219]
    ds_read_b128 v[196:199], v252 offset:14336
    s_waitcnt lgkmcnt(4)
    v_mfma_f32_16x16x32_bf16 v[212:215], a[104:107], v[192:195], v[212:215]
    ds_read_b128 v[176:179], v252 offset:24576
    v_mfma_f32_16x16x32_bf16 v[220:223], a[76:79], v[204:207], v[220:223]
    ds_read_b128 v[64:67], v11 offset:5120
    v_mfma_f32_16x16x32_bf16 v[220:223], a[80:83], v[180:183], v[220:223]
    ds_read_b128 v[56:59], v11 offset:1024
    v_mfma_f32_16x16x32_bf16 v[216:219], a[12:15], v[204:207], v[216:219]
    ds_read_b128 v[204:207], v253 offset:14336
    v_mfma_f32_16x16x32_bf16 v[216:219], a[16:19], v[180:183], v[216:219]
    ds_read_b128 v[180:183], v252 offset:18432
    v_mfma_f32_16x16x32_bf16 v[208:211], a[40:43], v[192:195], v[208:211]
    s_waitcnt lgkmcnt(8)
    v_mfma_f32_16x16x32_bf16 v[208:211], a[44:47], v[200:203], v[208:211]
    s_waitcnt lgkmcnt(7)
    v_mfma_f32_16x16x32_bf16 v[216:219], a[20:23], v[188:191], v[216:219]
    ds_read_b128 v[68:71], v11 offset:8192
    v_mfma_f32_16x16x32_bf16 v[220:223], a[84:87], v[188:191], v[220:223]
    s_waitcnt lgkmcnt(6)
    v_mfma_f32_16x16x32_bf16 v[220:223], a[88:91], v[196:199], v[220:223]
    ds_read_b128 v[72:75], v11 offset:9216
    v_mfma_f32_16x16x32_bf16 v[216:219], a[24:27], v[196:199], v[216:219]
    ds_read_b128 v[196:199], v252 offset:22528
    v_mfma_f32_16x16x32_bf16 v[212:215], a[108:111], v[200:203], v[212:215]
    ds_read_b128 v[200:203], v253 offset:28672
    s_waitcnt lgkmcnt(8)
    v_mfma_f32_16x16x32_bf16 v[212:215], a[112:115], v[176:179], v[212:215]
    buffer_load_dword v111, v4, s[8:11], s36 offen sc1
    v_mfma_f32_16x16x32_bf16 v[208:211], a[48:51], v[176:179], v[208:211]
    ds_read_b128 v[192:195], v252 offset:28672
    v_mfma_f32_16x16x32_bf16 v[208:211], a[52:55], v[184:187], v[208:211]
    ds_read_b128 v[188:191], v253 offset:18432
    v_mfma_f32_16x16x32_bf16 v[212:215], a[116:119], v[184:187], v[212:215]
    ds_read_b128 v[88:91], v3 offset:3072
    s_waitcnt lgkmcnt(8)
    v_mfma_f32_16x16x32_bf16 v[216:219], a[28:31], v[204:207], v[216:219]
    s_nop 0
    v_mfma_f32_16x16x32_bf16 v[220:223], a[92:95], v[204:207], v[220:223]
    ds_read_b128 v[204:207], v253 offset:22528
    s_waitcnt lgkmcnt(8)
    v_mfma_f32_16x16x32_bf16 v[216:219], a[32:35], v[180:183], v[216:219]
    ds_read_b128 v[84:87], v3 offset:2048
    v_mfma_f32_16x16x32_bf16 v[220:223], a[96:99], v[180:183], v[220:223]
    s_waitcnt lgkmcnt(3)
    v_mfma_f32_16x16x32_bf16 v[220:223], a[100:103], v[188:191], v[220:223]
    v_mfma_f32_16x16x32_bf16 v[220:223], a[104:107], v[196:199], v[220:223]
    ds_read_b128 v[180:183], v252 offset:26624
    v_mfma_f32_16x16x32_bf16 v[208:211], a[56:59], v[192:195], v[208:211]
    v_mfma_f32_16x16x32_bf16 v[208:211], a[60:63], v[200:203], v[208:211]
    v_mfma_f32_16x16x32_bf16 v[212:215], a[120:123], v[192:195], v[212:215]
    v_mfma_f32_16x16x32_bf16 v[212:215], a[124:127], v[200:203], v[212:215]
    ds_read_b128 v[60:63], v11 offset:4096
    v_mfma_f32_16x16x32_bf16 v[216:219], a[36:39], v[188:191], v[216:219]
    ds_read_b128 v[188:191], v253 offset:26624
    v_mfma_f32_16x16x32_bf16 v[216:219], a[40:43], v[196:199], v[216:219]
    ds_read_b128 v[196:199], v252 offset:30720
    s_waitcnt lgkmcnt(5)
    v_mfma_f32_16x16x32_bf16 v[216:219], a[44:47], v[204:207], v[216:219]
    v_cvt_pk_bf16_f32 v226, v212, v213
    s_waitcnt lgkmcnt(3)
    v_mfma_f32_16x16x32_bf16 v[216:219], a[48:51], v[180:183], v[216:219]
    v_cvt_pk_bf16_f32 v227, v214, v215
    v_cvt_pk_bf16_f32 v225, v210, v211
    v_mfma_f32_16x16x32_bf16 v[220:223], a[108:111], v[204:207], v[220:223]
    ds_read_b128 v[204:207], v253 offset:30720
    v_mfma_f32_16x16x32_bf16 v[220:223], a[112:115], v[180:183], v[220:223]
    s_waitcnt lgkmcnt(2)
    v_mfma_f32_16x16x32_bf16 v[220:223], a[116:119], v[188:191], v[220:223]
    s_waitcnt lgkmcnt(1)
    v_mfma_f32_16x16x32_bf16 v[220:223], a[120:123], v[196:199], v[220:223]
    ds_read_b128 v[80:83], v11 offset:13312
    v_cvt_pk_bf16_f32 v224, v208, v209
    v_mfma_f32_16x16x32_bf16 v[216:219], a[52:55], v[188:191], v[216:219]
    ds_write_b128 v8, v[224:227] offset:0
    v_mfma_f32_16x16x32_bf16 v[216:219], a[56:59], v[196:199], v[216:219]
    s_waitcnt lgkmcnt(2)
    v_mfma_f32_16x16x32_bf16 v[216:219], a[60:63], v[204:207], v[216:219]
    ds_read_b128 v[96:99], v3 offset:7168
    v_mfma_f32_16x16x32_bf16 v[220:223], a[124:127], v[204:207], v[220:223]
    s_nop 3
    v_cvt_pk_bf16_f32 v229, v218, v219
    v_cvt_pk_bf16_f32 v228, v216, v217
    s_nop 0
    s_nop 0
    v_cvt_pk_bf16_f32 v230, v220, v221
    v_cvt_pk_bf16_f32 v231, v222, v223
    ds_write_b128 v8, v[228:231] offset:1024
at_r:
    s_waitcnt vmcnt(0)
    v_cmp_gt_u32 vcc, s27, v111
    s_cbranch_vccz at_apgo
at_appoll:
    s_sub_u32 s3, s3, 1
    s_cbranch_scc1 main_timeout
    buffer_load_dword v111, v4, s[8:11], s36 offen sc1
    s_waitcnt vmcnt(0)
    v_cmp_gt_u32_e64 vcc, s27, v111
    s_cbranch_vccnz at_appoll
at_apgo:
    v_max3_u32 v109, v100, v101, v102
    v_max_u32 v109, v109, v103
    v_cmp_eq_u32 s[40:41], s19, v109
    s_add_u32 s22, s49, 2
    s_min_u32 s22, s22, 63
    v_max_u32 v108, v108, v115
    v_cmp_ge_u32 s[50:51], s22, v108
    v_cmp_eq_u32 vcc, s19, v110
    s_nop 0
    s_or_b64 vcc, vcc, s[50:51]
    s_cselect_b32 s52, 0, 1
    s_cselect_b32 s24, 0x7fff0000, s30
    s_cmp_lg_u64 s[40:41], 0
    s_cbranch_scc1 at_xretry
    s_waitcnt lgkmcnt(0)
    s_xor_b32 s23, s42, 0
    buffer_load_dwordx4 v[140:143], v13, s[8:11], s23 offen sc1
    v_lshlrev_b32 v178, 16, v101
    s_xor_b32 s23, s42, 4096
    buffer_load_dwordx4 v[144:147], v13, s[8:11], s23 offen sc1
    s_xor_b32 s23, s42, 8192
    buffer_load_dwordx4 v[148:151], v13, s[8:11], s23 offen sc1
    s_xor_b32 s23, s42, 12288
    buffer_load_dwordx4 v[152:155], v13, s[8:11], s23 offen sc1
    v_and_b32 v179, 0xffff0000, v101
    s_xor_b32 s23, s42, 16384
    buffer_load_dwordx4 v[156:159], v13, s[8:11], s23 offen sc1
    v_lshlrev_b32_e64 v176, 16, v100
    s_xor_b32 s23, s42, 20480
    buffer_load_dwordx4 v[160:163], v13, s[8:11], s23 offen sc1
    s_xor_b32 s23, s42, 24576
    buffer_load_dwordx4 v[164:167], v13, s[8:11], s23 offen sc1
    s_xor_b32 s23, s42, 28672
    buffer_load_dwordx4 v[168:171], v13, s[8:11], s23 offen sc1
    s_barrier
    ds_read_b128 v[28:31], v9 offset:0
    ds_read_b128 v[36:39], v9 offset:4096
    ds_read_b128 v[32:35], v9 offset:2048
    buffer_load_dwordx4 v[116:119], v1, s[8:11], s24 offen offset:0 sc1
    ds_read_b128 v[40:43], v9 offset:6144
    s_waitcnt lgkmcnt(3)
    v_mfma_f32_16x16x32_bf16 v[44:47], v[52:55], v[28:31], v[20:23]
    v_mfma_f32_16x16x32_bf16 v[48:51], v[56:59], v[28:31], v[24:27]
    buffer_load_dwordx4 v[120:123], v1, s[8:11], s24 offen offset:1024 sc1
    s_waitcnt lgkmcnt(1)
    v_mfma_f32_16x16x32_bf16 v[48:51], v[64:67], v[32:35], v[48:51]
    buffer_load_dword v110, off, s[8:11], s30 sc1
    v_mfma_f32_16x16x32_bf16 v[48:51], v[72:75], v[36:39], v[48:51]
    s_waitcnt lgkmcnt(0)
    v_mfma_f32_16x16x32_bf16 v[48:51], v[80:83], v[40:43], v[48:51]
    v_mfma_f32_16x16x32_bf16 v[44:47], v[60:63], v[32:35], v[44:47]
    v_mfma_f32_16x16x32_bf16 v[44:47], v[68:71], v[36:39], v[44:47]
    v_mfma_f32_16x16x32_bf16 v[44:47], v[76:79], v[40:43], v[44:47]
    buffer_load_dword v115, off, s[8:11], s25 sc1
    s_waitcnt vmcnt(11)
    v_mfma_f32_16x16x32_bf16 v[172:175], v[16:19], v[140:143], 0
    s_waitcnt vmcnt(10)
    v_mfma_f32_16x16x32_bf16 v[172:175], v[16:19], v[144:147], v[172:175]
    v_max3_f32 v112, v44, v45, v46
    v_max3_f32 v113, v47, v48, v49
    v_max3_f32 v112, v112, v50, v51
    v_max_f32 v112, v112, v113
    v_mov_b32 v113, v112
    s_waitcnt vmcnt(9)
    v_mfma_f32_16x16x32_bf16 v[172:175], v[16:19], v[148:151], v[172:175]
    s_waitcnt vmcnt(8)
    v_mfma_f32_16x16x32_bf16 v[172:175], v[16:19], v[152:155], v[172:175]
    v_permlane16_swap_b32 v112, v113
    v_max_f32 v112, v112, v113
    v_mov_b32 v113, v112
    s_nop 1
    v_permlane32_swap_b32 v112, v113
    v_max_f32 v112, v112, v113
    v_mul_f32_e64 v112, s18, v112
    v_pk_fma_f32 v[44:45], v[44:45], s[18:19], v[112:113] op_sel_hi:[1,0,0] neg_lo:[0,0,1] neg_hi:[0,0,1]
    v_pk_fma_f32 v[46:47], v[46:47], s[18:19], v[112:113] op_sel_hi:[1,0,0] neg_lo:[0,0,1] neg_hi:[0,0,1]
    v_pk_fma_f32 v[50:51], v[50:51], s[18:19], v[112:113] op_sel_hi:[1,0,0] neg_lo:[0,0,1] neg_hi:[0,0,1]
    v_exp_f32 v45, v45
    v_exp_f32 v50, v50
    v_exp_f32 v51, v51
    v_exp_f32 v47, v47
    v_pk_fma_f32 v[48:49], v[48:49], s[18:19], v[112:113] op_sel_hi:[1,0,0] neg_lo:[0,0,1] neg_hi:[0,0,1]
    v_lshlrev_b32 v182, 16, v103
    s_waitcnt vmcnt(7)
    v_mfma_f32_16x16x32_bf16 v[172:175], v[16:19], v[156:159], v[172:175]
    v_exp_f32 v46, v46
    v_cvt_pk_bf16_f32 v71, v50, v51
    s_waitcnt vmcnt(6)
    v_mfma_f32_16x16x32_bf16 v[172:175], v[16:19], v[160:163], v[172:175]
    v_exp_f32 v49, v49
    s_waitcnt vmcnt(5)
    v_mfma_f32_16x16x32_bf16 v[172:175], v[16:19], v[164:167], v[172:175]
    v_exp_f32 v48, v48
    s_waitcnt vmcnt(4)
    v_mfma_f32_16x16x32_bf16 v[172:175], v[16:19], v[168:171], v[172:175]
    v_cvt_pk_bf16_f32 v69, v46, v47
    v_exp_f32 v44, v44
    s_nop 0
    v_cvt_pk_bf16_f32 v68, v44, v45
    v_pk_add_f32 v[44:45], v[44:45], v[46:47]
    v_lshlrev_b32 v180, 16, v102
    s_mov_b32 exec_hi, 0
    s_nop 0
    ds_write2_b32 v14, v172, v173 offset0:0 offset1:4
    ds_write2_b32 v14, v174, v175 offset0:32 offset1:36
    s_mov_b64 exec, -1
    v_cvt_pk_bf16_f32 v70, v48, v49
    v_pk_add_f32 v[48:49], v[48:49], v[50:51]
    v_pk_add_f32 v[44:45], v[44:45], v[48:49]
    v_add_f32_e64 v114, v44, v45
    v_mov_b32_e64 v113, v114
    v_mfma_f32_16x16x32_bf16 v[64:67], v[96:99], v[68:71], 0
    v_mov_b32_e64 v168, s38
    buffer_store_dword v168, off, s[8:11], s53
    buffer_store_dword v168, off, s[8:11], s48 sc1
    s_waitcnt lgkmcnt(0)
    s_barrier
    ds_read_b128 v[192:195], v15
    ds_read_b128 v[196:199], v15 offset:16
    v_mfma_f32_16x16x32_bf16 v[56:59], v[88:91], v[68:71], 0
    v_permlane16_swap_b32_e64 v114, v113
    v_mfma_f32_16x16x32_bf16 v[52:55], v[84:87], v[68:71], 0
    v_add_f32_e64 v114, v114, v113
    v_mov_b32_e64 v113, v114
    v_mfma_f32_16x16x32_bf16 v[60:63], v[92:95], v[68:71], 0
    s_nop 0
    v_permlane32_swap_b32 v114, v113
    v_add_f32_e64 v114, v114, v113
    v_and_b32 v181, 0xffff0000, v102
    v_and_b32 v183, 0xffff0000, v103
    v_and_b32 v177, 0xffff0000, v100
    s_waitcnt lgkmcnt(1)
    v_pk_add_f32 v[176:177], v[176:177], v[192:193]
    v_cvt_pk_bf16_f32 v200, v176, v177
    v_pk_add_f32 v[178:179], v[178:179], v[194:195]
    v_cvt_pk_bf16_f32 v201, v178, v179
    s_waitcnt lgkmcnt(0)
    v_pk_add_f32 v[182:183], v[182:183], v[198:199]
    v_cvt_pk_bf16_f32 v203, v182, v183
    v_pk_add_f32 v[180:181], v[180:181], v[196:197]
    v_cvt_pk_bf16_f32 v202, v180, v181
    s_waitcnt lgkmcnt(0)
    s_cmp_lg_u32 s12, 0
    s_cbranch_scc1 at_other
    s_cmp_eq_u32 s16, 0
    s_cbranch_scc1 at_row1
    buffer_store_dwordx4 v[200:203], v1, s[56:59], s39 offen
at_other:
    s_cmp_eq_u32 s52, 1
    s_cbranch_scc1 at_nokm_a
    s_add_u32 s22, s49, 2
    s_min_u32 s22, s22, 63
    s_waitcnt vmcnt(2)
    v_max_u32 v108, v108, v115
    v_cmp_ge_u32 s[50:51], s22, v108
    v_cmp_eq_u32 vcc, s19, v110
    s_nop 0
    s_or_b64 vcc, vcc, s[50:51]
    s_cbranch_scc1 at_nokm_a
    buffer_load_dwordx4 v[116:119], v1, s[8:11], s30 offen offset:0 sc1
    buffer_load_dwordx4 v[120:123], v1, s[8:11], s30 offen offset:1024 sc1
    s_mov_b32 s52, 1
at_nokm_a:
    s_branch at_rowdone
    s_nop 0
at_row1:
    v_and_b32 v177, 0xffff0000, v200
    v_lshlrev_b32 v176, 16, v200
    v_and_b32 v179, 0xffff0000, v201
    v_lshlrev_b32 v178, 16, v201
    v_and_b32 v181, 0xffff0000, v202
    v_lshlrev_b32 v180, 16, v202
    v_and_b32 v183, 0xffff0000, v203
    v_lshlrev_b32 v182, 16, v203
    v_pk_mul_f32 v[196:197], v[176:177], v[176:177]
    v_pk_mul_f32 v[198:199], v[178:179], v[178:179]
    v_pk_add_f32 v[192:193], v[176:177], v[178:179]
    v_pk_add_f32 v[194:195], v[180:181], v[182:183]
    v_pk_fma_f32 v[196:197], v[180:181], v[180:181], v[196:197]
    v_pk_fma_f32 v[198:199], v[182:183], v[182:183], v[198:199]
    v_pk_add_f32 v[192:193], v[192:193], v[194:195]
    v_pk_add_f32 v[196:197], v[196:197], v[198:199]
    v_add_f32 v208, v192, v193
    v_add_f32 v210, v196, v197
    v_and_b32 v185, 0xffff0000, v104
    v_add_f32_dpp v208, v208, v208 row_ror:1 row_mask:0xf bank_mask:0xf
    v_add_f32_dpp v210, v210, v210 row_ror:1 row_mask:0xf bank_mask:0xf
    v_lshlrev_b32_e64 v184, 16, v104
    v_add_f32_dpp v208, v208, v208 row_ror:2 row_mask:0xf bank_mask:0xf
    v_add_f32_dpp v210, v210, v210 row_ror:2 row_mask:0xf bank_mask:0xf
    v_and_b32 v187, 0xffff0000, v105
    v_add_f32_dpp v208, v208, v208 row_ror:4 row_mask:0xf bank_mask:0xf
    v_add_f32_dpp v210, v210, v210 row_ror:4 row_mask:0xf bank_mask:0xf
    v_lshlrev_b32 v186, 16, v105
    v_add_f32_dpp v208, v208, v208 row_ror:8 row_mask:0xf bank_mask:0xf
    v_add_f32_dpp v210, v210, v210 row_ror:8 row_mask:0xf bank_mask:0xf
    v_mov_b32 v209, v208
    v_mov_b32_e64 v211, v210
    v_and_b32 v189, 0xffff0000, v106
    v_permlane16_swap_b32 v208, v209
    v_permlane16_swap_b32 v210, v211
    v_add_f32 v208, v208, v209
    v_add_f32 v210, v210, v211
    v_mov_b32 v209, v208
    v_mov_b32 v211, v210
    v_lshlrev_b32 v188, 16, v106
    v_permlane32_swap_b32 v208, v209
    v_permlane32_swap_b32_e64 v210, v211
    v_add_f32_e64 v208, v208, v209
    v_add_f32_e64 v210, v210, v211
    v_mul_f32 v208, 0x3b000000, v208
    v_mul_f32 v210, 0x3b000000, v210
    v_fma_f32 v210, -v208, v208, v210
    v_max_f32_e64 v210, 0, v210
    v_add_f32 v210, 0x3727c5ac, v210
    v_rsq_f32_e64 v210, v210
    v_pk_add_f32 v[192:193], v[176:177], v[208:209] op_sel_hi:[1,0] neg_lo:[0,1] neg_hi:[0,1]
    v_pk_add_f32 v[194:195], v[178:179], v[208:209] op_sel_hi:[1,0] neg_lo:[0,1] neg_hi:[0,1]
    v_pk_add_f32 v[196:197], v[180:181], v[208:209] op_sel_hi:[1,0] neg_lo:[0,1] neg_hi:[0,1]
    v_pk_add_f32 v[198:199], v[182:183], v[208:209] op_sel_hi:[1,0] neg_lo:[0,1] neg_hi:[0,1]
    v_pk_mul_f32 v[192:193], v[192:193], v[210:211] op_sel_hi:[1,0]
    v_pk_mul_f32 v[194:195], v[194:195], v[210:211] op_sel_hi:[1,0]
    v_pk_mul_f32 v[196:197], v[196:197], v[210:211] op_sel_hi:[1,0]
    v_pk_mul_f32 v[198:199], v[198:199], v[210:211] op_sel_hi:[1,0]
    v_and_b32 v191, 0xffff0000, v107
    v_lshlrev_b32_e64 v190, 16, v107
    v_pk_fma_f32 v[176:177], v[192:193], v[184:185], v[176:177]
    v_pk_fma_f32 v[178:179], v[194:195], v[186:187], v[178:179]
    v_pk_fma_f32 v[180:181], v[196:197], v[188:189], v[180:181]
    v_pk_fma_f32 v[182:183], v[198:199], v[190:191], v[182:183]
    v_cvt_pk_bf16_f32 v200, v176, v177
    v_cvt_pk_bf16_f32 v201, v178, v179
    v_cvt_pk_bf16_f32 v202, v180, v181
    v_cvt_pk_bf16_f32 v203, v182, v183
    s_cmp_eq_u32 s52, 1
    s_cbranch_scc1 at_nokm_b
    s_add_u32 s22, s49, 2
    s_min_u32 s22, s22, 63
    s_waitcnt vmcnt(2)
    v_max_u32 v108, v108, v115
    v_cmp_ge_u32 s[50:51], s22, v108
    v_cmp_eq_u32 vcc, s19, v110
    s_nop 0
    s_or_b64 vcc, vcc, s[50:51]
    s_cbranch_scc1 at_nokm_b
    buffer_load_dwordx4 v[116:119], v1, s[8:11], s30 offen offset:0 sc1
    buffer_load_dwordx4 v[120:123], v1, s[8:11], s30 offen offset:1024 sc1
    s_mov_b32 s52, 1
at_nokm_b:
    v_and_b32 v177, 0xffff0000, v200
    v_lshlrev_b32 v180, 16, v202
    v_lshlrev_b32 v182, 16, v203
    v_lshlrev_b32 v178, 16, v201
    v_and_b32 v179, 0xffff0000, v201
    v_and_b32 v183, 0xffff0000, v203
    v_lshlrev_b32_e64 v176, 16, v200
    v_and_b32 v181, 0xffff0000, v202
    v_pk_add_f32 v[192:193], v[176:177], v[178:179]
    v_pk_add_f32 v[194:195], v[180:181], v[182:183]
    v_pk_add_f32 v[192:193], v[192:193], v[194:195]
    v_add_f32_e64 v208, v192, v193
    v_pk_mul_f32 v[196:197], v[176:177], v[176:177]
    v_pk_fma_f32 v[196:197], v[180:181], v[180:181], v[196:197]
    v_add_f32_dpp v208, v208, v208 row_ror:1 row_mask:0xf bank_mask:0xf
    v_pk_mul_f32 v[198:199], v[178:179], v[178:179]
    v_pk_fma_f32 v[198:199], v[182:183], v[182:183], v[198:199]
    v_add_f32_dpp v208, v208, v208 row_ror:2 row_mask:0xf bank_mask:0xf
    v_pk_add_f32 v[196:197], v[196:197], v[198:199]
    v_add_f32 v210, v196, v197
    v_add_f32_dpp v208, v208, v208 row_ror:4 row_mask:0xf bank_mask:0xf
    s_nop 0
    v_add_f32_dpp v210, v210, v210 row_ror:1 row_mask:0xf bank_mask:0xf
    v_add_f32_dpp v208, v208, v208 row_ror:8 row_mask:0xf bank_mask:0xf
    v_mov_b32 v209, v208
    v_add_f32_dpp v210, v210, v210 row_ror:2 row_mask:0xf bank_mask:0xf
    s_nop 0
    v_permlane16_swap_b32 v208, v209
    v_add_f32_dpp v210, v210, v210 row_ror:4 row_mask:0xf bank_mask:0xf
    v_add_f32 v208, v208, v209
    v_mov_b32 v209, v208
    v_add_f32_dpp v210, v210, v210 row_ror:8 row_mask:0xf bank_mask:0xf
    v_mov_b32 v211, v210
    v_permlane32_swap_b32 v208, v209
    v_add_f32 v208, v208, v209
    v_permlane16_swap_b32 v210, v211
    v_add_f32 v210, v210, v211
    v_mul_f32 v208, 0x3b000000, v208
    v_mov_b32_e64 v211, v210
    v_pk_add_f32 v[192:193], v[176:177], v[208:209] op_sel_hi:[1,0] neg_lo:[0,1] neg_hi:[0,1]
    v_pk_add_f32 v[194:195], v[178:179], v[208:209] op_sel_hi:[1,0] neg_lo:[0,1] neg_hi:[0,1]
    v_permlane32_swap_b32 v210, v211
    v_pk_add_f32 v[196:197], v[180:181], v[208:209] op_sel_hi:[1,0] neg_lo:[0,1] neg_hi:[0,1]
    v_add_f32 v210, v210, v211
    v_mul_f32 v210, 0x3b000000, v210
    v_fma_f32 v210, -v208, v208, v210
    v_max_f32_e64 v210, 0, v210
    v_add_f32 v210, 0x3727c5ac, v210
    v_pk_add_f32 v[198:199], v[182:183], v[208:209] op_sel_hi:[1,0] neg_lo:[0,1] neg_hi:[0,1]
    v_rsq_f32 v210, v210
    s_nop 0
    v_pk_mul_f32 v[194:195], v[194:195], v[210:211] op_sel_hi:[1,0]
    v_pk_mul_f32 v[198:199], v[198:199], v[210:211] op_sel_hi:[1,0]
    v_pk_mul_f32 v[196:197], v[196:197], v[210:211] op_sel_hi:[1,0]
    v_pk_mul_f32 v[192:193], v[192:193], v[210:211] op_sel_hi:[1,0]
    v_cvt_pk_bf16_f32 v207, v198, v199
    v_cvt_pk_bf16_f32 v205, v194, v195
    v_cvt_pk_bf16_f32 v206, v196, v197
    v_cvt_pk_bf16_f32 v204, v192, v193
    s_add_u32 s22, s39, 134217728
    s_add_u32 s23, s39, 138412032
    buffer_store_dwordx4 v[204:207], v1, s[8:11], s23 offen sc1
    buffer_store_dwordx4 v[200:203], v1, s[8:11], s22 offen sc1
    s_waitcnt vmcnt(2)
    s_branch at_next
at_rowdone:
    s_waitcnt vmcnt(0)
at_next:
    s_cmp_lt_u32 s49, 64
    s_cbranch_scc1 at_loop
    s_branch at_done
    s_nop 0
    s_nop 0
    s_nop 0
    s_nop 0
    s_nop 0
    s_nop 0
    s_nop 0
at_war_fast:
    s_sub_u32 s3, s3, 1
    s_cbranch_scc1 main_timeout
    buffer_load_dword v111, v4, s[8:11], s36 offen sc1
    s_waitcnt vmcnt(0)
    v_cmp_gt_u32_e64 vcc, s38, v111
    s_cbranch_vccnz at_war_fast
    s_branch at_warok_fast
    s_nop 0
    s_nop 0
    s_nop 0
    s_nop 0
    s_nop 0
    s_nop 0
    s_nop 0
at_war_slow:
    s_sub_u32 s3, s3, 1
    s_cbranch_scc1 main_timeout
    buffer_load_dword v111, v4, s[8:11], s36 offen sc1
    s_waitcnt vmcnt(0)
    v_cmp_gt_u32_e64 vcc, s38, v111
    s_cbranch_vccnz at_war_slow
    s_branch at_warok_slow
    s_nop 0
    s_nop 0
    s_nop 0
    s_nop 0
    s_nop 0
    s_nop 0
at_xretry:
    s_sub_u32 s3, s3, 1
    s_cbranch_scc1 main_timeout
    buffer_load_dwordx4 v[100:103], v1, s[8:11], s26 offen sc1
    s_waitcnt vmcnt(0)
    s_branch at_apgo
    s_nop 0
    s_nop 0
at_done:
    s_waitcnt vmcnt(0)
    s_endpgm
pre_role:
    s_load_dwordx2 s[24:25], s[0:1], 8
    s_mov_b32 s26, 2097152
    s_mov_b32 s27, 0x00020000
    s_load_dwordx2 s[28:29], s[0:1], 16
    s_mov_b32 s30, 2097152
    s_mov_b32 s31, 0x00020000
    s_load_dwordx2 s[32:33], s[0:1], 32
    s_mov_b32 s34, 2097152
    s_mov_b32 s35, 0x00020000
    s_load_dwordx2 s[36:37], s[0:1], 40
    s_mov_b32 s38, 1024
    s_mov_b32 s39, 0x00020000
    s_load_dwordx2 s[40:41], s[0:1], 24
    s_mov_b32 s42, 4096
    s_mov_b32 s43, 0x00020000
    s_lshr_b32 s22, s14, 1
    s_cmp_eq_u32 s14, 6
    s_cselect_b32 s22, 2, s22
    s_lshl_b32 s54, s22, 5
    s_add_u32 s54, s54, s13
    s_lshl_b32 s55, s54, 7
    s_add_u32 s55, s55, 143802368
    s_lshr_b32 s23, s13, 4
    s_lshl_b32 s23, s23, 2
    s_add_u32 s22, s22, s23
    s_lshl_b32 s22, s22, 4
    s_and_b32 s23, s13, 15
    s_add_u32 s22, s22, s23
    s_lshl_b32 s52, s22, 2
    v_and_b32 v15, 63, v0
    v_lshlrev_b32 v10, 4, v15
    v_subrev_u32 v11, 16, v10
    v_cmp_eq_u32_e64 vcc, 0, v15
    v_mov_b32 v12, 0x7ffffff0
    s_nop 0
    v_cndmask_b32 v9, v11, v12, vcc
    s_waitcnt lgkmcnt(0)
    s_add_u32 s53, s52, s12
    s_lshl_b32 s49, s53, 1
    s_lshl_b32 s53, s53, 12
    buffer_load_dwordx4 v[112:115], v9, s[32:35], s53 offen
    buffer_load_dwordx4 v[116:119], v10, s[32:35], s53 offen offset:0
    buffer_load_dwordx4 v[120:123], v10, s[32:35], s53 offen offset:1008
    buffer_load_dwordx4 v[124:127], v10, s[32:35], s53 offen offset:1024
    buffer_load_ushort v108, off, s[36:39], s49
    v_mul_u32_u24 v8, 4096, v0
    s_lshl_b32 s51, s52, 1
    v_add_u32_e64 v8, s51, v8
    s_lshl_b32 s50, s52, 3
    s_movk_i32 s51, 4096
    s_mov_b64 exec, 1
    v_subrev_u32 v7, 3072, v8
    buffer_load_dwordx2 v[144:145], v7, s[24:27], 0 offen
    v_subrev_u32 v7, 2048, v8
    buffer_load_dwordx2 v[146:147], v7, s[24:27], 0 offen
    v_subrev_u32 v7, 1024, v8
    buffer_load_dwordx2 v[148:149], v7, s[24:27], 0 offen
    s_mov_b64 exec, -1
    buffer_load_dwordx2 v[150:151], v8, s[24:27], 0 offen offset:0
    buffer_load_dwordx2 v[188:189], v8, s[28:31], 0 offen offset:0
    buffer_load_dwordx2 v[152:153], v8, s[24:27], 0 offen offset:1024
    buffer_load_dwordx2 v[190:191], v8, s[28:31], 0 offen offset:1024
    buffer_load_dwordx2 v[154:155], v8, s[24:27], 0 offen offset:2048
    buffer_load_dwordx2 v[192:193], v8, s[28:31], 0 offen offset:2048
    buffer_load_dwordx2 v[156:157], v8, s[24:27], 0 offen offset:3072
    buffer_load_dwordx2 v[194:195], v8, s[28:31], 0 offen offset:3072
    buffer_load_dwordx4 v[220:223], off, s[40:43], s50 offset:0
    buffer_load_dwordx4 v[224:227], off, s[40:43], s50 offset:16
    s_cmp_eq_u32 s67, 0
    s_cbranch_scc1 clm_30
    s_lshl_b32 s21, 1, s13
    v_mov_b32 v255, s21
    s_lshl_b32 s22, s14, 2
    s_mov_b64 exec, 1
    buffer_atomic_or v255, off, s[4:7], s22 sc0
    s_mov_b64 exec, -1
    s_mov_b32 s67, 0
    s_branch clm_30_d
    s_nop 0
    s_nop 0
    s_nop 0
    s_nop 0
    s_nop 0
    s_nop 0
clm_30:
    buffer_load_dword v253, off, s[4:7], 0 offset:1024
clm_30_d:
    s_mul_i32 s48, s12, 40960
    v_mov_b32 v40, 0
    v_mov_b32 v41, 0
    v_mov_b32 v42, 0
    v_mov_b32 v43, 0
    v_add_u32 v14, s48, v10
    ds_write_b128 v14, v[40:43] offset:19456
    ds_write_b128 v14, v[40:43] offset:20480
    ds_write_b128 v14, v[40:43] offset:20912
    v_and_b32 v12, 7, v15
    v_mul_u32_u24 v12, 2112, v12
    v_add_u32_e64 v12, s48, v12
    ds_write_b128 v12, v[40:43]
    ds_write_b128 v12, v[40:43] offset:16
    ds_write_b128 v12, v[40:43] offset:32
    v_sub_u32 v11, 255, v0
    v_lshrrev_b32 v13, 3, v11
    v_mul_u32_u24 v13, 80, v13
    v_and_b32 v11, 7, v11
    v_lshl_add_u32 v13, v11, 3, v13
    v_add_u32 v13, 16896, v13
    v_add_u32 v11, 81920, v13
    v_and_b32 v3, 31, v15
    v_lshrrev_b32 v4, 5, v15
    v_lshrrev_b32 v6, 3, v3
    v_add_u32 v6, v6, v4
    v_lshl_add_u32 v5, v6, 4, v12
    v_sub_u32_e64 v6, 31, v3
    v_mul_u32_u24 v6, 80, v6
    v_lshl_add_u32 v6, v4, 4, v6
    v_add_u32 v6, s48, v6
    v_lshlrev_b32 v3, 6, v3
    v_lshl_add_u32 v3, v4, 4, v3
    s_waitcnt vmcnt(14)
    v_lshlrev_b32 v8, 16, v108
    v_lshlrev_b32 v7, 16, v116
    v_add_f32 v7, v7, v8
    v_cvt_pk_bf16_f32 v7, v7, v7
    v_mov_b32 v8, 0xffff
    v_bfi_b32 v7, v8, v7, v116
    v_cmp_eq_u32 vcc, 0, v15
    s_nop 0
    s_nop 0
    v_cndmask_b32 v116, v116, v7, vcc
    v_alignbit_b32 v48, v113, v112, 16
    v_alignbit_b32 v49, v114, v113, 16
    v_alignbit_b32 v50, v115, v114, 16
    v_alignbit_b32 v51, v116, v115, 16
    ds_write_b128 v14, v[48:51] offset:48
    v_mov_b32 v52, v113
    v_mov_b32 v53, v114
    v_mov_b32 v54, v115
    v_mov_b32 v55, v116
    ds_write_b128 v14, v[52:55] offset:2160
    v_alignbit_b32 v48, v114, v113, 16
    v_alignbit_b32 v49, v115, v114, 16
    v_alignbit_b32 v50, v116, v115, 16
    v_alignbit_b32 v51, v117, v116, 16
    ds_write_b128 v14, v[48:51] offset:4272
    ds_write_b128 v14, v[114:117] offset:6384
    v_alignbit_b32 v48, v115, v114, 16
    v_alignbit_b32 v49, v116, v115, 16
    v_alignbit_b32 v50, v117, v116, 16
    v_alignbit_b32 v51, v118, v117, 16
    ds_write_b128 v14, v[48:51] offset:8496
    v_mov_b32 v52, v115
    v_mov_b32 v53, v116
    v_mov_b32 v54, v117
    v_mov_b32 v55, v118
    ds_write_b128 v14, v[52:55] offset:10608
    v_alignbit_b32 v48, v116, v115, 16
    v_alignbit_b32 v49, v117, v116, 16
    v_alignbit_b32 v50, v118, v117, 16
    v_alignbit_b32 v51, v119, v118, 16
    ds_write_b128 v14, v[48:51] offset:12720
    ds_write_b128 v14, v[116:119] offset:14832
    v_alignbit_b32 v48, v121, v120, 16
    v_alignbit_b32 v49, v122, v121, 16
    v_alignbit_b32 v50, v123, v122, 16
    v_alignbit_b32 v51, v124, v123, 16
    ds_write_b128 v14, v[48:51] offset:1072
    v_mov_b32 v52, v121
    v_mov_b32 v53, v122
    v_mov_b32 v54, v123
    v_mov_b32 v55, v124
    ds_write_b128 v14, v[52:55] offset:3184
    v_alignbit_b32 v48, v122, v121, 16
    v_alignbit_b32 v49, v123, v122, 16
    v_alignbit_b32 v50, v124, v123, 16
    v_alignbit_b32 v51, v125, v124, 16
    ds_write_b128 v14, v[48:51] offset:5296
    ds_write_b128 v14, v[122:125] offset:7408
    v_alignbit_b32 v48, v123, v122, 16
    v_alignbit_b32 v49, v124, v123, 16
    v_alignbit_b32 v50, v125, v124, 16
    v_alignbit_b32 v51, v126, v125, 16
    ds_write_b128 v14, v[48:51] offset:9520
    v_mov_b32_e64 v52, v123
    v_mov_b32_e64 v53, v124
    v_mov_b32_e64 v54, v125
    v_mov_b32_e64 v55, v126
    ds_write_b128 v14, v[52:55] offset:11632
    v_alignbit_b32 v48, v124, v123, 16
    v_alignbit_b32 v49, v125, v124, 16
    v_alignbit_b32 v50, v126, v125, 16
    v_alignbit_b32 v51, v127, v126, 16
    ds_write_b128 v14, v[48:51] offset:13744
    ds_write_b128 v14, v[124:127] offset:15856
    s_waitcnt vmcnt(8)
    v_mov_b32_dpp v144, v152 wave_shr:1 row_mask:0xf bank_mask:0xf
    v_mov_b32_dpp v145, v153 wave_shr:1 row_mask:0xf bank_mask:0xf
    s_waitcnt vmcnt(6)
    v_mov_b32_dpp v146, v154 wave_shr:1 row_mask:0xf bank_mask:0xf
    v_mov_b32_dpp v147, v155 wave_shr:1 row_mask:0xf bank_mask:0xf
    s_waitcnt vmcnt(4)
    v_mov_b32_dpp v148, v156 wave_shr:1 row_mask:0xf bank_mask:0xf
    v_mov_b32_dpp v149, v157 wave_shr:1 row_mask:0xf bank_mask:0xf
    s_waitcnt vmcnt(2)
    v_lshlrev_b32 v16, 16, v220
    v_and_b32 v17, 0xffff0000, v220
    v_lshlrev_b32 v18, 16, v221
    v_and_b32 v19, 0xffff0000, v221
    v_lshlrev_b32 v20, 16, v144
    v_lshlrev_b32 v21, 16, v146
    v_lshlrev_b32 v22, 16, v148
    v_lshlrev_b32 v23, 16, v150
    v_lshlrev_b32 v24, 16, v152
    v_lshlrev_b32 v25, 16, v154
    v_lshlrev_b32 v26, 16, v156
    v_mul_f32 v32, v23, v16
    v_mul_f32 v33, v24, v16
    v_mul_f32 v34, v25, v16
    v_mul_f32 v35, v26, v16
    v_fmac_f32 v32, v22, v17
    v_fmac_f32 v33, v23, v17
    v_fmac_f32 v34, v24, v17
    v_fmac_f32 v35, v25, v17
    v_fmac_f32 v32, v21, v18
    v_fmac_f32 v33, v22, v18
    v_fmac_f32 v34, v23, v18
    v_fmac_f32 v35, v24, v18
    v_fmac_f32 v32, v20, v19
    v_fmac_f32 v33, v21, v19
    v_fmac_f32 v34, v22, v19
    v_fmac_f32 v35, v23, v19
    v_lshlrev_b32 v20, 16, v188
    v_lshlrev_b32 v21, 16, v190
    v_lshlrev_b32 v22, 16, v192
    v_lshlrev_b32_e64 v23, 16, v194
    v_pk_mul_f32 v[32:33], v[32:33], v[20:21]
    v_pk_mul_f32 v[34:35], v[34:35], v[22:23]
    v_cvt_pk_bf16_f32 v40, v35, v34
    v_cvt_pk_bf16_f32 v41, v33, v32
    ds_write_b64 v13, v[40:41] offset:0
    v_lshlrev_b32 v16, 16, v222
    v_and_b32 v17, 0xffff0000, v222
    v_lshlrev_b32 v18, 16, v223
    v_and_b32 v19, 0xffff0000, v223
    v_and_b32 v20, 0xffff0000, v144
    v_and_b32 v21, 0xffff0000, v146
    v_and_b32 v22, 0xffff0000, v148
    v_and_b32 v23, 0xffff0000, v150
    v_and_b32 v24, 0xffff0000, v152
    v_and_b32 v25, 0xffff0000, v154
    v_and_b32 v26, 0xffff0000, v156
    v_mul_f32 v32, v23, v16
    v_mul_f32 v33, v24, v16
    v_mul_f32 v34, v25, v16
    v_mul_f32 v35, v26, v16
    v_fmac_f32 v32, v22, v17
    v_fmac_f32 v33, v23, v17
    v_fmac_f32 v34, v24, v17
    v_fmac_f32 v35, v25, v17
    v_fmac_f32 v32, v21, v18
    v_fmac_f32 v33, v22, v18
    v_fmac_f32 v34, v23, v18
    v_fmac_f32 v35, v24, v18
    v_fmac_f32 v32, v20, v19
    v_fmac_f32 v33, v21, v19
    v_fmac_f32 v34, v22, v19
    v_fmac_f32 v35, v23, v19
    v_and_b32 v20, 0xffff0000, v188
    v_and_b32 v21, 0xffff0000, v190
    v_and_b32 v22, 0xffff0000, v192
    v_and_b32 v23, 0xffff0000, v194
    v_pk_mul_f32 v[32:33], v[32:33], v[20:21]
    v_pk_mul_f32 v[34:35], v[34:35], v[22:23]
    v_cvt_pk_bf16_f32 v44, v35, v34
    v_cvt_pk_bf16_f32 v45, v33, v32
    ds_write_b64 v13, v[44:45] offset:40960
    s_waitcnt vmcnt(1)
    v_lshlrev_b32 v16, 16, v224
    v_and_b32 v17, 0xffff0000, v224
    v_lshlrev_b32_e64 v18, 16, v225
    v_and_b32 v19, 0xffff0000, v225
    v_lshlrev_b32 v20, 16, v145
    v_lshlrev_b32 v21, 16, v147
    v_lshlrev_b32 v22, 16, v149
    v_lshlrev_b32 v23, 16, v151
    v_lshlrev_b32 v24, 16, v153
    v_lshlrev_b32 v25, 16, v155
    v_lshlrev_b32 v26, 16, v157
    v_mul_f32 v32, v23, v16
    v_mul_f32 v33, v24, v16
    v_mul_f32 v34, v25, v16
    v_mul_f32 v35, v26, v16
    v_fmac_f32 v32, v22, v17
    v_fmac_f32 v33, v23, v17
    v_fmac_f32 v34, v24, v17
    v_fmac_f32 v35, v25, v17
    v_fmac_f32 v32, v21, v18
    v_fmac_f32 v33, v22, v18
    v_fmac_f32 v34, v23, v18
    v_fmac_f32 v35, v24, v18
    v_fmac_f32 v32, v20, v19
    v_fmac_f32 v33, v21, v19
    v_fmac_f32 v34, v22, v19
    v_fmac_f32 v35, v23, v19
    v_lshlrev_b32 v20, 16, v189
    v_lshlrev_b32 v21, 16, v191
    v_lshlrev_b32 v22, 16, v193
    v_lshlrev_b32_e64 v23, 16, v195
    v_pk_mul_f32 v[32:33], v[32:33], v[20:21]
    v_pk_mul_f32 v[34:35], v[34:35], v[22:23]
    v_cvt_pk_bf16_f32 v40, v35, v34
    v_cvt_pk_bf16_f32 v41, v33, v32
    ds_write_b64 v11, v[40:41] offset:0
    v_lshlrev_b32 v16, 16, v226
    v_and_b32 v17, 0xffff0000, v226
    v_lshlrev_b32 v18, 16, v227
    v_and_b32 v19, 0xffff0000, v227
    v_and_b32 v20, 0xffff0000, v145
    v_and_b32 v21, 0xffff0000, v147
    v_and_b32 v22, 0xffff0000, v149
    v_and_b32 v23, 0xffff0000, v151
    v_and_b32 v24, 0xffff0000, v153
    v_and_b32 v25, 0xffff0000, v155
    v_and_b32 v26, 0xffff0000, v157
    v_mul_f32 v32, v23, v16
    v_mul_f32 v33, v24, v16
    v_mul_f32 v34, v25, v16
    v_mul_f32 v35, v26, v16
    v_fmac_f32 v32, v22, v17
    v_fmac_f32 v33, v23, v17
    v_fmac_f32 v34, v24, v17
    v_fmac_f32 v35, v25, v17
    v_fmac_f32 v32, v21, v18
    v_fmac_f32 v33, v22, v18
    v_fmac_f32_e64 v34, v23, v18
    v_fmac_f32_e64 v35, v24, v18
    v_fmac_f32_e64 v32, v20, v19
    v_fmac_f32_e64 v33, v21, v19
    v_fmac_f32_e64 v34, v22, v19
    v_fmac_f32_e64 v35, v23, v19
    v_and_b32 v20, 0xffff0000, v189
    v_and_b32 v21, 0xffff0000, v191
    v_and_b32 v22, 0xffff0000, v193
    v_and_b32 v23, 0xffff0000, v195
    v_pk_mul_f32 v[32:33], v[32:33], v[20:21]
    v_pk_mul_f32 v[34:35], v[34:35], v[22:23]
    v_cvt_pk_bf16_f32 v44, v35, v34
    v_cvt_pk_bf16_f32 v45, v33, v32
    ds_write_b64 v11, v[44:45] offset:40960
    s_add_u32 s21, s53, 127926272
    s_waitcnt lgkmcnt(0)
    s_waitcnt vmcnt(0)
    v_mov_b32 v17, 30720
    s_cmp_lg_u32 s12, 0
    s_cbranch_scc1 rdy_31
    s_mov_b64 exec, 1
    ds_write_b32 v17, v255
    s_mov_b64 exec, -1
    s_waitcnt lgkmcnt(0)
rdy_31:
    s_barrier
    ds_read_b32 v16, v17
    s_waitcnt lgkmcnt(0)
    v_readfirstlane_b32 s22, v16
    s_barrier
    s_bitcmp1_b32 s22, s13
    s_cbranch_scc1 main_late
    v_mov_b32_e64 v1, 0
    buffer_store_dword v1, off, s[8:11], s55 sc1
    s_lshl_b32 s50, s13, 4
    s_load_dwordx2 s[44:45], s[0:1], 0
    s_mov_b32 s46, 2097152
    s_mov_b32 s47, 0x00020000
    v_and_b32 v10, 63, v0
    v_lshlrev_b32 v10, 4, v10
    s_lshl_b32 s48, s50, 10
    s_lshl_b32 s49, s12, 12
    s_add_u32 s48, s48, s49
    s_waitcnt lgkmcnt(0)
    buffer_load_dwordx4 v[112:115], v10, s[44:47], s48 offen offset:0
    buffer_load_dwordx4 v[116:119], v10, s[44:47], s48 offen offset:1024
    buffer_load_dwordx4 v[120:123], v10, s[44:47], s48 offen offset:2048
    buffer_load_dwordx4 v[124:127], v10, s[44:47], s48 offen offset:3072
    ds_read_b128 v[16:19], v5 offset:0
    ds_read_b128 v[20:23], v6 offset:16896
    ds_read_b128 v[24:27], v5 offset:32
    ds_read_b128 v[28:31], v6 offset:16928
    ds_read_b128 v[32:35], v5 offset:64
    ds_read_b128 v[36:39], v6 offset:16976
    s_waitcnt lgkmcnt(4)
    v_mfma_f32_32x32x16_bf16 v[64:79], v[16:19], v[20:23], 0
    ds_read_b128 v[40:43], v5 offset:96
    ds_read_b128 v[44:47], v6 offset:17008
    s_waitcnt lgkmcnt(4)
    v_mfma_f32_32x32x16_bf16 v[64:79], v[24:27], v[28:31], v[64:79]
    ds_read_b128 v[16:19], v5 offset:128
    ds_read_b128 v[20:23], v6 offset:17056
    s_waitcnt lgkmcnt(4)
    v_mfma_f32_32x32x16_bf16 v[64:79], v[32:35], v[36:39], v[64:79]
    ds_read_b128 v[24:27], v5 offset:160
    ds_read_b128 v[28:31], v6 offset:17088
    s_waitcnt lgkmcnt(4)
    v_mfma_f32_32x32x16_bf16 v[64:79], v[40:43], v[44:47], v[64:79]
    ds_read_b128 v[32:35], v5 offset:192
    ds_read_b128 v[36:39], v6 offset:17136
    s_waitcnt lgkmcnt(4)
    v_mfma_f32_32x32x16_bf16 v[64:79], v[16:19], v[20:23], v[64:79]
    ds_read_b128 v[40:43], v5 offset:224
    ds_read_b128 v[44:47], v6 offset:17168
    s_waitcnt lgkmcnt(4)
    v_mfma_f32_32x32x16_bf16 v[64:79], v[24:27], v[28:31], v[64:79]
    ds_read_b128 v[16:19], v5 offset:256
    ds_read_b128 v[20:23], v6 offset:17216
    s_waitcnt lgkmcnt(4)
    v_mfma_f32_32x32x16_bf16 v[64:79], v[32:35], v[36:39], v[64:79]
    ds_read_b128 v[24:27], v5 offset:288
    ds_read_b128 v[28:31], v6 offset:17248
    s_waitcnt lgkmcnt(4)
    v_mfma_f32_32x32x16_bf16 v[64:79], v[40:43], v[44:47], v[64:79]
    ds_read_b128 v[32:35], v5 offset:320
    ds_read_b128 v[36:39], v6 offset:17296
    s_waitcnt lgkmcnt(4)
    v_mfma_f32_32x32x16_bf16 v[64:79], v[16:19], v[20:23], v[64:79]
    ds_read_b128 v[40:43], v5 offset:352
    ds_read_b128 v[44:47], v6 offset:17328
    s_waitcnt lgkmcnt(4)
    v_mfma_f32_32x32x16_bf16 v[64:79], v[24:27], v[28:31], v[64:79]
    ds_read_b128 v[16:19], v5 offset:384
    ds_read_b128 v[20:23], v6 offset:17376
    s_waitcnt lgkmcnt(4)
    v_mfma_f32_32x32x16_bf16 v[64:79], v[32:35], v[36:39], v[64:79]
    ds_read_b128 v[24:27], v5 offset:416
    ds_read_b128 v[28:31], v6 offset:17408
    s_waitcnt lgkmcnt(4)
    v_mfma_f32_32x32x16_bf16 v[64:79], v[40:43], v[44:47], v[64:79]
    ds_read_b128 v[32:35], v5 offset:448
    ds_read_b128 v[36:39], v6 offset:17456
    s_waitcnt lgkmcnt(4)
    v_mfma_f32_32x32x16_bf16 v[64:79], v[16:19], v[20:23], v[64:79]
    ds_read_b128 v[40:43], v5 offset:480
    ds_read_b128 v[44:47], v6 offset:17488
    s_waitcnt lgkmcnt(4)
    v_mfma_f32_32x32x16_bf16 v[64:79], v[24:27], v[28:31], v[64:79]
    ds_read_b128 v[16:19], v5 offset:512
    ds_read_b128 v[20:23], v6 offset:17536
    s_waitcnt lgkmcnt(4)
    v_mfma_f32_32x32x16_bf16 v[64:79], v[32:35], v[36:39], v[64:79]
    ds_read_b128 v[24:27], v5 offset:544
    ds_read_b128 v[28:31], v6 offset:17568
    s_waitcnt lgkmcnt(4)
    v_mfma_f32_32x32x16_bf16 v[64:79], v[40:43], v[44:47], v[64:79]
    ds_read_b128 v[32:35], v5 offset:576
    ds_read_b128 v[36:39], v6 offset:17616
    s_waitcnt lgkmcnt(4)
    v_mfma_f32_32x32x16_bf16 v[64:79], v[16:19], v[20:23], v[64:79]
    ds_read_b128 v[40:43], v5 offset:608
    ds_read_b128 v[44:47], v6 offset:17648
    s_waitcnt lgkmcnt(4)
    v_mfma_f32_32x32x16_bf16 v[64:79], v[24:27], v[28:31], v[64:79]
    ds_read_b128 v[16:19], v5 offset:640
    ds_read_b128 v[20:23], v6 offset:17696
    s_waitcnt lgkmcnt(4)
    v_mfma_f32_32x32x16_bf16 v[64:79], v[32:35], v[36:39], v[64:79]
    ds_read_b128 v[24:27], v5 offset:672
    ds_read_b128 v[28:31], v6 offset:17728
    s_waitcnt lgkmcnt(4)
    v_mfma_f32_32x32x16_bf16 v[64:79], v[40:43], v[44:47], v[64:79]
    ds_read_b128 v[32:35], v5 offset:704
    ds_read_b128 v[36:39], v6 offset:17776
    s_waitcnt lgkmcnt(4)
    v_mfma_f32_32x32x16_bf16 v[64:79], v[16:19], v[20:23], v[64:79]
    ds_read_b128 v[40:43], v5 offset:736
    ds_read_b128 v[44:47], v6 offset:17808
    s_waitcnt lgkmcnt(4)
    v_mfma_f32_32x32x16_bf16 v[64:79], v[24:27], v[28:31], v[64:79]
    ds_read_b128 v[16:19], v5 offset:768
    ds_read_b128 v[20:23], v6 offset:17856
    s_waitcnt lgkmcnt(4)
    v_mfma_f32_32x32x16_bf16 v[64:79], v[32:35], v[36:39], v[64:79]
    ds_read_b128 v[24:27], v5 offset:800
    ds_read_b128 v[28:31], v6 offset:17888
    s_waitcnt lgkmcnt(4)
    v_mfma_f32_32x32x16_bf16 v[64:79], v[40:43], v[44:47], v[64:79]
    ds_read_b128 v[32:35], v5 offset:832
    ds_read_b128 v[36:39], v6 offset:17936
    s_waitcnt lgkmcnt(4)
    v_mfma_f32_32x32x16_bf16 v[64:79], v[16:19], v[20:23], v[64:79]
    ds_read_b128 v[40:43], v5 offset:864
    ds_read_b128 v[44:47], v6 offset:17968
    s_waitcnt lgkmcnt(4)
    v_mfma_f32_32x32x16_bf16 v[64:79], v[24:27], v[28:31], v[64:79]
    ds_read_b128 v[16:19], v5 offset:896
    ds_read_b128 v[20:23], v6 offset:18016
    s_waitcnt lgkmcnt(4)
    v_mfma_f32_32x32x16_bf16 v[64:79], v[32:35], v[36:39], v[64:79]
    ds_read_b128 v[24:27], v5 offset:928
    ds_read_b128 v[28:31], v6 offset:18048
    s_waitcnt lgkmcnt(4)
    v_mfma_f32_32x32x16_bf16 v[64:79], v[40:43], v[44:47], v[64:79]
    ds_read_b128 v[32:35], v5 offset:960
    ds_read_b128 v[36:39], v6 offset:18096
    s_waitcnt lgkmcnt(4)
    v_mfma_f32_32x32x16_bf16 v[64:79], v[16:19], v[20:23], v[64:79]
    ds_read_b128 v[40:43], v5 offset:992
    ds_read_b128 v[44:47], v6 offset:18128
    s_waitcnt lgkmcnt(4)
    v_mfma_f32_32x32x16_bf16 v[64:79], v[24:27], v[28:31], v[64:79]
    ds_read_b128 v[16:19], v5 offset:1024
    ds_read_b128 v[20:23], v6 offset:18176
    s_waitcnt lgkmcnt(4)
    v_mfma_f32_32x32x16_bf16 v[64:79], v[32:35], v[36:39], v[64:79]
    ds_read_b128 v[24:27], v5 offset:1056
    ds_read_b128 v[28:31], v6 offset:18208
    s_cmp_lg_u32 s12, 0
    s_cbranch_scc1 pw_cnt
    s_waitcnt vmcnt(4)
    s_mov_b64 exec, 1
    v_mov_b32_e64 v1, 1
    buffer_atomic_add v1, off, s[4:7], 0 offset:140
    s_mov_b64 exec, -1
pw_cnt:
    s_waitcnt lgkmcnt(4)
    v_mfma_f32_32x32x16_bf16 v[64:79], v[40:43], v[44:47], v[64:79]
    ds_read_b128 v[32:35], v5 offset:1088
    ds_read_b128 v[36:39], v6 offset:18256
    s_waitcnt lgkmcnt(4)
    v_mfma_f32_32x32x16_bf16 v[64:79], v[16:19], v[20:23], v[64:79]
    ds_read_b128 v[40:43], v5 offset:1120
    ds_read_b128 v[44:47], v6 offset:18288
    s_waitcnt lgkmcnt(4)
    v_mfma_f32_32x32x16_bf16 v[64:79], v[24:27], v[28:31], v[64:79]
    ds_read_b128 v[16:19], v5 offset:1152
    ds_read_b128 v[20:23], v6 offset:18336
    s_waitcnt lgkmcnt(4)
    v_mfma_f32_32x32x16_bf16 v[64:79], v[32:35], v[36:39], v[64:79]
    ds_read_b128 v[24:27], v5 offset:1184
    ds_read_b128 v[28:31], v6 offset:18368
    s_waitcnt lgkmcnt(4)
    v_mfma_f32_32x32x16_bf16 v[64:79], v[40:43], v[44:47], v[64:79]
    ds_read_b128 v[32:35], v5 offset:1216
    ds_read_b128 v[36:39], v6 offset:18416
    s_waitcnt lgkmcnt(4)
    v_mfma_f32_32x32x16_bf16 v[64:79], v[16:19], v[20:23], v[64:79]
    ds_read_b128 v[40:43], v5 offset:1248
    ds_read_b128 v[44:47], v6 offset:18448
    s_waitcnt lgkmcnt(4)
    v_mfma_f32_32x32x16_bf16 v[64:79], v[24:27], v[28:31], v[64:79]
    ds_read_b128 v[16:19], v5 offset:1280
    ds_read_b128 v[20:23], v6 offset:18496
    s_waitcnt lgkmcnt(4)
    v_mfma_f32_32x32x16_bf16 v[64:79], v[32:35], v[36:39], v[64:79]
    ds_read_b128 v[24:27], v5 offset:1312
    ds_read_b128 v[28:31], v6 offset:18528
    s_waitcnt lgkmcnt(4)
    v_mfma_f32_32x32x16_bf16 v[64:79], v[40:43], v[44:47], v[64:79]
    ds_read_b128 v[32:35], v5 offset:1344
    ds_read_b128 v[36:39], v6 offset:18576
    s_waitcnt lgkmcnt(4)
    v_mfma_f32_32x32x16_bf16 v[64:79], v[16:19], v[20:23], v[64:79]
    ds_read_b128 v[40:43], v5 offset:1376
    ds_read_b128 v[44:47], v6 offset:18608
    s_waitcnt lgkmcnt(4)
    v_mfma_f32_32x32x16_bf16 v[64:79], v[24:27], v[28:31], v[64:79]
    ds_read_b128 v[16:19], v5 offset:1408
    ds_read_b128 v[20:23], v6 offset:18656
    s_waitcnt lgkmcnt(4)
    v_mfma_f32_32x32x16_bf16 v[64:79], v[32:35], v[36:39], v[64:79]
    ds_read_b128 v[24:27], v5 offset:1440
    ds_read_b128 v[28:31], v6 offset:18688
    s_waitcnt lgkmcnt(4)
    v_mfma_f32_32x32x16_bf16 v[64:79], v[40:43], v[44:47], v[64:79]
    ds_read_b128 v[32:35], v5 offset:1472
    ds_read_b128 v[36:39], v6 offset:18736
    s_waitcnt lgkmcnt(4)
    v_mfma_f32_32x32x16_bf16 v[64:79], v[16:19], v[20:23], v[64:79]
    ds_read_b128 v[40:43], v5 offset:1504
    ds_read_b128 v[44:47], v6 offset:18768
    s_waitcnt lgkmcnt(4)
    v_mfma_f32_32x32x16_bf16 v[64:79], v[24:27], v[28:31], v[64:79]
    ds_read_b128 v[16:19], v5 offset:1536
    ds_read_b128 v[20:23], v6 offset:18816
    s_waitcnt lgkmcnt(4)
    v_mfma_f32_32x32x16_bf16 v[64:79], v[32:35], v[36:39], v[64:79]
    ds_read_b128 v[24:27], v5 offset:1568
    ds_read_b128 v[28:31], v6 offset:18848
    s_waitcnt lgkmcnt(4)
    v_mfma_f32_32x32x16_bf16 v[64:79], v[40:43], v[44:47], v[64:79]
    ds_read_b128 v[32:35], v5 offset:1600
    ds_read_b128 v[36:39], v6 offset:18896
    s_waitcnt lgkmcnt(4)
    v_mfma_f32_32x32x16_bf16 v[64:79], v[16:19], v[20:23], v[64:79]
    ds_read_b128 v[40:43], v5 offset:1632
    ds_read_b128 v[44:47], v6 offset:18928
    s_waitcnt lgkmcnt(4)
    v_mfma_f32_32x32x16_bf16 v[64:79], v[24:27], v[28:31], v[64:79]
    ds_read_b128 v[16:19], v5 offset:1664
    ds_read_b128 v[20:23], v6 offset:18976
    s_waitcnt lgkmcnt(4)
    v_mfma_f32_32x32x16_bf16 v[64:79], v[32:35], v[36:39], v[64:79]
    ds_read_b128 v[24:27], v5 offset:1696
    ds_read_b128 v[28:31], v6 offset:19008
    s_waitcnt lgkmcnt(4)
    v_mfma_f32_32x32x16_bf16 v[64:79], v[40:43], v[44:47], v[64:79]
    ds_read_b128 v[32:35], v5 offset:1728
    ds_read_b128 v[36:39], v6 offset:19056
    s_waitcnt lgkmcnt(4)
    v_mfma_f32_32x32x16_bf16 v[64:79], v[16:19], v[20:23], v[64:79]
    ds_read_b128 v[40:43], v5 offset:1760
    ds_read_b128 v[44:47], v6 offset:19088
    s_waitcnt lgkmcnt(4)
    v_mfma_f32_32x32x16_bf16 v[64:79], v[24:27], v[28:31], v[64:79]
    ds_read_b128 v[16:19], v5 offset:1792
    ds_read_b128 v[20:23], v6 offset:19136
    s_waitcnt lgkmcnt(4)
    v_mfma_f32_32x32x16_bf16 v[64:79], v[32:35], v[36:39], v[64:79]
    ds_read_b128 v[24:27], v5 offset:1824
    ds_read_b128 v[28:31], v6 offset:19168
    s_waitcnt lgkmcnt(4)
    v_mfma_f32_32x32x16_bf16 v[64:79], v[40:43], v[44:47], v[64:79]
    ds_read_b128 v[32:35], v5 offset:1856
    ds_read_b128 v[36:39], v6 offset:19216
    s_waitcnt lgkmcnt(4)
    v_mfma_f32_32x32x16_bf16 v[64:79], v[16:19], v[20:23], v[64:79]
    ds_read_b128 v[40:43], v5 offset:1888
    ds_read_b128 v[44:47], v6 offset:19248
    s_waitcnt lgkmcnt(4)
    v_mfma_f32_32x32x16_bf16 v[64:79], v[24:27], v[28:31], v[64:79]
    ds_read_b128 v[16:19], v5 offset:1920
    ds_read_b128 v[20:23], v6 offset:19296
    s_waitcnt lgkmcnt(4)
    v_mfma_f32_32x32x16_bf16 v[64:79], v[32:35], v[36:39], v[64:79]
    ds_read_b128 v[24:27], v5 offset:1952
    ds_read_b128 v[28:31], v6 offset:19328
    s_waitcnt lgkmcnt(4)
    v_mfma_f32_32x32x16_bf16 v[64:79], v[40:43], v[44:47], v[64:79]
    ds_read_b128 v[32:35], v5 offset:1984
    ds_read_b128 v[36:39], v6 offset:19376
    s_waitcnt lgkmcnt(4)
    v_mfma_f32_32x32x16_bf16 v[64:79], v[16:19], v[20:23], v[64:79]
    ds_read_b128 v[40:43], v5 offset:2016
    ds_read_b128 v[44:47], v6 offset:19408
    s_waitcnt lgkmcnt(4)
    v_mfma_f32_32x32x16_bf16 v[64:79], v[24:27], v[28:31], v[64:79]
    s_waitcnt lgkmcnt(2)
    v_mfma_f32_32x32x16_bf16 v[64:79], v[32:35], v[36:39], v[64:79]
    s_waitcnt lgkmcnt(0)
    v_mfma_f32_32x32x16_bf16 v[64:79], v[40:43], v[44:47], v[64:79]
    s_nop 3
    s_nop 3
    s_nop 3
    v_cvt_pk_bf16_f32 v96, v64, v65
    v_cvt_pk_bf16_f32 v97, v66, v67
    v_cvt_pk_bf16_f32 v98, v68, v69
    v_cvt_pk_bf16_f32 v99, v70, v71
    v_cvt_pk_bf16_f32 v100, v72, v73
    v_cvt_pk_bf16_f32 v101, v74, v75
    v_cvt_pk_bf16_f32 v102, v76, v77
    v_cvt_pk_bf16_f32 v103, v78, v79
    v_permlane32_swap_b32 v96, v98
    v_permlane32_swap_b32 v97, v99
    buffer_store_dwordx4 v[96:99], v3, s[8:11], s21 offen offset:0 sc1
    v_permlane32_swap_b32 v100, v102
    v_permlane32_swap_b32_e64 v101, v103
    buffer_store_dwordx4 v[100:103], v3, s[8:11], s21 offen offset:32 sc1
    s_waitcnt vmcnt(0)
    s_barrier
    s_cmp_lg_u32 s12, 0
    s_cbranch_scc1 ann_32
    v_mov_b32_e64 v1, 1
    buffer_store_dword v1, off, s[8:11], s55 sc1
ann_32:
    s_cmp_lt_u32 s54, 32
    s_cbranch_scc1 pw_done
    s_cmp_lt_u32 s54, 64
    s_cbranch_scc1 pw_rows
    s_and_b32 s52, s54, 63
    s_lshl_b32 s52, s52, 3
    s_add_u32 s53, s52, s12
    s_lshl_b32 s49, s53, 1
    s_lshl_b32 s53, s53, 12
    buffer_load_dwordx4 v[112:115], v9, s[32:35], s53 offen
    buffer_load_dwordx4 v[116:119], v10, s[32:35], s53 offen offset:0
    buffer_load_dwordx4 v[120:123], v10, s[32:35], s53 offen offset:1008
    buffer_load_dwordx4 v[124:127], v10, s[32:35], s53 offen offset:1024
    buffer_load_dwordx4 v[128:131], v10, s[32:35], s53 offen offset:2032
    buffer_load_dwordx4 v[132:135], v10, s[32:35], s53 offen offset:2048
    buffer_load_dwordx4 v[136:139], v10, s[32:35], s53 offen offset:3056
    buffer_load_dwordx4 v[140:143], v10, s[32:35], s53 offen offset:3072
    buffer_load_ushort v108, off, s[36:39], s49
    v_mul_u32_u24 v8, 8192, v0
    s_lshl_b32 s51, s52, 1
    v_add_u32 v8, s51, v8
    s_lshl_b32 s50, s52, 3
    s_movk_i32 s51, 4096
    s_mov_b64 exec, 1
    v_subrev_u32 v7, 3072, v8
    buffer_load_dwordx4 v[144:147], v7, s[24:27], 0 offen
    v_subrev_u32 v7, 2048, v8
    buffer_load_dwordx4 v[148:151], v7, s[24:27], 0 offen
    v_subrev_u32 v7, 1024, v8
    buffer_load_dwordx4 v[152:155], v7, s[24:27], 0 offen
    s_mov_b64 exec, -1
    buffer_load_dwordx4 v[156:159], v8, s[24:27], 0 offen offset:0
    buffer_load_dwordx4 v[188:191], v8, s[28:31], 0 offen offset:0
    buffer_load_dwordx4 v[160:163], v8, s[24:27], 0 offen offset:1024
    buffer_load_dwordx4 v[192:195], v8, s[28:31], 0 offen offset:1024
    buffer_load_dwordx4 v[164:167], v8, s[24:27], 0 offen offset:2048
    buffer_load_dwordx4 v[196:199], v8, s[28:31], 0 offen offset:2048
    buffer_load_dwordx4 v[168:171], v8, s[24:27], 0 offen offset:3072
    buffer_load_dwordx4 v[200:203], v8, s[28:31], 0 offen offset:3072
    buffer_load_dwordx4 v[172:175], v8, s[24:27], s51 offen offset:0
    buffer_load_dwordx4 v[204:207], v8, s[28:31], s51 offen offset:0
    buffer_load_dwordx4 v[176:179], v8, s[24:27], s51 offen offset:1024
    buffer_load_dwordx4 v[208:211], v8, s[28:31], s51 offen offset:1024
    buffer_load_dwordx4 v[180:183], v8, s[24:27], s51 offen offset:2048
    buffer_load_dwordx4 v[212:215], v8, s[28:31], s51 offen offset:2048
    buffer_load_dwordx4 v[184:187], v8, s[24:27], s51 offen offset:3072
    buffer_load_dwordx4 v[216:219], v8, s[28:31], s51 offen offset:3072
    buffer_load_dwordx4 v[220:223], off, s[40:43], s50 offset:0
    buffer_load_dwordx4 v[224:227], off, s[40:43], s50 offset:16
    buffer_load_dwordx4 v[228:231], off, s[40:43], s50 offset:32
    buffer_load_dwordx4 v[232:235], off, s[40:43], s50 offset:48
    s_mul_i32 s48, s12, 40960
    v_mov_b32 v40, 0
    v_mov_b32 v41, 0
    v_mov_b32 v42, 0
    v_mov_b32 v43, 0
    v_add_u32_e64 v14, s48, v10
    ds_write_b128 v14, v[40:43] offset:38400
    ds_write_b128 v14, v[40:43] offset:39424
    ds_write_b128 v14, v[40:43] offset:39856
    v_and_b32 v12, 7, v15
    v_mul_u32_u24 v12, 4160, v12
    v_add_u32 v12, s48, v12
    ds_write_b128 v12, v[40:43]
    ds_write_b128 v12, v[40:43] offset:16
    ds_write_b128 v12, v[40:43] offset:32
    v_sub_u32 v11, 255, v0
    v_lshrrev_b32 v13, 2, v11
    v_mul_u32_u24 v13, 80, v13
    v_and_b32 v11, 3, v11
    v_lshl_add_u32 v13, v11, 4, v13
    v_add_u32 v13, 33280, v13
    v_add_u32 v11, 81920, v13
    v_and_b32 v3, 31, v15
    v_lshrrev_b32 v4, 5, v15
    v_lshrrev_b32 v6, 3, v3
    v_add_u32 v6, v6, v4
    v_lshl_add_u32 v5, v6, 4, v12
    v_sub_u32 v6, 31, v3
    v_mul_u32_u24 v6, 80, v6
    v_lshl_add_u32 v6, v4, 4, v6
    v_add_u32 v6, s48, v6
    v_lshlrev_b32_e64 v3, 6, v3
    v_lshl_add_u32 v3, v4, 4, v3
pw_b:
    s_waitcnt vmcnt(2)
    v_lshlrev_b32 v8, 16, v108
    v_lshlrev_b32 v7, 16, v116
    v_add_f32 v7, v7, v8
    v_cvt_pk_bf16_f32 v7, v7, v7
    v_mov_b32 v8, 0xffff
    v_bfi_b32 v7, v8, v7, v116
    v_cmp_eq_u32 vcc, 0, v15
    s_nop 0
    s_nop 0
    v_cndmask_b32 v116, v116, v7, vcc
    v_alignbit_b32 v48, v113, v112, 16
    v_alignbit_b32 v49, v114, v113, 16
    v_alignbit_b32 v50, v115, v114, 16
    v_alignbit_b32 v51, v116, v115, 16
    ds_write_b128 v14, v[48:51] offset:48
    v_mov_b32 v52, v113
    v_mov_b32 v53, v114
    v_mov_b32 v54, v115
    v_mov_b32 v55, v116
    ds_write_b128 v14, v[52:55] offset:4208
    v_alignbit_b32 v48, v114, v113, 16
    v_alignbit_b32 v49, v115, v114, 16
    v_alignbit_b32 v50, v116, v115, 16
    v_alignbit_b32 v51, v117, v116, 16
    ds_write_b128 v14, v[48:51] offset:8368
    ds_write_b128 v14, v[114:117] offset:12528
    v_alignbit_b32 v48, v115, v114, 16
    v_alignbit_b32 v49, v116, v115, 16
    v_alignbit_b32 v50, v117, v116, 16
    v_alignbit_b32 v51, v118, v117, 16
    ds_write_b128 v14, v[48:51] offset:16688
    v_mov_b32 v52, v115
    v_mov_b32 v53, v116
    v_mov_b32 v54, v117
    v_mov_b32 v55, v118
    ds_write_b128 v14, v[52:55] offset:20848
    v_alignbit_b32 v48, v116, v115, 16
    v_alignbit_b32 v49, v117, v116, 16
    v_alignbit_b32 v50, v118, v117, 16
    v_alignbit_b32 v51, v119, v118, 16
    ds_write_b128 v14, v[48:51] offset:25008
    ds_write_b128 v14, v[116:119] offset:29168
    v_alignbit_b32 v48, v121, v120, 16
    v_alignbit_b32 v49, v122, v121, 16
    v_alignbit_b32 v50, v123, v122, 16
    v_alignbit_b32 v51, v124, v123, 16
    ds_write_b128 v14, v[48:51] offset:1072
    v_mov_b32 v52, v121
    v_mov_b32 v53, v122
    v_mov_b32 v54, v123
    v_mov_b32 v55, v124
    ds_write_b128 v14, v[52:55] offset:5232
    v_alignbit_b32 v48, v122, v121, 16
    v_alignbit_b32 v49, v123, v122, 16
    v_alignbit_b32 v50, v124, v123, 16
    v_alignbit_b32 v51, v125, v124, 16
    ds_write_b128 v14, v[48:51] offset:9392
    ds_write_b128 v14, v[122:125] offset:13552
    v_alignbit_b32 v48, v123, v122, 16
    v_alignbit_b32 v49, v124, v123, 16
    v_alignbit_b32 v50, v125, v124, 16
    v_alignbit_b32 v51, v126, v125, 16
    ds_write_b128 v14, v[48:51] offset:17712
    v_mov_b32 v52, v123
    v_mov_b32 v53, v124
    v_mov_b32 v54, v125
    v_mov_b32 v55, v126
    ds_write_b128 v14, v[52:55] offset:21872
    v_alignbit_b32 v48, v124, v123, 16
    v_alignbit_b32 v49, v125, v124, 16
    v_alignbit_b32 v50, v126, v125, 16
    v_alignbit_b32 v51, v127, v126, 16
    ds_write_b128 v14, v[48:51] offset:26032
    ds_write_b128 v14, v[124:127] offset:30192
    v_alignbit_b32 v48, v129, v128, 16
    v_alignbit_b32 v49, v130, v129, 16
    v_alignbit_b32 v50, v131, v130, 16
    v_alignbit_b32 v51, v132, v131, 16
    ds_write_b128 v14, v[48:51] offset:2096
    v_mov_b32 v52, v129
    v_mov_b32 v53, v130
    v_mov_b32 v54, v131
    v_mov_b32 v55, v132
    ds_write_b128 v14, v[52:55] offset:6256
    v_alignbit_b32 v48, v130, v129, 16
    v_alignbit_b32 v49, v131, v130, 16
    v_alignbit_b32 v50, v132, v131, 16
    v_alignbit_b32 v51, v133, v132, 16
    ds_write_b128 v14, v[48:51] offset:10416
    ds_write_b128 v14, v[130:133] offset:14576
    v_alignbit_b32 v48, v131, v130, 16
    v_alignbit_b32 v49, v132, v131, 16
    v_alignbit_b32 v50, v133, v132, 16
    v_alignbit_b32 v51, v134, v133, 16
    ds_write_b128 v14, v[48:51] offset:18736
    v_mov_b32 v52, v131
    v_mov_b32 v53, v132
    v_mov_b32 v54, v133
    v_mov_b32 v55, v134
    ds_write_b128 v14, v[52:55] offset:22896
    v_alignbit_b32 v48, v132, v131, 16
    v_alignbit_b32 v49, v133, v132, 16
    v_alignbit_b32 v50, v134, v133, 16
    v_alignbit_b32 v51, v135, v134, 16
    ds_write_b128 v14, v[48:51] offset:27056
    ds_write_b128 v14, v[132:135] offset:31216
    v_alignbit_b32 v48, v137, v136, 16
    v_alignbit_b32 v49, v138, v137, 16
    v_alignbit_b32 v50, v139, v138, 16
    v_alignbit_b32 v51, v140, v139, 16
    ds_write_b128 v14, v[48:51] offset:3120
    v_mov_b32 v52, v137
    v_mov_b32 v53, v138
    v_mov_b32 v54, v139
    v_mov_b32 v55, v140
    ds_write_b128 v14, v[52:55] offset:7280
    v_alignbit_b32 v48, v138, v137, 16
    v_alignbit_b32 v49, v139, v138, 16
    v_alignbit_b32 v50, v140, v139, 16
    v_alignbit_b32 v51, v141, v140, 16
    ds_write_b128 v14, v[48:51] offset:11440
    ds_write_b128 v14, v[138:141] offset:15600
    v_alignbit_b32 v48, v139, v138, 16
    v_alignbit_b32 v49, v140, v139, 16
    v_alignbit_b32 v50, v141, v140, 16
    v_alignbit_b32 v51, v142, v141, 16
    ds_write_b128 v14, v[48:51] offset:19760
    v_mov_b32 v52, v139
    v_mov_b32 v53, v140
    v_mov_b32 v54, v141
    v_mov_b32 v55, v142
    ds_write_b128 v14, v[52:55] offset:23920
    v_alignbit_b32 v48, v140, v139, 16
    v_alignbit_b32 v49, v141, v140, 16
    v_alignbit_b32 v50, v142, v141, 16
    v_alignbit_b32 v51, v143, v142, 16
    ds_write_b128 v14, v[48:51] offset:28080
    ds_write_b128 v14, v[140:143] offset:32240
    s_waitcnt vmcnt(9)
    v_mov_b32_dpp v144, v176 wave_shr:1 row_mask:0xf bank_mask:0xf
    v_mov_b32_dpp v145, v177 wave_shr:1 row_mask:0xf bank_mask:0xf
    s_waitcnt vmcnt(7)
    v_mov_b32_dpp v148, v180 wave_shr:1 row_mask:0xf bank_mask:0xf
    v_mov_b32_dpp v149, v181 wave_shr:1 row_mask:0xf bank_mask:0xf
    s_waitcnt vmcnt(5)
    v_mov_b32_dpp v152, v184 wave_shr:1 row_mask:0xf bank_mask:0xf
    v_mov_b32_dpp v153, v185 wave_shr:1 row_mask:0xf bank_mask:0xf
    s_waitcnt vmcnt(3)
    v_lshlrev_b32 v16, 16, v220
    v_and_b32 v17, 0xffff0000, v220
    v_lshlrev_b32 v18, 16, v221
    v_and_b32 v19, 0xffff0000, v221
    v_lshlrev_b32 v20, 16, v144
    v_lshlrev_b32 v21, 16, v148
    v_lshlrev_b32 v22, 16, v152
    v_lshlrev_b32 v23, 16, v156
    v_lshlrev_b32 v24, 16, v160
    v_lshlrev_b32 v25, 16, v164
    v_lshlrev_b32 v26, 16, v168
    v_lshlrev_b32 v27, 16, v172
    v_lshlrev_b32 v28, 16, v176
    v_lshlrev_b32 v29, 16, v180
    v_lshlrev_b32 v30, 16, v184
    v_mul_f32 v32, v23, v16
    v_mul_f32 v33, v24, v16
    v_mul_f32 v34, v25, v16
    v_mul_f32 v35, v26, v16
    v_mul_f32 v36, v27, v16
    v_mul_f32 v37, v28, v16
    v_mul_f32 v38, v29, v16
    v_mul_f32 v39, v30, v16
    v_fmac_f32 v32, v22, v17
    v_fmac_f32 v33, v23, v17
    v_fmac_f32 v34, v24, v17
    v_fmac_f32 v35, v25, v17
    v_fmac_f32 v36, v26, v17
    v_fmac_f32 v37, v27, v17
    v_fmac_f32 v38, v28, v17
    v_fmac_f32 v39, v29, v17
    v_fmac_f32 v32, v21, v18
    v_fmac_f32 v33, v22, v18
    v_fmac_f32 v34, v23, v18
    v_fmac_f32 v35, v24, v18
    v_fmac_f32 v36, v25, v18
    v_fmac_f32 v37, v26, v18
    v_fmac_f32 v38, v27, v18
    v_fmac_f32 v39, v28, v18
    v_fmac_f32 v32, v20, v19
    v_fmac_f32 v33, v21, v19
    v_fmac_f32 v34, v22, v19
    v_fmac_f32 v35, v23, v19
    v_fmac_f32 v36, v24, v19
    v_fmac_f32 v37, v25, v19
    v_fmac_f32 v38, v26, v19
    v_fmac_f32 v39, v27, v19
    v_lshlrev_b32 v20, 16, v188
    v_lshlrev_b32 v21, 16, v192
    v_lshlrev_b32 v22, 16, v196
    v_lshlrev_b32 v23, 16, v200
    v_lshlrev_b32 v24, 16, v204
    v_lshlrev_b32 v25, 16, v208
    v_lshlrev_b32 v26, 16, v212
    v_lshlrev_b32_e64 v27, 16, v216
    v_pk_mul_f32 v[32:33], v[32:33], v[20:21]
    v_pk_mul_f32 v[34:35], v[34:35], v[22:23]
    v_pk_mul_f32 v[36:37], v[36:37], v[24:25]
    v_pk_mul_f32 v[38:39], v[38:39], v[26:27]
    v_cvt_pk_bf16_f32 v40, v39, v38
    v_cvt_pk_bf16_f32 v41, v37, v36
    v_cvt_pk_bf16_f32 v42, v35, v34
    v_cvt_pk_bf16_f32 v43, v33, v32
    ds_write_b128 v13, v[40:43] offset:0
    v_lshlrev_b32 v16, 16, v222
    v_and_b32 v17, 0xffff0000, v222
    v_lshlrev_b32 v18, 16, v223
    v_and_b32 v19, 0xffff0000, v223
    v_and_b32 v20, 0xffff0000, v144
    v_and_b32 v21, 0xffff0000, v148
    v_and_b32 v22, 0xffff0000, v152
    v_and_b32 v23, 0xffff0000, v156
    v_and_b32 v24, 0xffff0000, v160
    v_and_b32 v25, 0xffff0000, v164
    v_and_b32 v26, 0xffff0000, v168
    v_and_b32 v27, 0xffff0000, v172
    v_and_b32 v28, 0xffff0000, v176
    v_and_b32 v29, 0xffff0000, v180
    v_and_b32 v30, 0xffff0000, v184
    v_mul_f32 v32, v23, v16
    v_mul_f32 v33, v24, v16
    v_mul_f32 v34, v25, v16
    v_mul_f32 v35, v26, v16
    v_mul_f32 v36, v27, v16
    v_mul_f32 v37, v28, v16
    v_mul_f32 v38, v29, v16
    v_mul_f32 v39, v30, v16
    v_fmac_f32 v32, v22, v17
    v_fmac_f32 v33, v23, v17
    v_fmac_f32 v34, v24, v17
    v_fmac_f32 v35, v25, v17
    v_fmac_f32 v36, v26, v17
    v_fmac_f32 v37, v27, v17
    v_fmac_f32 v38, v28, v17
    v_fmac_f32 v39, v29, v17
    v_fmac_f32 v32, v21, v18
    v_fmac_f32 v33, v22, v18
    v_fmac_f32 v34, v23, v18
    v_fmac_f32 v35, v24, v18
    v_fmac_f32 v36, v25, v18
    v_fmac_f32 v37, v26, v18
    v_fmac_f32 v38, v27, v18
    v_fmac_f32 v39, v28, v18
    v_fmac_f32 v32, v20, v19
    v_fmac_f32 v33, v21, v19
    v_fmac_f32 v34, v22, v19
    v_fmac_f32 v35, v23, v19
    v_fmac_f32 v36, v24, v19
    v_fmac_f32 v37, v25, v19
    v_fmac_f32 v38, v26, v19
    v_fmac_f32 v39, v27, v19
    v_and_b32 v20, 0xffff0000, v188
    v_and_b32 v21, 0xffff0000, v192
    v_and_b32 v22, 0xffff0000, v196
    v_and_b32 v23, 0xffff0000, v200
    v_and_b32 v24, 0xffff0000, v204
    v_and_b32 v25, 0xffff0000, v208
    v_and_b32 v26, 0xffff0000, v212
    v_and_b32 v27, 0xffff0000, v216
    v_pk_mul_f32 v[32:33], v[32:33], v[20:21]
    v_pk_mul_f32 v[34:35], v[34:35], v[22:23]
    v_pk_mul_f32 v[36:37], v[36:37], v[24:25]
    v_pk_mul_f32 v[38:39], v[38:39], v[26:27]
    v_cvt_pk_bf16_f32 v44, v39, v38
    v_cvt_pk_bf16_f32 v45, v37, v36
    v_cvt_pk_bf16_f32 v46, v35, v34
    v_cvt_pk_bf16_f32 v47, v33, v32
    ds_write_b128 v13, v[44:47] offset:40960
    s_waitcnt vmcnt(2)
    v_lshlrev_b32 v16, 16, v224
    v_and_b32 v17, 0xffff0000, v224
    v_lshlrev_b32_e64 v18, 16, v225
    v_and_b32 v19, 0xffff0000, v225
    v_lshlrev_b32 v20, 16, v145
    v_lshlrev_b32 v21, 16, v149
    v_lshlrev_b32 v22, 16, v153
    v_lshlrev_b32 v23, 16, v157
    v_lshlrev_b32 v24, 16, v161
    v_lshlrev_b32 v25, 16, v165
    v_lshlrev_b32 v26, 16, v169
    v_lshlrev_b32 v27, 16, v173
    v_lshlrev_b32 v28, 16, v177
    v_lshlrev_b32 v29, 16, v181
    v_lshlrev_b32 v30, 16, v185
    v_mul_f32 v32, v23, v16
    v_mul_f32 v33, v24, v16
    v_mul_f32 v34, v25, v16
    v_mul_f32 v35, v26, v16
    v_mul_f32 v36, v27, v16
    v_mul_f32 v37, v28, v16
    v_mul_f32 v38, v29, v16
    v_mul_f32 v39, v30, v16
    v_fmac_f32 v32, v22, v17
    v_fmac_f32 v33, v23, v17
    v_fmac_f32 v34, v24, v17
    v_fmac_f32 v35, v25, v17
    v_fmac_f32 v36, v26, v17
    v_fmac_f32 v37, v27, v17
    v_fmac_f32 v38, v28, v17
    v_fmac_f32 v39, v29, v17
    v_fmac_f32 v32, v21, v18
    v_fmac_f32 v33, v22, v18
    v_fmac_f32 v34, v23, v18
    v_fmac_f32 v35, v24, v18
    v_fmac_f32 v36, v25, v18
    v_fmac_f32 v37, v26, v18
    v_fmac_f32 v38, v27, v18
    v_fmac_f32 v39, v28, v18
    v_fmac_f32 v32, v20, v19
    v_fmac_f32 v33, v21, v19
    v_fmac_f32 v34, v22, v19
    v_fmac_f32 v35, v23, v19
    v_fmac_f32 v36, v24, v19
    v_fmac_f32 v37, v25, v19
    v_fmac_f32 v38, v26, v19
    v_fmac_f32 v39, v27, v19
    v_lshlrev_b32 v20, 16, v189
    v_lshlrev_b32 v21, 16, v193
    v_lshlrev_b32 v22, 16, v197
    v_lshlrev_b32 v23, 16, v201
    v_lshlrev_b32 v24, 16, v205
    v_lshlrev_b32 v25, 16, v209
    v_lshlrev_b32 v26, 16, v213
    v_lshlrev_b32_e64 v27, 16, v217
    v_pk_mul_f32 v[32:33], v[32:33], v[20:21]
    v_pk_mul_f32 v[34:35], v[34:35], v[22:23]
    v_pk_mul_f32 v[36:37], v[36:37], v[24:25]
    v_pk_mul_f32 v[38:39], v[38:39], v[26:27]
    v_cvt_pk_bf16_f32 v40, v39, v38
    v_cvt_pk_bf16_f32 v41, v37, v36
    v_cvt_pk_bf16_f32 v42, v35, v34
    v_cvt_pk_bf16_f32 v43, v33, v32
    ds_write_b128 v11, v[40:43] offset:0
    v_lshlrev_b32 v16, 16, v226
    v_and_b32 v17, 0xffff0000, v226
    v_lshlrev_b32 v18, 16, v227
    v_and_b32 v19, 0xffff0000, v227
    v_and_b32 v20, 0xffff0000, v145
    v_and_b32 v21, 0xffff0000, v149
    v_and_b32 v22, 0xffff0000, v153
    v_and_b32 v23, 0xffff0000, v157
    v_and_b32 v24, 0xffff0000, v161
    v_and_b32 v25, 0xffff0000, v165
    v_and_b32 v26, 0xffff0000, v169
    v_and_b32 v27, 0xffff0000, v173
    v_and_b32 v28, 0xffff0000, v177
    v_and_b32 v29, 0xffff0000, v181
    v_and_b32 v30, 0xffff0000, v185
    v_mul_f32 v32, v23, v16
    v_mul_f32 v33, v24, v16
    v_mul_f32 v34, v25, v16
    v_mul_f32 v35, v26, v16
    v_mul_f32 v36, v27, v16
    v_mul_f32 v37, v28, v16
    v_mul_f32 v38, v29, v16
    v_mul_f32 v39, v30, v16
    v_fmac_f32 v32, v22, v17
    v_fmac_f32 v33, v23, v17
    v_fmac_f32 v34, v24, v17
    v_fmac_f32 v35, v25, v17
    v_fmac_f32 v36, v26, v17
    v_fmac_f32 v37, v27, v17
    v_fmac_f32 v38, v28, v17
    v_fmac_f32 v39, v29, v17
    v_fmac_f32 v32, v21, v18
    v_fmac_f32 v33, v22, v18
    v_fmac_f32 v34, v23, v18
    v_fmac_f32 v35, v24, v18
    v_fmac_f32 v36, v25, v18
    v_fmac_f32 v37, v26, v18
    v_fmac_f32 v38, v27, v18
    v_fmac_f32 v39, v28, v18
    v_fmac_f32 v32, v20, v19
    v_fmac_f32 v33, v21, v19
    v_fmac_f32 v34, v22, v19
    v_fmac_f32 v35, v23, v19
    v_fmac_f32_e64 v36, v24, v19
    v_fmac_f32_e64 v37, v25, v19
    v_fmac_f32_e64 v38, v26, v19
    v_fmac_f32_e64 v39, v27, v19
    v_and_b32 v20, 0xffff0000, v189
    v_and_b32 v21, 0xffff0000, v193
    v_and_b32 v22, 0xffff0000, v197
    v_and_b32 v23, 0xffff0000, v201
    v_and_b32 v24, 0xffff0000, v205
    v_and_b32 v25, 0xffff0000, v209
    v_and_b32 v26, 0xffff0000, v213
    v_and_b32 v27, 0xffff0000, v217
    v_pk_mul_f32 v[32:33], v[32:33], v[20:21]
    v_pk_mul_f32 v[34:35], v[34:35], v[22:23]
    v_pk_mul_f32 v[36:37], v[36:37], v[24:25]
    v_pk_mul_f32 v[38:39], v[38:39], v[26:27]
    v_cvt_pk_bf16_f32 v44, v39, v38
    v_cvt_pk_bf16_f32 v45, v37, v36
    v_cvt_pk_bf16_f32 v46, v35, v34
    v_cvt_pk_bf16_f32 v47, v33, v32
    ds_write_b128 v11, v[44:47] offset:40960
    s_add_u32 s21, s53, 127928320
    s_waitcnt lgkmcnt(0)
    s_barrier
    s_xor_b32 s52, s52, 4
    s_bitcmp0_b32 s52, 2
    s_cbranch_scc1 pw_b2
    s_add_u32 s53, s52, s12
    s_lshl_b32 s49, s53, 1
    s_lshl_b32 s53, s53, 12
    buffer_load_dwordx4 v[112:115], v9, s[32:35], s53 offen
    buffer_load_dwordx4 v[116:119], v10, s[32:35], s53 offen offset:0
    buffer_load_dwordx4 v[120:123], v10, s[32:35], s53 offen offset:1008
    buffer_load_dwordx4 v[124:127], v10, s[32:35], s53 offen offset:1024
    buffer_load_dwordx4 v[128:131], v10, s[32:35], s53 offen offset:2032
    buffer_load_dwordx4 v[132:135], v10, s[32:35], s53 offen offset:2048
    buffer_load_dwordx4 v[136:139], v10, s[32:35], s53 offen offset:3056
    buffer_load_dwordx4 v[140:143], v10, s[32:35], s53 offen offset:3072
    buffer_load_ushort v108, off, s[36:39], s49
    v_mov_b32 v144, v146
    v_mov_b32 v145, v147
    v_mov_b32 v148, v150
    v_mov_b32 v149, v151
    v_mov_b32 v152, v154
    v_mov_b32 v153, v155
    v_mov_b32 v156, v158
    v_mov_b32 v157, v159
    v_mov_b32 v160, v162
    v_mov_b32 v161, v163
    v_mov_b32 v164, v166
    v_mov_b32 v165, v167
    v_mov_b32 v168, v170
    v_mov_b32 v169, v171
    v_mov_b32 v172, v174
    v_mov_b32 v173, v175
    v_mov_b32 v176, v178
    v_mov_b32 v177, v179
    v_mov_b32 v180, v182
    v_mov_b32 v181, v183
    v_mov_b32 v184, v186
    v_mov_b32 v185, v187
    v_mov_b32 v188, v190
    v_mov_b32 v189, v191
    v_mov_b32 v192, v194
    v_mov_b32 v193, v195
    v_mov_b32 v196, v198
    v_mov_b32 v197, v199
    v_mov_b32 v200, v202
    v_mov_b32 v201, v203
    v_mov_b32 v204, v206
    v_mov_b32 v205, v207
    v_mov_b32 v208, v210
    v_mov_b32 v209, v211
    v_mov_b32 v212, v214
    v_mov_b32 v213, v215
    v_mov_b32 v216, v218
    v_mov_b32 v217, v219
    s_waitcnt vmcnt(10)
    v_mov_b32 v220, v228
    v_mov_b32 v221, v229
    v_mov_b32 v222, v230
    v_mov_b32 v223, v231
    s_waitcnt vmcnt(9)
    v_mov_b32 v224, v232
    v_mov_b32 v225, v233
    v_mov_b32 v226, v234
    v_mov_b32 v227, v235
pw_b2:
    ds_read_b128 v[16:19], v5 offset:0
    ds_read_b128 v[20:23], v6 offset:33280
    ds_read_b128 v[24:27], v5 offset:32
    ds_read_b128 v[28:31], v6 offset:33312
    ds_read_b128 v[32:35], v5 offset:64
    ds_read_b128 v[36:39], v6 offset:33360
    s_waitcnt lgkmcnt(4)
    v_mfma_f32_32x32x16_bf16 v[64:79], v[16:19], v[20:23], 0
    ds_read_b128 v[40:43], v5 offset:96
    ds_read_b128 v[44:47], v6 offset:33392
    s_waitcnt lgkmcnt(4)
    v_mfma_f32_32x32x16_bf16 v[64:79], v[24:27], v[28:31], v[64:79]
    ds_read_b128 v[16:19], v5 offset:128
    ds_read_b128 v[20:23], v6 offset:33440
    s_waitcnt lgkmcnt(4)
    v_mfma_f32_32x32x16_bf16 v[64:79], v[32:35], v[36:39], v[64:79]
    ds_read_b128 v[24:27], v5 offset:160
    ds_read_b128 v[28:31], v6 offset:33472
    s_waitcnt lgkmcnt(4)
    v_mfma_f32_32x32x16_bf16 v[64:79], v[40:43], v[44:47], v[64:79]
    ds_read_b128 v[32:35], v5 offset:192
    ds_read_b128 v[36:39], v6 offset:33520
    s_waitcnt lgkmcnt(4)
    v_mfma_f32_32x32x16_bf16 v[64:79], v[16:19], v[20:23], v[64:79]
    ds_read_b128 v[40:43], v5 offset:224
    ds_read_b128 v[44:47], v6 offset:33552
    s_waitcnt lgkmcnt(4)
    v_mfma_f32_32x32x16_bf16 v[64:79], v[24:27], v[28:31], v[64:79]
    ds_read_b128 v[16:19], v5 offset:256
    ds_read_b128 v[20:23], v6 offset:33600
    s_waitcnt lgkmcnt(4)
    v_mfma_f32_32x32x16_bf16 v[64:79], v[32:35], v[36:39], v[64:79]
    ds_read_b128 v[24:27], v5 offset:288
    ds_read_b128 v[28:31], v6 offset:33632
    s_waitcnt lgkmcnt(4)
    v_mfma_f32_32x32x16_bf16 v[64:79], v[40:43], v[44:47], v[64:79]
    ds_read_b128 v[32:35], v5 offset:320
    ds_read_b128 v[36:39], v6 offset:33680
    s_waitcnt lgkmcnt(4)
    v_mfma_f32_32x32x16_bf16 v[64:79], v[16:19], v[20:23], v[64:79]
    ds_read_b128 v[40:43], v5 offset:352
    ds_read_b128 v[44:47], v6 offset:33712
    s_waitcnt lgkmcnt(4)
    v_mfma_f32_32x32x16_bf16 v[64:79], v[24:27], v[28:31], v[64:79]
    ds_read_b128 v[16:19], v5 offset:384
    ds_read_b128 v[20:23], v6 offset:33760
    s_waitcnt lgkmcnt(4)
    v_mfma_f32_32x32x16_bf16 v[64:79], v[32:35], v[36:39], v[64:79]
    ds_read_b128 v[24:27], v5 offset:416
    ds_read_b128 v[28:31], v6 offset:33792
    s_waitcnt lgkmcnt(4)
    v_mfma_f32_32x32x16_bf16 v[64:79], v[40:43], v[44:47], v[64:79]
    ds_read_b128 v[32:35], v5 offset:448
    ds_read_b128 v[36:39], v6 offset:33840
    s_waitcnt lgkmcnt(4)
    v_mfma_f32_32x32x16_bf16 v[64:79], v[16:19], v[20:23], v[64:79]
    ds_read_b128 v[40:43], v5 offset:480
    ds_read_b128 v[44:47], v6 offset:33872
    s_waitcnt lgkmcnt(4)
    v_mfma_f32_32x32x16_bf16 v[64:79], v[24:27], v[28:31], v[64:79]
    ds_read_b128 v[16:19], v5 offset:512
    ds_read_b128 v[20:23], v6 offset:33920
    s_waitcnt lgkmcnt(4)
    v_mfma_f32_32x32x16_bf16 v[64:79], v[32:35], v[36:39], v[64:79]
    ds_read_b128 v[24:27], v5 offset:544
    ds_read_b128 v[28:31], v6 offset:33952
    s_waitcnt lgkmcnt(4)
    v_mfma_f32_32x32x16_bf16 v[64:79], v[40:43], v[44:47], v[64:79]
    ds_read_b128 v[32:35], v5 offset:576
    ds_read_b128 v[36:39], v6 offset:34000
    s_waitcnt lgkmcnt(4)
    v_mfma_f32_32x32x16_bf16 v[64:79], v[16:19], v[20:23], v[64:79]
    ds_read_b128 v[40:43], v5 offset:608
    ds_read_b128 v[44:47], v6 offset:34032
    s_waitcnt lgkmcnt(4)
    v_mfma_f32_32x32x16_bf16 v[64:79], v[24:27], v[28:31], v[64:79]
    ds_read_b128 v[16:19], v5 offset:640
    ds_read_b128 v[20:23], v6 offset:34080
    s_waitcnt lgkmcnt(4)
    v_mfma_f32_32x32x16_bf16 v[64:79], v[32:35], v[36:39], v[64:79]
    ds_read_b128 v[24:27], v5 offset:672
    ds_read_b128 v[28:31], v6 offset:34112
    s_waitcnt lgkmcnt(4)
    v_mfma_f32_32x32x16_bf16 v[64:79], v[40:43], v[44:47], v[64:79]
    ds_read_b128 v[32:35], v5 offset:704
    ds_read_b128 v[36:39], v6 offset:34160
    s_waitcnt lgkmcnt(4)
    v_mfma_f32_32x32x16_bf16 v[64:79], v[16:19], v[20:23], v[64:79]
    ds_read_b128 v[40:43], v5 offset:736
    ds_read_b128 v[44:47], v6 offset:34192
    s_waitcnt lgkmcnt(4)
    v_mfma_f32_32x32x16_bf16 v[64:79], v[24:27], v[28:31], v[64:79]
    ds_read_b128 v[16:19], v5 offset:768
    ds_read_b128 v[20:23], v6 offset:34240
    s_waitcnt lgkmcnt(4)
    v_mfma_f32_32x32x16_bf16 v[64:79], v[32:35], v[36:39], v[64:79]
    ds_read_b128 v[24:27], v5 offset:800
    ds_read_b128 v[28:31], v6 offset:34272
    s_waitcnt lgkmcnt(4)
    v_mfma_f32_32x32x16_bf16 v[64:79], v[40:43], v[44:47], v[64:79]
    ds_read_b128 v[32:35], v5 offset:832
    ds_read_b128 v[36:39], v6 offset:34320
    s_waitcnt lgkmcnt(4)
    v_mfma_f32_32x32x16_bf16 v[64:79], v[16:19], v[20:23], v[64:79]
    ds_read_b128 v[40:43], v5 offset:864
    ds_read_b128 v[44:47], v6 offset:34352
    s_waitcnt lgkmcnt(4)
    v_mfma_f32_32x32x16_bf16 v[64:79], v[24:27], v[28:31], v[64:79]
    ds_read_b128 v[16:19], v5 offset:896
    ds_read_b128 v[20:23], v6 offset:34400
    s_waitcnt lgkmcnt(4)
    v_mfma_f32_32x32x16_bf16 v[64:79], v[32:35], v[36:39], v[64:79]
    ds_read_b128 v[24:27], v5 offset:928
    ds_read_b128 v[28:31], v6 offset:34432
    s_waitcnt lgkmcnt(4)
    v_mfma_f32_32x32x16_bf16 v[64:79], v[40:43], v[44:47], v[64:79]
    ds_read_b128 v[32:35], v5 offset:960
    ds_read_b128 v[36:39], v6 offset:34480
    s_waitcnt lgkmcnt(4)
    v_mfma_f32_32x32x16_bf16 v[64:79], v[16:19], v[20:23], v[64:79]
    ds_read_b128 v[40:43], v5 offset:992
    ds_read_b128 v[44:47], v6 offset:34512
    s_waitcnt lgkmcnt(4)
    v_mfma_f32_32x32x16_bf16 v[64:79], v[24:27], v[28:31], v[64:79]
    ds_read_b128 v[16:19], v5 offset:1024
    ds_read_b128 v[20:23], v6 offset:34560
    s_waitcnt lgkmcnt(4)
    v_mfma_f32_32x32x16_bf16 v[64:79], v[32:35], v[36:39], v[64:79]
    ds_read_b128 v[24:27], v5 offset:1056
    ds_read_b128 v[28:31], v6 offset:34592
    s_waitcnt lgkmcnt(4)
    v_mfma_f32_32x32x16_bf16 v[64:79], v[40:43], v[44:47], v[64:79]
    ds_read_b128 v[32:35], v5 offset:1088
    ds_read_b128 v[36:39], v6 offset:34640
    s_waitcnt lgkmcnt(4)
    v_mfma_f32_32x32x16_bf16 v[64:79], v[16:19], v[20:23], v[64:79]
    ds_read_b128 v[40:43], v5 offset:1120
    ds_read_b128 v[44:47], v6 offset:34672
    s_waitcnt lgkmcnt(4)
    v_mfma_f32_32x32x16_bf16 v[64:79], v[24:27], v[28:31], v[64:79]
    ds_read_b128 v[16:19], v5 offset:1152
    ds_read_b128 v[20:23], v6 offset:34720
    s_waitcnt lgkmcnt(4)
    v_mfma_f32_32x32x16_bf16 v[64:79], v[32:35], v[36:39], v[64:79]
    ds_read_b128 v[24:27], v5 offset:1184
    ds_read_b128 v[28:31], v6 offset:34752
    s_waitcnt lgkmcnt(4)
    v_mfma_f32_32x32x16_bf16 v[64:79], v[40:43], v[44:47], v[64:79]
    ds_read_b128 v[32:35], v5 offset:1216
    ds_read_b128 v[36:39], v6 offset:34800
    s_waitcnt lgkmcnt(4)
    v_mfma_f32_32x32x16_bf16 v[64:79], v[16:19], v[20:23], v[64:79]
    ds_read_b128 v[40:43], v5 offset:1248
    ds_read_b128 v[44:47], v6 offset:34832
    s_waitcnt lgkmcnt(4)
    v_mfma_f32_32x32x16_bf16 v[64:79], v[24:27], v[28:31], v[64:79]
    ds_read_b128 v[16:19], v5 offset:1280
    ds_read_b128 v[20:23], v6 offset:34880
    s_waitcnt lgkmcnt(4)
    v_mfma_f32_32x32x16_bf16 v[64:79], v[32:35], v[36:39], v[64:79]
    ds_read_b128 v[24:27], v5 offset:1312
    ds_read_b128 v[28:31], v6 offset:34912
    s_waitcnt lgkmcnt(4)
    v_mfma_f32_32x32x16_bf16 v[64:79], v[40:43], v[44:47], v[64:79]
    ds_read_b128 v[32:35], v5 offset:1344
    ds_read_b128 v[36:39], v6 offset:34960
    s_waitcnt lgkmcnt(4)
    v_mfma_f32_32x32x16_bf16 v[64:79], v[16:19], v[20:23], v[64:79]
    ds_read_b128 v[40:43], v5 offset:1376
    ds_read_b128 v[44:47], v6 offset:34992
    s_waitcnt lgkmcnt(4)
    v_mfma_f32_32x32x16_bf16 v[64:79], v[24:27], v[28:31], v[64:79]
    ds_read_b128 v[16:19], v5 offset:1408
    ds_read_b128 v[20:23], v6 offset:35040
    s_waitcnt lgkmcnt(4)
    v_mfma_f32_32x32x16_bf16 v[64:79], v[32:35], v[36:39], v[64:79]
    ds_read_b128 v[24:27], v5 offset:1440
    ds_read_b128 v[28:31], v6 offset:35072
    s_waitcnt lgkmcnt(4)
    v_mfma_f32_32x32x16_bf16 v[64:79], v[40:43], v[44:47], v[64:79]
    ds_read_b128 v[32:35], v5 offset:1472
    ds_read_b128 v[36:39], v6 offset:35120
    s_waitcnt lgkmcnt(4)
    v_mfma_f32_32x32x16_bf16 v[64:79], v[16:19], v[20:23], v[64:79]
    ds_read_b128 v[40:43], v5 offset:1504
    ds_read_b128 v[44:47], v6 offset:35152
    s_waitcnt lgkmcnt(4)
    v_mfma_f32_32x32x16_bf16 v[64:79], v[24:27], v[28:31], v[64:79]
    ds_read_b128 v[16:19], v5 offset:1536
    ds_read_b128 v[20:23], v6 offset:35200
    s_waitcnt lgkmcnt(4)
    v_mfma_f32_32x32x16_bf16 v[64:79], v[32:35], v[36:39], v[64:79]
    ds_read_b128 v[24:27], v5 offset:1568
    ds_read_b128 v[28:31], v6 offset:35232
    s_waitcnt lgkmcnt(4)
    v_mfma_f32_32x32x16_bf16 v[64:79], v[40:43], v[44:47], v[64:79]
    ds_read_b128 v[32:35], v5 offset:1600
    ds_read_b128 v[36:39], v6 offset:35280
    s_waitcnt lgkmcnt(4)
    v_mfma_f32_32x32x16_bf16 v[64:79], v[16:19], v[20:23], v[64:79]
    ds_read_b128 v[40:43], v5 offset:1632
    ds_read_b128 v[44:47], v6 offset:35312
    s_waitcnt lgkmcnt(4)
    v_mfma_f32_32x32x16_bf16 v[64:79], v[24:27], v[28:31], v[64:79]
    ds_read_b128 v[16:19], v5 offset:1664
    ds_read_b128 v[20:23], v6 offset:35360
    s_waitcnt lgkmcnt(4)
    v_mfma_f32_32x32x16_bf16 v[64:79], v[32:35], v[36:39], v[64:79]
    ds_read_b128 v[24:27], v5 offset:1696
    ds_read_b128 v[28:31], v6 offset:35392
    s_waitcnt lgkmcnt(4)
    v_mfma_f32_32x32x16_bf16 v[64:79], v[40:43], v[44:47], v[64:79]
    ds_read_b128 v[32:35], v5 offset:1728
    ds_read_b128 v[36:39], v6 offset:35440
    s_waitcnt lgkmcnt(4)
    v_mfma_f32_32x32x16_bf16 v[64:79], v[16:19], v[20:23], v[64:79]
    ds_read_b128 v[40:43], v5 offset:1760
    ds_read_b128 v[44:47], v6 offset:35472
    s_waitcnt lgkmcnt(4)
    v_mfma_f32_32x32x16_bf16 v[64:79], v[24:27], v[28:31], v[64:79]
    ds_read_b128 v[16:19], v5 offset:1792
    ds_read_b128 v[20:23], v6 offset:35520
    s_waitcnt lgkmcnt(4)
    v_mfma_f32_32x32x16_bf16 v[64:79], v[32:35], v[36:39], v[64:79]
    ds_read_b128 v[24:27], v5 offset:1824
    ds_read_b128 v[28:31], v6 offset:35552
    s_waitcnt lgkmcnt(4)
    v_mfma_f32_32x32x16_bf16 v[64:79], v[40:43], v[44:47], v[64:79]
    ds_read_b128 v[32:35], v5 offset:1856
    ds_read_b128 v[36:39], v6 offset:35600
    s_waitcnt lgkmcnt(4)
    v_mfma_f32_32x32x16_bf16 v[64:79], v[16:19], v[20:23], v[64:79]
    ds_read_b128 v[40:43], v5 offset:1888
    ds_read_b128 v[44:47], v6 offset:35632
    s_waitcnt lgkmcnt(4)
    v_mfma_f32_32x32x16_bf16 v[64:79], v[24:27], v[28:31], v[64:79]
    ds_read_b128 v[16:19], v5 offset:1920
    ds_read_b128 v[20:23], v6 offset:35680
    s_waitcnt lgkmcnt(4)
    v_mfma_f32_32x32x16_bf16 v[64:79], v[32:35], v[36:39], v[64:79]
    ds_read_b128 v[24:27], v5 offset:1952
    ds_read_b128 v[28:31], v6 offset:35712
    s_waitcnt lgkmcnt(4)
    v_mfma_f32_32x32x16_bf16 v[64:79], v[40:43], v[44:47], v[64:79]
    ds_read_b128 v[32:35], v5 offset:1984
    ds_read_b128 v[36:39], v6 offset:35760
    s_waitcnt lgkmcnt(4)
    v_mfma_f32_32x32x16_bf16 v[64:79], v[16:19], v[20:23], v[64:79]
    ds_read_b128 v[40:43], v5 offset:2016
    ds_read_b128 v[44:47], v6 offset:35792
    s_waitcnt lgkmcnt(4)
    v_mfma_f32_32x32x16_bf16 v[64:79], v[24:27], v[28:31], v[64:79]
    ds_read_b128 v[16:19], v5 offset:2048
    ds_read_b128 v[20:23], v6 offset:35840
    s_waitcnt lgkmcnt(4)
    v_mfma_f32_32x32x16_bf16 v[64:79], v[32:35], v[36:39], v[64:79]
    ds_read_b128 v[24:27], v5 offset:2080
    ds_read_b128 v[28:31], v6 offset:35872
    s_waitcnt lgkmcnt(4)
    v_mfma_f32_32x32x16_bf16 v[64:79], v[40:43], v[44:47], v[64:79]
    ds_read_b128 v[32:35], v5 offset:2112
    ds_read_b128 v[36:39], v6 offset:35920
    s_waitcnt lgkmcnt(4)
    v_mfma_f32_32x32x16_bf16 v[64:79], v[16:19], v[20:23], v[64:79]
    ds_read_b128 v[40:43], v5 offset:2144
    ds_read_b128 v[44:47], v6 offset:35952
    s_waitcnt lgkmcnt(4)
    v_mfma_f32_32x32x16_bf16 v[64:79], v[24:27], v[28:31], v[64:79]
    ds_read_b128 v[16:19], v5 offset:2176
    ds_read_b128 v[20:23], v6 offset:36000
    s_waitcnt lgkmcnt(4)
    v_mfma_f32_32x32x16_bf16 v[64:79], v[32:35], v[36:39], v[64:79]
    ds_read_b128 v[24:27], v5 offset:2208
    ds_read_b128 v[28:31], v6 offset:36032
    s_waitcnt lgkmcnt(4)
    v_mfma_f32_32x32x16_bf16 v[64:79], v[40:43], v[44:47], v[64:79]
    ds_read_b128 v[32:35], v5 offset:2240
    ds_read_b128 v[36:39], v6 offset:36080
    s_waitcnt lgkmcnt(4)
    v_mfma_f32_32x32x16_bf16 v[64:79], v[16:19], v[20:23], v[64:79]
    ds_read_b128 v[40:43], v5 offset:2272
    ds_read_b128 v[44:47], v6 offset:36112
    s_waitcnt lgkmcnt(4)
    v_mfma_f32_32x32x16_bf16 v[64:79], v[24:27], v[28:31], v[64:79]
    ds_read_b128 v[16:19], v5 offset:2304
    ds_read_b128 v[20:23], v6 offset:36160
    s_waitcnt lgkmcnt(4)
    v_mfma_f32_32x32x16_bf16 v[64:79], v[32:35], v[36:39], v[64:79]
    ds_read_b128 v[24:27], v5 offset:2336
    ds_read_b128 v[28:31], v6 offset:36192
    s_waitcnt lgkmcnt(4)
    v_mfma_f32_32x32x16_bf16 v[64:79], v[40:43], v[44:47], v[64:79]
    ds_read_b128 v[32:35], v5 offset:2368
    ds_read_b128 v[36:39], v6 offset:36240
    s_waitcnt lgkmcnt(4)
    v_mfma_f32_32x32x16_bf16 v[64:79], v[16:19], v[20:23], v[64:79]
    ds_read_b128 v[40:43], v5 offset:2400
    ds_read_b128 v[44:47], v6 offset:36272
    s_waitcnt lgkmcnt(4)
    v_mfma_f32_32x32x16_bf16 v[64:79], v[24:27], v[28:31], v[64:79]
    ds_read_b128 v[16:19], v5 offset:2432
    ds_read_b128 v[20:23], v6 offset:36320
    s_waitcnt lgkmcnt(4)
    v_mfma_f32_32x32x16_bf16 v[64:79], v[32:35], v[36:39], v[64:79]
    ds_read_b128 v[24:27], v5 offset:2464
    ds_read_b128 v[28:31], v6 offset:36352
    s_waitcnt lgkmcnt(4)
    v_mfma_f32_32x32x16_bf16 v[64:79], v[40:43], v[44:47], v[64:79]
    ds_read_b128 v[32:35], v5 offset:2496
    ds_read_b128 v[36:39], v6 offset:36400
    s_waitcnt lgkmcnt(4)
    v_mfma_f32_32x32x16_bf16 v[64:79], v[16:19], v[20:23], v[64:79]
    ds_read_b128 v[40:43], v5 offset:2528
    ds_read_b128 v[44:47], v6 offset:36432
    s_waitcnt lgkmcnt(4)
    v_mfma_f32_32x32x16_bf16 v[64:79], v[24:27], v[28:31], v[64:79]
    ds_read_b128 v[16:19], v5 offset:2560
    ds_read_b128 v[20:23], v6 offset:36480
    s_waitcnt lgkmcnt(4)
    v_mfma_f32_32x32x16_bf16 v[64:79], v[32:35], v[36:39], v[64:79]
    ds_read_b128 v[24:27], v5 offset:2592
    ds_read_b128 v[28:31], v6 offset:36512
    s_waitcnt lgkmcnt(4)
    v_mfma_f32_32x32x16_bf16 v[64:79], v[40:43], v[44:47], v[64:79]
    ds_read_b128 v[32:35], v5 offset:2624
    ds_read_b128 v[36:39], v6 offset:36560
    s_waitcnt lgkmcnt(4)
    v_mfma_f32_32x32x16_bf16 v[64:79], v[16:19], v[20:23], v[64:79]
    ds_read_b128 v[40:43], v5 offset:2656
    ds_read_b128 v[44:47], v6 offset:36592
    s_waitcnt lgkmcnt(4)
    v_mfma_f32_32x32x16_bf16 v[64:79], v[24:27], v[28:31], v[64:79]
    ds_read_b128 v[16:19], v5 offset:2688
    ds_read_b128 v[20:23], v6 offset:36640
    s_waitcnt lgkmcnt(4)
    v_mfma_f32_32x32x16_bf16 v[64:79], v[32:35], v[36:39], v[64:79]
    ds_read_b128 v[24:27], v5 offset:2720
    ds_read_b128 v[28:31], v6 offset:36672
    s_waitcnt lgkmcnt(4)
    v_mfma_f32_32x32x16_bf16 v[64:79], v[40:43], v[44:47], v[64:79]
    ds_read_b128 v[32:35], v5 offset:2752
    ds_read_b128 v[36:39], v6 offset:36720
    s_waitcnt lgkmcnt(4)
    v_mfma_f32_32x32x16_bf16 v[64:79], v[16:19], v[20:23], v[64:79]
    ds_read_b128 v[40:43], v5 offset:2784
    ds_read_b128 v[44:47], v6 offset:36752
    s_waitcnt lgkmcnt(4)
    v_mfma_f32_32x32x16_bf16 v[64:79], v[24:27], v[28:31], v[64:79]
    ds_read_b128 v[16:19], v5 offset:2816
    ds_read_b128 v[20:23], v6 offset:36800
    s_waitcnt lgkmcnt(4)
    v_mfma_f32_32x32x16_bf16 v[64:79], v[32:35], v[36:39], v[64:79]
    ds_read_b128 v[24:27], v5 offset:2848
    ds_read_b128 v[28:31], v6 offset:36832
    s_waitcnt lgkmcnt(4)
    v_mfma_f32_32x32x16_bf16 v[64:79], v[40:43], v[44:47], v[64:79]
    ds_read_b128 v[32:35], v5 offset:2880
    ds_read_b128 v[36:39], v6 offset:36880
    s_waitcnt lgkmcnt(4)
    v_mfma_f32_32x32x16_bf16 v[64:79], v[16:19], v[20:23], v[64:79]
    ds_read_b128 v[40:43], v5 offset:2912
    ds_read_b128 v[44:47], v6 offset:36912
    s_waitcnt lgkmcnt(4)
    v_mfma_f32_32x32x16_bf16 v[64:79], v[24:27], v[28:31], v[64:79]
    ds_read_b128 v[16:19], v5 offset:2944
    ds_read_b128 v[20:23], v6 offset:36960
    s_waitcnt lgkmcnt(4)
    v_mfma_f32_32x32x16_bf16 v[64:79], v[32:35], v[36:39], v[64:79]
    ds_read_b128 v[24:27], v5 offset:2976
    ds_read_b128 v[28:31], v6 offset:36992
    s_waitcnt lgkmcnt(4)
    v_mfma_f32_32x32x16_bf16 v[64:79], v[40:43], v[44:47], v[64:79]
    ds_read_b128 v[32:35], v5 offset:3008
    ds_read_b128 v[36:39], v6 offset:37040
    s_waitcnt lgkmcnt(4)
    v_mfma_f32_32x32x16_bf16 v[64:79], v[16:19], v[20:23], v[64:79]
    ds_read_b128 v[40:43], v5 offset:3040
    ds_read_b128 v[44:47], v6 offset:37072
    s_waitcnt lgkmcnt(4)
    v_mfma_f32_32x32x16_bf16 v[64:79], v[24:27], v[28:31], v[64:79]
    ds_read_b128 v[16:19], v5 offset:3072
    ds_read_b128 v[20:23], v6 offset:37120
    s_waitcnt lgkmcnt(4)
    v_mfma_f32_32x32x16_bf16 v[64:79], v[32:35], v[36:39], v[64:79]
    ds_read_b128 v[24:27], v5 offset:3104
    ds_read_b128 v[28:31], v6 offset:37152
    s_waitcnt lgkmcnt(4)
    v_mfma_f32_32x32x16_bf16 v[64:79], v[40:43], v[44:47], v[64:79]
    ds_read_b128 v[32:35], v5 offset:3136
    ds_read_b128 v[36:39], v6 offset:37200
    s_waitcnt lgkmcnt(4)
    v_mfma_f32_32x32x16_bf16 v[64:79], v[16:19], v[20:23], v[64:79]
    ds_read_b128 v[40:43], v5 offset:3168
    ds_read_b128 v[44:47], v6 offset:37232
    s_waitcnt lgkmcnt(4)
    v_mfma_f32_32x32x16_bf16 v[64:79], v[24:27], v[28:31], v[64:79]
    ds_read_b128 v[16:19], v5 offset:3200
    ds_read_b128 v[20:23], v6 offset:37280
    s_waitcnt lgkmcnt(4)
    v_mfma_f32_32x32x16_bf16 v[64:79], v[32:35], v[36:39], v[64:79]
    ds_read_b128 v[24:27], v5 offset:3232
    ds_read_b128 v[28:31], v6 offset:37312
    s_waitcnt lgkmcnt(4)
    v_mfma_f32_32x32x16_bf16 v[64:79], v[40:43], v[44:47], v[64:79]
    ds_read_b128 v[32:35], v5 offset:3264
    ds_read_b128 v[36:39], v6 offset:37360
    s_waitcnt lgkmcnt(4)
    v_mfma_f32_32x32x16_bf16 v[64:79], v[16:19], v[20:23], v[64:79]
    ds_read_b128 v[40:43], v5 offset:3296
    ds_read_b128 v[44:47], v6 offset:37392
    s_waitcnt lgkmcnt(4)
    v_mfma_f32_32x32x16_bf16 v[64:79], v[24:27], v[28:31], v[64:79]
    ds_read_b128 v[16:19], v5 offset:3328
    ds_read_b128 v[20:23], v6 offset:37440
    s_waitcnt lgkmcnt(4)
    v_mfma_f32_32x32x16_bf16 v[64:79], v[32:35], v[36:39], v[64:79]
    ds_read_b128 v[24:27], v5 offset:3360
    ds_read_b128 v[28:31], v6 offset:37472
    s_waitcnt lgkmcnt(4)
    v_mfma_f32_32x32x16_bf16 v[64:79], v[40:43], v[44:47], v[64:79]
    ds_read_b128 v[32:35], v5 offset:3392
    ds_read_b128 v[36:39], v6 offset:37520
    s_waitcnt lgkmcnt(4)
    v_mfma_f32_32x32x16_bf16 v[64:79], v[16:19], v[20:23], v[64:79]
    ds_read_b128 v[40:43], v5 offset:3424
    ds_read_b128 v[44:47], v6 offset:37552
    s_waitcnt lgkmcnt(4)
    v_mfma_f32_32x32x16_bf16 v[64:79], v[24:27], v[28:31], v[64:79]
    ds_read_b128 v[16:19], v5 offset:3456
    ds_read_b128 v[20:23], v6 offset:37600
    s_waitcnt lgkmcnt(4)
    v_mfma_f32_32x32x16_bf16 v[64:79], v[32:35], v[36:39], v[64:79]
    ds_read_b128 v[24:27], v5 offset:3488
    ds_read_b128 v[28:31], v6 offset:37632
    s_waitcnt lgkmcnt(4)
    v_mfma_f32_32x32x16_bf16 v[64:79], v[40:43], v[44:47], v[64:79]
    ds_read_b128 v[32:35], v5 offset:3520
    ds_read_b128 v[36:39], v6 offset:37680
    s_waitcnt lgkmcnt(4)
    v_mfma_f32_32x32x16_bf16 v[64:79], v[16:19], v[20:23], v[64:79]
    ds_read_b128 v[40:43], v5 offset:3552
    ds_read_b128 v[44:47], v6 offset:37712
    s_waitcnt lgkmcnt(4)
    v_mfma_f32_32x32x16_bf16 v[64:79], v[24:27], v[28:31], v[64:79]
    ds_read_b128 v[16:19], v5 offset:3584
    ds_read_b128 v[20:23], v6 offset:37760
    s_waitcnt lgkmcnt(4)
    v_mfma_f32_32x32x16_bf16 v[64:79], v[32:35], v[36:39], v[64:79]
    ds_read_b128 v[24:27], v5 offset:3616
    ds_read_b128 v[28:31], v6 offset:37792
    s_waitcnt lgkmcnt(4)
    v_mfma_f32_32x32x16_bf16 v[64:79], v[40:43], v[44:47], v[64:79]
    ds_read_b128 v[32:35], v5 offset:3648
    ds_read_b128 v[36:39], v6 offset:37840
    s_waitcnt lgkmcnt(4)
    v_mfma_f32_32x32x16_bf16 v[64:79], v[16:19], v[20:23], v[64:79]
    ds_read_b128 v[40:43], v5 offset:3680
    ds_read_b128 v[44:47], v6 offset:37872
    s_waitcnt lgkmcnt(4)
    v_mfma_f32_32x32x16_bf16 v[64:79], v[24:27], v[28:31], v[64:79]
    ds_read_b128 v[16:19], v5 offset:3712
    ds_read_b128 v[20:23], v6 offset:37920
    s_waitcnt lgkmcnt(4)
    v_mfma_f32_32x32x16_bf16 v[64:79], v[32:35], v[36:39], v[64:79]
    ds_read_b128 v[24:27], v5 offset:3744
    ds_read_b128 v[28:31], v6 offset:37952
    s_waitcnt lgkmcnt(4)
    v_mfma_f32_32x32x16_bf16 v[64:79], v[40:43], v[44:47], v[64:79]
    ds_read_b128 v[32:35], v5 offset:3776
    ds_read_b128 v[36:39], v6 offset:38000
    s_waitcnt lgkmcnt(4)
    v_mfma_f32_32x32x16_bf16 v[64:79], v[16:19], v[20:23], v[64:79]
    ds_read_b128 v[40:43], v5 offset:3808
    ds_read_b128 v[44:47], v6 offset:38032
    s_waitcnt lgkmcnt(4)
    v_mfma_f32_32x32x16_bf16 v[64:79], v[24:27], v[28:31], v[64:79]
    ds_read_b128 v[16:19], v5 offset:3840
    ds_read_b128 v[20:23], v6 offset:38080
    s_waitcnt lgkmcnt(4)
    v_mfma_f32_32x32x16_bf16 v[64:79], v[32:35], v[36:39], v[64:79]
    ds_read_b128 v[24:27], v5 offset:3872
    ds_read_b128 v[28:31], v6 offset:38112
    s_waitcnt lgkmcnt(4)
    v_mfma_f32_32x32x16_bf16 v[64:79], v[40:43], v[44:47], v[64:79]
    ds_read_b128 v[32:35], v5 offset:3904
    ds_read_b128 v[36:39], v6 offset:38160
    s_waitcnt lgkmcnt(4)
    v_mfma_f32_32x32x16_bf16 v[64:79], v[16:19], v[20:23], v[64:79]
    ds_read_b128 v[40:43], v5 offset:3936
    ds_read_b128 v[44:47], v6 offset:38192
    s_waitcnt lgkmcnt(4)
    v_mfma_f32_32x32x16_bf16 v[64:79], v[24:27], v[28:31], v[64:79]
    ds_read_b128 v[16:19], v5 offset:3968
    ds_read_b128 v[20:23], v6 offset:38240
    s_waitcnt lgkmcnt(4)
    v_mfma_f32_32x32x16_bf16 v[64:79], v[32:35], v[36:39], v[64:79]
    ds_read_b128 v[24:27], v5 offset:4000
    ds_read_b128 v[28:31], v6 offset:38272
    s_waitcnt lgkmcnt(4)
    v_mfma_f32_32x32x16_bf16 v[64:79], v[40:43], v[44:47], v[64:79]
    ds_read_b128 v[32:35], v5 offset:4032
    ds_read_b128 v[36:39], v6 offset:38320
    s_waitcnt lgkmcnt(4)
    v_mfma_f32_32x32x16_bf16 v[64:79], v[16:19], v[20:23], v[64:79]
    ds_read_b128 v[40:43], v5 offset:4064
    ds_read_b128 v[44:47], v6 offset:38352
    s_waitcnt lgkmcnt(4)
    v_mfma_f32_32x32x16_bf16 v[64:79], v[24:27], v[28:31], v[64:79]
    s_waitcnt lgkmcnt(2)
    v_mfma_f32_32x32x16_bf16 v[64:79], v[32:35], v[36:39], v[64:79]
    s_waitcnt lgkmcnt(0)
    v_mfma_f32_32x32x16_bf16 v[64:79], v[40:43], v[44:47], v[64:79]
    s_nop 5
    s_nop 5
    v_cvt_pk_bf16_f32 v96, v64, v65
    v_cvt_pk_bf16_f32 v97, v66, v67
    v_cvt_pk_bf16_f32 v98, v68, v69
    v_cvt_pk_bf16_f32 v99, v70, v71
    v_cvt_pk_bf16_f32 v100, v72, v73
    v_cvt_pk_bf16_f32 v101, v74, v75
    v_cvt_pk_bf16_f32 v102, v76, v77
    v_cvt_pk_bf16_f32 v103, v78, v79
    v_permlane32_swap_b32 v96, v98
    v_permlane32_swap_b32 v97, v99
    buffer_store_dwordx4 v[96:99], v3, s[8:11], s21 offen offset:0 sc1
    v_permlane32_swap_b32_e64 v100, v102
    v_permlane32_swap_b32_e64 v101, v103
    buffer_store_dwordx4 v[100:103], v3, s[8:11], s21 offen offset:32 sc1
    s_barrier
    s_bitcmp1_b32 s52, 2
    s_cbranch_scc1 pw_b
    s_waitcnt vmcnt(0)
    s_barrier
    s_cmp_lg_u32 s12, 0
    s_cbranch_scc1 ann_33
    v_mov_b32 v1, 2
    buffer_store_dword v1, off, s[8:11], s55 sc1
ann_33:
    s_branch pw_done
    s_nop 0
    s_nop 0
    s_nop 0
pw_rows:
    v_bfe_u32 v11, v0, 1, 4
    v_lshlrev_b32 v11, 7, v11
    v_bfe_u32 v12, v0, 5, 2
    v_lshl_add_u32 v11, v12, 12, v11
    v_lshrrev_b32 v12, 7, v0
    v_lshl_add_u32 v11, v12, 11, v11
    v_and_b32 v33, 0xffff0000, v112
    v_and_b32 v73, 0xffff0000, v116
    v_and_b32 v145, 0xffff0000, v120
    v_and_b32 v185, 0xffff0000, v124
    v_lshlrev_b32 v32, 16, v112
    v_lshlrev_b32 v72, 16, v116
    v_lshlrev_b32 v144, 16, v120
    v_lshlrev_b32 v184, 16, v124
    v_and_b32 v35, 0xffff0000, v113
    v_and_b32 v75, 0xffff0000, v117
    v_and_b32 v147, 0xffff0000, v121
    v_and_b32 v187, 0xffff0000, v125
    v_lshlrev_b32 v34, 16, v113
    v_lshlrev_b32 v74, 16, v117
    v_lshlrev_b32 v146, 16, v121
    v_lshlrev_b32 v186, 16, v125
    v_and_b32 v37, 0xffff0000, v114
    v_and_b32 v77, 0xffff0000, v118
    v_and_b32 v149, 0xffff0000, v122
    v_and_b32 v189, 0xffff0000, v126
    v_lshlrev_b32 v36, 16, v114
    v_lshlrev_b32 v76, 16, v118
    v_lshlrev_b32 v148, 16, v122
    v_lshlrev_b32 v188, 16, v126
    v_and_b32 v39, 0xffff0000, v115
    v_and_b32 v79, 0xffff0000, v119
    v_and_b32 v151, 0xffff0000, v123
    v_and_b32 v191, 0xffff0000, v127
    v_lshlrev_b32 v38, 16, v115
    v_lshlrev_b32 v78, 16, v119
    v_lshlrev_b32 v150, 16, v123
    v_lshlrev_b32 v190, 16, v127
    v_pk_add_f32 v[48:49], v[32:33], v[34:35]
    v_pk_add_f32 v[88:89], v[72:73], v[74:75]
    v_pk_add_f32 v[160:161], v[144:145], v[146:147]
    v_pk_add_f32 v[200:201], v[184:185], v[186:187]
    v_pk_mul_f32 v[52:53], v[32:33], v[32:33]
    v_pk_mul_f32 v[92:93], v[72:73], v[72:73]
    v_pk_mul_f32 v[164:165], v[144:145], v[144:145]
    v_pk_mul_f32 v[204:205], v[184:185], v[184:185]
    v_pk_add_f32 v[50:51], v[36:37], v[38:39]
    v_pk_add_f32 v[90:91], v[76:77], v[78:79]
    v_pk_add_f32 v[162:163], v[148:149], v[150:151]
    v_pk_add_f32 v[202:203], v[188:189], v[190:191]
    v_pk_mul_f32 v[54:55], v[34:35], v[34:35]
    v_pk_mul_f32 v[94:95], v[74:75], v[74:75]
    v_pk_mul_f32 v[166:167], v[146:147], v[146:147]
    v_pk_mul_f32 v[206:207], v[186:187], v[186:187]
    v_pk_fma_f32 v[52:53], v[36:37], v[36:37], v[52:53]
    v_pk_fma_f32 v[92:93], v[76:77], v[76:77], v[92:93]
    v_pk_fma_f32 v[164:165], v[148:149], v[148:149], v[164:165]
    v_pk_fma_f32 v[204:205], v[188:189], v[188:189], v[204:205]
    v_pk_fma_f32 v[54:55], v[38:39], v[38:39], v[54:55]
    v_pk_fma_f32 v[94:95], v[78:79], v[78:79], v[94:95]
    v_pk_fma_f32 v[166:167], v[150:151], v[150:151], v[166:167]
    v_pk_fma_f32 v[206:207], v[190:191], v[190:191], v[206:207]
    v_pk_add_f32 v[48:49], v[48:49], v[50:51]
    v_pk_add_f32 v[88:89], v[88:89], v[90:91]
    v_pk_add_f32 v[160:161], v[160:161], v[162:163]
    v_pk_add_f32 v[200:201], v[200:201], v[202:203]
    v_pk_add_f32 v[52:53], v[52:53], v[54:55]
    v_pk_add_f32 v[92:93], v[92:93], v[94:95]
    v_pk_add_f32 v[164:165], v[164:165], v[166:167]
    v_pk_add_f32 v[204:205], v[204:205], v[206:207]
    v_add_f32 v64, v48, v49
    v_add_f32 v104, v88, v89
    v_add_f32 v176, v160, v161
    v_add_f32 v216, v200, v201
    v_add_f32 v66, v52, v53
    v_add_f32 v106, v92, v93
    v_add_f32 v178, v164, v165
    v_add_f32 v218, v204, v205
    v_add_f32_dpp v64, v64, v64 row_ror:1 row_mask:0xf bank_mask:0xf
    v_add_f32_dpp v104, v104, v104 row_ror:1 row_mask:0xf bank_mask:0xf
    v_add_f32_dpp v176, v176, v176 row_ror:1 row_mask:0xf bank_mask:0xf
    v_add_f32_dpp v216, v216, v216 row_ror:1 row_mask:0xf bank_mask:0xf
    v_add_f32_dpp v66, v66, v66 row_ror:1 row_mask:0xf bank_mask:0xf
    v_add_f32_dpp v106, v106, v106 row_ror:1 row_mask:0xf bank_mask:0xf
    v_add_f32_dpp v178, v178, v178 row_ror:1 row_mask:0xf bank_mask:0xf
    v_add_f32_dpp v218, v218, v218 row_ror:1 row_mask:0xf bank_mask:0xf
    v_add_f32_dpp v64, v64, v64 row_ror:2 row_mask:0xf bank_mask:0xf
    v_add_f32_dpp v104, v104, v104 row_ror:2 row_mask:0xf bank_mask:0xf
    v_add_f32_dpp v176, v176, v176 row_ror:2 row_mask:0xf bank_mask:0xf
    v_add_f32_dpp v216, v216, v216 row_ror:2 row_mask:0xf bank_mask:0xf
    v_add_f32_dpp v66, v66, v66 row_ror:2 row_mask:0xf bank_mask:0xf
    v_add_f32_dpp v106, v106, v106 row_ror:2 row_mask:0xf bank_mask:0xf
    v_add_f32_dpp v178, v178, v178 row_ror:2 row_mask:0xf bank_mask:0xf
    v_add_f32_dpp v218, v218, v218 row_ror:2 row_mask:0xf bank_mask:0xf
    v_add_f32_dpp v64, v64, v64 row_ror:4 row_mask:0xf bank_mask:0xf
    v_add_f32_dpp v104, v104, v104 row_ror:4 row_mask:0xf bank_mask:0xf
    v_add_f32_dpp v176, v176, v176 row_ror:4 row_mask:0xf bank_mask:0xf
    v_add_f32_dpp v216, v216, v216 row_ror:4 row_mask:0xf bank_mask:0xf
    v_add_f32_dpp v66, v66, v66 row_ror:4 row_mask:0xf bank_mask:0xf
    v_add_f32_dpp v106, v106, v106 row_ror:4 row_mask:0xf bank_mask:0xf
    v_add_f32_dpp v178, v178, v178 row_ror:4 row_mask:0xf bank_mask:0xf
    v_add_f32_dpp v218, v218, v218 row_ror:4 row_mask:0xf bank_mask:0xf
    v_add_f32_dpp v64, v64, v64 row_ror:8 row_mask:0xf bank_mask:0xf
    v_add_f32_dpp v104, v104, v104 row_ror:8 row_mask:0xf bank_mask:0xf
    v_add_f32_dpp v176, v176, v176 row_ror:8 row_mask:0xf bank_mask:0xf
    v_add_f32_dpp v216, v216, v216 row_ror:8 row_mask:0xf bank_mask:0xf
    v_add_f32_dpp v66, v66, v66 row_ror:8 row_mask:0xf bank_mask:0xf
    v_add_f32_dpp v106, v106, v106 row_ror:8 row_mask:0xf bank_mask:0xf
    v_add_f32_dpp v178, v178, v178 row_ror:8 row_mask:0xf bank_mask:0xf
    v_add_f32_dpp v218, v218, v218 row_ror:8 row_mask:0xf bank_mask:0xf
    v_mov_b32 v65, v64
    v_mov_b32 v105, v104
    v_mov_b32 v177, v176
    v_mov_b32 v217, v216
    v_mov_b32 v67, v66
    v_mov_b32 v107, v106
    v_mov_b32 v179, v178
    v_mov_b32 v219, v218
    v_permlane16_swap_b32 v64, v65
    v_permlane16_swap_b32 v104, v105
    v_permlane16_swap_b32 v176, v177
    v_permlane16_swap_b32 v216, v217
    v_permlane16_swap_b32 v66, v67
    v_permlane16_swap_b32 v106, v107
    v_permlane16_swap_b32 v178, v179
    v_permlane16_swap_b32 v218, v219
    v_add_f32 v64, v64, v65
    v_add_f32 v104, v104, v105
    v_add_f32 v176, v176, v177
    v_add_f32 v216, v216, v217
    v_add_f32 v66, v66, v67
    v_add_f32 v106, v106, v107
    v_add_f32 v178, v178, v179
    v_add_f32 v218, v218, v219
    v_mov_b32 v65, v64
    v_mov_b32 v105, v104
    v_mov_b32 v177, v176
    v_mov_b32 v217, v216
    v_mov_b32 v67, v66
    v_mov_b32 v107, v106
    v_mov_b32 v179, v178
    v_mov_b32 v219, v218
    v_permlane32_swap_b32 v64, v65
    v_permlane32_swap_b32 v104, v105
    v_permlane32_swap_b32 v176, v177
    v_permlane32_swap_b32 v216, v217
    v_permlane32_swap_b32 v66, v67
    v_permlane32_swap_b32 v106, v107
    v_permlane32_swap_b32 v178, v179
    v_permlane32_swap_b32 v218, v219
    v_add_f32 v64, v64, v65
    v_add_f32 v104, v104, v105
    v_add_f32 v176, v176, v177
    v_add_f32 v216, v216, v217
    v_add_f32 v66, v66, v67
    v_add_f32 v106, v106, v107
    v_add_f32 v178, v178, v179
    v_add_f32 v218, v218, v219
    v_mul_f32 v64, 0x3b000000, v64
    v_mul_f32 v104, 0x3b000000, v104
    v_mul_f32 v176, 0x3b000000, v176
    v_mul_f32 v216, 0x3b000000, v216
    v_mul_f32 v66, 0x3b000000, v66
    v_mul_f32 v106, 0x3b000000, v106
    v_mul_f32 v178, 0x3b000000, v178
    v_mul_f32 v218, 0x3b000000, v218
    v_fma_f32 v66, -v64, v64, v66
    v_fma_f32 v106, -v104, v104, v106
    v_fma_f32 v178, -v176, v176, v178
    v_fma_f32 v218, -v216, v216, v218
    v_max_f32 v66, 0, v66
    v_max_f32 v106, 0, v106
    v_max_f32_e64 v178, 0, v178
    v_max_f32_e64 v218, 0, v218
    v_add_f32 v66, 0x3727c5ac, v66
    v_add_f32 v106, 0x3727c5ac, v106
    v_add_f32 v178, 0x3727c5ac, v178
    v_add_f32 v218, 0x3727c5ac, v218
    v_rsq_f32_e64 v66, v66
    v_rsq_f32_e64 v106, v106
    v_rsq_f32_e64 v178, v178
    v_rsq_f32_e64 v218, v218
    v_pk_add_f32 v[48:49], v[32:33], v[64:65] op_sel_hi:[1,0] neg_lo:[0,1] neg_hi:[0,1]
    v_pk_add_f32 v[88:89], v[72:73], v[104:105] op_sel_hi:[1,0] neg_lo:[0,1] neg_hi:[0,1]
    v_pk_add_f32 v[160:161], v[144:145], v[176:177] op_sel_hi:[1,0] neg_lo:[0,1] neg_hi:[0,1]
    v_pk_add_f32 v[200:201], v[184:185], v[216:217] op_sel_hi:[1,0] neg_lo:[0,1] neg_hi:[0,1]
    v_pk_add_f32 v[50:51], v[34:35], v[64:65] op_sel_hi:[1,0] neg_lo:[0,1] neg_hi:[0,1]
    v_pk_add_f32 v[90:91], v[74:75], v[104:105] op_sel_hi:[1,0] neg_lo:[0,1] neg_hi:[0,1]
    v_pk_add_f32 v[162:163], v[146:147], v[176:177] op_sel_hi:[1,0] neg_lo:[0,1] neg_hi:[0,1]
    v_pk_add_f32 v[202:203], v[186:187], v[216:217] op_sel_hi:[1,0] neg_lo:[0,1] neg_hi:[0,1]
    v_pk_add_f32 v[52:53], v[36:37], v[64:65] op_sel_hi:[1,0] neg_lo:[0,1] neg_hi:[0,1]
    v_pk_add_f32 v[92:93], v[76:77], v[104:105] op_sel_hi:[1,0] neg_lo:[0,1] neg_hi:[0,1]
    v_pk_add_f32 v[164:165], v[148:149], v[176:177] op_sel_hi:[1,0] neg_lo:[0,1] neg_hi:[0,1]
    v_pk_add_f32 v[204:205], v[188:189], v[216:217] op_sel_hi:[1,0] neg_lo:[0,1] neg_hi:[0,1]
    v_pk_add_f32 v[54:55], v[38:39], v[64:65] op_sel_hi:[1,0] neg_lo:[0,1] neg_hi:[0,1]
    v_pk_add_f32 v[94:95], v[78:79], v[104:105] op_sel_hi:[1,0] neg_lo:[0,1] neg_hi:[0,1]
    v_pk_add_f32 v[166:167], v[150:151], v[176:177] op_sel_hi:[1,0] neg_lo:[0,1] neg_hi:[0,1]
    v_pk_add_f32 v[206:207], v[190:191], v[216:217] op_sel_hi:[1,0] neg_lo:[0,1] neg_hi:[0,1]
    v_pk_mul_f32 v[48:49], v[48:49], v[66:67] op_sel_hi:[1,0]
    v_pk_mul_f32 v[88:89], v[88:89], v[106:107] op_sel_hi:[1,0]
    v_pk_mul_f32 v[160:161], v[160:161], v[178:179] op_sel_hi:[1,0]
    v_pk_mul_f32 v[200:201], v[200:201], v[218:219] op_sel_hi:[1,0]
    v_pk_mul_f32 v[50:51], v[50:51], v[66:67] op_sel_hi:[1,0]
    v_pk_mul_f32 v[90:91], v[90:91], v[106:107] op_sel_hi:[1,0]
    v_pk_mul_f32 v[162:163], v[162:163], v[178:179] op_sel_hi:[1,0]
    v_pk_mul_f32 v[202:203], v[202:203], v[218:219] op_sel_hi:[1,0]
    v_pk_mul_f32 v[52:53], v[52:53], v[66:67] op_sel_hi:[1,0]
    v_pk_mul_f32 v[92:93], v[92:93], v[106:107] op_sel_hi:[1,0]
    v_pk_mul_f32 v[164:165], v[164:165], v[178:179] op_sel_hi:[1,0]
    v_pk_mul_f32 v[204:205], v[204:205], v[218:219] op_sel_hi:[1,0]
    v_pk_mul_f32 v[54:55], v[54:55], v[66:67] op_sel_hi:[1,0]
    v_pk_mul_f32 v[94:95], v[94:95], v[106:107] op_sel_hi:[1,0]
    v_pk_mul_f32 v[166:167], v[166:167], v[178:179] op_sel_hi:[1,0]
    v_pk_mul_f32 v[206:207], v[206:207], v[218:219] op_sel_hi:[1,0]
    s_mul_i32 s23, s16, 0
wr_34:
    buffer_load_dwordx4 v[16:19], off, s[4:7], s23 offset:128 sc1
    s_waitcnt vmcnt(0)
    v_mov_b32_e64 v16, v19
    v_cmp_gt_u32 vcc, 0x80, v16
    s_cbranch_vccz wr_35
    s_sub_u32 s3, s3, 1
    s_cbranch_scc1 main_timeout
    s_sleep 4
    s_branch wr_34
    s_nop 0
    s_nop 0
    s_nop 0
    s_nop 0
wr_35:
    s_mov_b32 s22, 143802368
wa_37:
    buffer_load_dword v12, v11, s[8:11], s22 offen sc1
    s_waitcnt vmcnt(0)
    v_cmp_gt_u32_e64 vcc, 1, v12
    s_cbranch_vccz wa_38
    s_sub_u32 s3, s3, 1
    s_cbranch_scc1 main_timeout
    s_sleep 1
    s_branch wa_37
    s_nop 0
    s_nop 0
    s_nop 0
wa_38:
    v_lshlrev_b32 v3, 13, v0
    s_lshl_b32 s50, s50, 1
    s_add_u32 s50, s50, 127926272
    s_add_u32 s51, s50, 4096
    s_mov_b32 s22, 0x05040100
    s_mov_b32 s23, 0x07060302
    v_lshlrev_b32 v5, 2, v0
    v_add_u32 v5, 0, v5
    buffer_load_dwordx4 v[16:19], v3, s[8:11], s50 offen offset:0 sc1
    buffer_load_dwordx4 v[24:27], v3, s[8:11], s51 offen offset:0 sc1
    buffer_load_dwordx4 v[20:23], v3, s[8:11], s50 offen offset:16 sc1
    buffer_load_dwordx4 v[28:31], v3, s[8:11], s51 offen offset:16 sc1
    s_waitcnt vmcnt(2)
    v_perm_b32 v6, v24, v16, s22
    ds_write_b32 v5, v6 offset:0
    v_perm_b32 v7, v24, v16, s23
    ds_write_b32 v5, v7 offset:1024
    v_perm_b32 v6, v25, v17, s22
    ds_write_b32 v5, v6 offset:2048
    v_perm_b32 v7, v25, v17, s23
    ds_write_b32 v5, v7 offset:3072
    v_perm_b32 v6, v26, v18, s22
    ds_write_b32 v5, v6 offset:4096
    v_perm_b32 v7, v26, v18, s23
    ds_write_b32 v5, v7 offset:5120
    v_perm_b32 v6, v27, v19, s22
    ds_write_b32 v5, v6 offset:6144
    v_perm_b32 v7, v27, v19, s23
    ds_write_b32 v5, v7 offset:7168
    s_waitcnt vmcnt(0)
    v_perm_b32 v6, v28, v20, s22
    ds_write_b32 v5, v6 offset:8192
    v_perm_b32 v7, v28, v20, s23
    ds_write_b32 v5, v7 offset:9216
    v_perm_b32 v6, v29, v21, s22
    ds_write_b32 v5, v6 offset:10240
    v_perm_b32 v7, v29, v21, s23
    ds_write_b32 v5, v7 offset:11264
    v_perm_b32 v6, v30, v22, s22
    ds_write_b32 v5, v6 offset:12288
    v_perm_b32 v7, v30, v22, s23
    ds_write_b32 v5, v7 offset:13312
    v_perm_b32 v6, v31, v23, s22
    ds_write_b32 v5, v6 offset:14336
    v_perm_b32 v7, v31, v23, s23
    ds_write_b32 v5, v7 offset:15360
    v_add_u32_e64 v5, s49, v10
    v_add_u32_e64 v5, 0, v5
    s_add_u32 s50, s48, 130023424
    s_add_u32 s51, s48, 132120576
    s_add_u32 s49, s48, 136314880
    s_waitcnt lgkmcnt(0)
    s_barrier
    ds_read_b128 v[128:131], v5 offset:0
    ds_read_b128 v[132:135], v5 offset:1024
    ds_read_b128 v[136:139], v5 offset:2048
    ds_read_b128 v[140:143], v5 offset:3072
    s_waitcnt lgkmcnt(3)
    v_and_b32 v41, 0xffff0000, v128
    s_waitcnt lgkmcnt(2)
    v_and_b32 v81, 0xffff0000, v132
    s_waitcnt lgkmcnt(1)
    v_and_b32 v153, 0xffff0000, v136
    s_waitcnt lgkmcnt(0)
    v_and_b32 v193, 0xffff0000, v140
    v_lshlrev_b32 v40, 16, v128
    v_lshlrev_b32 v80, 16, v132
    v_lshlrev_b32 v152, 16, v136
    v_lshlrev_b32 v192, 16, v140
    v_and_b32 v43, 0xffff0000, v129
    v_and_b32 v83, 0xffff0000, v133
    v_and_b32 v155, 0xffff0000, v137
    v_and_b32 v195, 0xffff0000, v141
    v_lshlrev_b32 v42, 16, v129
    v_lshlrev_b32 v82, 16, v133
    v_lshlrev_b32 v154, 16, v137
    v_lshlrev_b32 v194, 16, v141
    v_and_b32 v45, 0xffff0000, v130
    v_and_b32 v85, 0xffff0000, v134
    v_and_b32 v157, 0xffff0000, v138
    v_and_b32 v197, 0xffff0000, v142
    v_lshlrev_b32 v44, 16, v130
    v_lshlrev_b32 v84, 16, v134
    v_lshlrev_b32 v156, 16, v138
    v_lshlrev_b32 v196, 16, v142
    v_and_b32 v47, 0xffff0000, v131
    v_and_b32 v87, 0xffff0000, v135
    v_and_b32 v159, 0xffff0000, v139
    v_and_b32 v199, 0xffff0000, v143
    v_lshlrev_b32 v46, 16, v131
    v_lshlrev_b32 v86, 16, v135
    v_lshlrev_b32 v158, 16, v139
    v_lshlrev_b32 v198, 16, v143
    v_pk_fma_f32 v[32:33], v[48:49], v[40:41], v[32:33]
    v_pk_fma_f32 v[72:73], v[88:89], v[80:81], v[72:73]
    v_pk_fma_f32 v[144:145], v[160:161], v[152:153], v[144:145]
    v_pk_fma_f32 v[184:185], v[200:201], v[192:193], v[184:185]
    v_pk_fma_f32 v[34:35], v[50:51], v[42:43], v[34:35]
    v_pk_fma_f32 v[74:75], v[90:91], v[82:83], v[74:75]
    v_pk_fma_f32 v[146:147], v[162:163], v[154:155], v[146:147]
    v_pk_fma_f32 v[186:187], v[202:203], v[194:195], v[186:187]
    v_pk_fma_f32 v[36:37], v[52:53], v[44:45], v[36:37]
    v_pk_fma_f32 v[76:77], v[92:93], v[84:85], v[76:77]
    v_pk_fma_f32 v[148:149], v[164:165], v[156:157], v[148:149]
    v_pk_fma_f32 v[188:189], v[204:205], v[196:197], v[188:189]
    v_pk_fma_f32 v[38:39], v[54:55], v[46:47], v[38:39]
    v_pk_fma_f32 v[78:79], v[94:95], v[86:87], v[78:79]
    v_pk_fma_f32 v[150:151], v[166:167], v[158:159], v[150:151]
    v_pk_fma_f32 v[190:191], v[206:207], v[198:199], v[190:191]
    v_cvt_pk_bf16_f32 v56, v32, v33
    v_cvt_pk_bf16_f32 v96, v72, v73
    v_cvt_pk_bf16_f32 v168, v144, v145
    v_cvt_pk_bf16_f32 v208, v184, v185
    v_cvt_pk_bf16_f32 v57, v34, v35
    v_cvt_pk_bf16_f32 v97, v74, v75
    v_cvt_pk_bf16_f32 v169, v146, v147
    v_cvt_pk_bf16_f32 v209, v186, v187
    v_cvt_pk_bf16_f32 v58, v36, v37
    v_cvt_pk_bf16_f32 v98, v76, v77
    v_cvt_pk_bf16_f32 v170, v148, v149
    v_cvt_pk_bf16_f32 v210, v188, v189
    v_cvt_pk_bf16_f32 v59, v38, v39
    v_cvt_pk_bf16_f32 v99, v78, v79
    v_cvt_pk_bf16_f32 v171, v150, v151
    v_cvt_pk_bf16_f32 v211, v190, v191
    v_and_b32 v33, 0xffff0000, v56
    v_and_b32 v73, 0xffff0000, v96
    v_and_b32 v145, 0xffff0000, v168
    v_and_b32 v185, 0xffff0000, v208
    v_lshlrev_b32 v32, 16, v56
    v_lshlrev_b32 v72, 16, v96
    v_lshlrev_b32 v144, 16, v168
    v_lshlrev_b32 v184, 16, v208
    v_and_b32 v35, 0xffff0000, v57
    v_and_b32 v75, 0xffff0000, v97
    v_and_b32 v147, 0xffff0000, v169
    v_and_b32 v187, 0xffff0000, v209
    v_lshlrev_b32 v34, 16, v57
    v_lshlrev_b32 v74, 16, v97
    v_lshlrev_b32 v146, 16, v169
    v_lshlrev_b32 v186, 16, v209
    v_and_b32 v37, 0xffff0000, v58
    v_and_b32 v77, 0xffff0000, v98
    v_and_b32 v149, 0xffff0000, v170
    v_and_b32 v189, 0xffff0000, v210
    v_lshlrev_b32 v36, 16, v58
    v_lshlrev_b32 v76, 16, v98
    v_lshlrev_b32 v148, 16, v170
    v_lshlrev_b32 v188, 16, v210
    v_and_b32 v39, 0xffff0000, v59
    v_and_b32 v79, 0xffff0000, v99
    v_and_b32 v151, 0xffff0000, v171
    v_and_b32 v191, 0xffff0000, v211
    v_lshlrev_b32 v38, 16, v59
    v_lshlrev_b32 v78, 16, v99
    v_lshlrev_b32 v150, 16, v171
    v_lshlrev_b32 v190, 16, v211
    v_pk_add_f32 v[48:49], v[32:33], v[34:35]
    v_pk_add_f32 v[88:89], v[72:73], v[74:75]
    v_pk_add_f32 v[160:161], v[144:145], v[146:147]
    v_pk_add_f32 v[200:201], v[184:185], v[186:187]
    v_pk_mul_f32 v[52:53], v[32:33], v[32:33]
    v_pk_mul_f32 v[92:93], v[72:73], v[72:73]
    v_pk_mul_f32 v[164:165], v[144:145], v[144:145]
    v_pk_mul_f32 v[204:205], v[184:185], v[184:185]
    v_pk_add_f32 v[50:51], v[36:37], v[38:39]
    v_pk_add_f32 v[90:91], v[76:77], v[78:79]
    v_pk_add_f32 v[162:163], v[148:149], v[150:151]
    v_pk_add_f32 v[202:203], v[188:189], v[190:191]
    v_pk_mul_f32 v[54:55], v[34:35], v[34:35]
    v_pk_mul_f32 v[94:95], v[74:75], v[74:75]
    v_pk_mul_f32 v[166:167], v[146:147], v[146:147]
    v_pk_mul_f32 v[206:207], v[186:187], v[186:187]
    v_pk_fma_f32 v[52:53], v[36:37], v[36:37], v[52:53]
    v_pk_fma_f32 v[92:93], v[76:77], v[76:77], v[92:93]
    v_pk_fma_f32 v[164:165], v[148:149], v[148:149], v[164:165]
    v_pk_fma_f32 v[204:205], v[188:189], v[188:189], v[204:205]
    v_pk_fma_f32 v[54:55], v[38:39], v[38:39], v[54:55]
    v_pk_fma_f32 v[94:95], v[78:79], v[78:79], v[94:95]
    v_pk_fma_f32 v[166:167], v[150:151], v[150:151], v[166:167]
    v_pk_fma_f32 v[206:207], v[190:191], v[190:191], v[206:207]
    v_pk_add_f32 v[48:49], v[48:49], v[50:51]
    v_pk_add_f32 v[88:89], v[88:89], v[90:91]
    v_pk_add_f32 v[160:161], v[160:161], v[162:163]
    v_pk_add_f32 v[200:201], v[200:201], v[202:203]
    v_pk_add_f32 v[52:53], v[52:53], v[54:55]
    v_pk_add_f32 v[92:93], v[92:93], v[94:95]
    v_pk_add_f32 v[164:165], v[164:165], v[166:167]
    v_pk_add_f32 v[204:205], v[204:205], v[206:207]
    v_add_f32 v64, v48, v49
    v_add_f32 v104, v88, v89
    v_add_f32 v176, v160, v161
    v_add_f32 v216, v200, v201
    v_add_f32 v66, v52, v53
    v_add_f32 v106, v92, v93
    v_add_f32 v178, v164, v165
    v_add_f32 v218, v204, v205
    v_add_f32_dpp v64, v64, v64 row_ror:1 row_mask:0xf bank_mask:0xf
    v_add_f32_dpp v104, v104, v104 row_ror:1 row_mask:0xf bank_mask:0xf
    v_add_f32_dpp v176, v176, v176 row_ror:1 row_mask:0xf bank_mask:0xf
    v_add_f32_dpp v216, v216, v216 row_ror:1 row_mask:0xf bank_mask:0xf
    v_add_f32_dpp v66, v66, v66 row_ror:1 row_mask:0xf bank_mask:0xf
    v_add_f32_dpp v106, v106, v106 row_ror:1 row_mask:0xf bank_mask:0xf
    v_add_f32_dpp v178, v178, v178 row_ror:1 row_mask:0xf bank_mask:0xf
    v_add_f32_dpp v218, v218, v218 row_ror:1 row_mask:0xf bank_mask:0xf
    v_add_f32_dpp v64, v64, v64 row_ror:2 row_mask:0xf bank_mask:0xf
    v_add_f32_dpp v104, v104, v104 row_ror:2 row_mask:0xf bank_mask:0xf
    v_add_f32_dpp v176, v176, v176 row_ror:2 row_mask:0xf bank_mask:0xf
    v_add_f32_dpp v216, v216, v216 row_ror:2 row_mask:0xf bank_mask:0xf
    v_add_f32_dpp v66, v66, v66 row_ror:2 row_mask:0xf bank_mask:0xf
    v_add_f32_dpp v106, v106, v106 row_ror:2 row_mask:0xf bank_mask:0xf
    v_add_f32_dpp v178, v178, v178 row_ror:2 row_mask:0xf bank_mask:0xf
    v_add_f32_dpp v218, v218, v218 row_ror:2 row_mask:0xf bank_mask:0xf
    v_add_f32_dpp v64, v64, v64 row_ror:4 row_mask:0xf bank_mask:0xf
    v_add_f32_dpp v104, v104, v104 row_ror:4 row_mask:0xf bank_mask:0xf
    v_add_f32_dpp v176, v176, v176 row_ror:4 row_mask:0xf bank_mask:0xf
    v_add_f32_dpp v216, v216, v216 row_ror:4 row_mask:0xf bank_mask:0xf
    v_add_f32_dpp v66, v66, v66 row_ror:4 row_mask:0xf bank_mask:0xf
    v_add_f32_dpp v106, v106, v106 row_ror:4 row_mask:0xf bank_mask:0xf
    v_add_f32_dpp v178, v178, v178 row_ror:4 row_mask:0xf bank_mask:0xf
    v_add_f32_dpp v218, v218, v218 row_ror:4 row_mask:0xf bank_mask:0xf
    v_add_f32_dpp v64, v64, v64 row_ror:8 row_mask:0xf bank_mask:0xf
    v_add_f32_dpp v104, v104, v104 row_ror:8 row_mask:0xf bank_mask:0xf
    v_add_f32_dpp v176, v176, v176 row_ror:8 row_mask:0xf bank_mask:0xf
    v_add_f32_dpp v216, v216, v216 row_ror:8 row_mask:0xf bank_mask:0xf
    v_add_f32_dpp v66, v66, v66 row_ror:8 row_mask:0xf bank_mask:0xf
    v_add_f32_dpp v106, v106, v106 row_ror:8 row_mask:0xf bank_mask:0xf
    v_add_f32_dpp v178, v178, v178 row_ror:8 row_mask:0xf bank_mask:0xf
    v_add_f32_dpp v218, v218, v218 row_ror:8 row_mask:0xf bank_mask:0xf
    v_mov_b32 v65, v64
    v_mov_b32 v105, v104
    v_mov_b32 v177, v176
    v_mov_b32 v217, v216
    v_mov_b32 v67, v66
    v_mov_b32 v107, v106
    v_mov_b32 v179, v178
    v_mov_b32 v219, v218
    v_permlane16_swap_b32 v64, v65
    v_permlane16_swap_b32 v104, v105
    v_permlane16_swap_b32 v176, v177
    v_permlane16_swap_b32 v216, v217
    v_permlane16_swap_b32 v66, v67
    v_permlane16_swap_b32 v106, v107
    v_permlane16_swap_b32 v178, v179
    v_permlane16_swap_b32 v218, v219
    v_add_f32 v64, v64, v65
    v_add_f32 v104, v104, v105
    v_add_f32 v176, v176, v177
    v_add_f32 v216, v216, v217
    v_add_f32 v66, v66, v67
    v_add_f32 v106, v106, v107
    v_add_f32 v178, v178, v179
    v_add_f32 v218, v218, v219
    v_mov_b32 v65, v64
    v_mov_b32 v105, v104
    v_mov_b32 v177, v176
    v_mov_b32 v217, v216
    v_mov_b32 v67, v66
    v_mov_b32 v107, v106
    v_mov_b32 v179, v178
    v_mov_b32 v219, v218
    v_permlane32_swap_b32 v64, v65
    v_permlane32_swap_b32 v104, v105
    v_permlane32_swap_b32 v176, v177
    v_permlane32_swap_b32 v216, v217
    v_permlane32_swap_b32 v66, v67
    v_permlane32_swap_b32 v106, v107
    v_permlane32_swap_b32 v178, v179
    v_permlane32_swap_b32 v218, v219
    v_add_f32 v64, v64, v65
    v_add_f32 v104, v104, v105
    v_add_f32 v176, v176, v177
    v_add_f32 v216, v216, v217
    v_add_f32 v66, v66, v67
    v_add_f32 v106, v106, v107
    v_add_f32 v178, v178, v179
    v_add_f32 v218, v218, v219
    v_mul_f32 v64, 0x3b000000, v64
    v_mul_f32 v104, 0x3b000000, v104
    v_mul_f32 v176, 0x3b000000, v176
    v_mul_f32 v216, 0x3b000000, v216
    v_mul_f32 v66, 0x3b000000, v66
    v_mul_f32 v106, 0x3b000000, v106
    v_mul_f32 v178, 0x3b000000, v178
    v_mul_f32 v218, 0x3b000000, v218
    v_fma_f32 v66, -v64, v64, v66
    v_fma_f32 v106, -v104, v104, v106
    v_fma_f32 v178, -v176, v176, v178
    v_fma_f32 v218, -v216, v216, v218
    v_max_f32 v66, 0, v66
    v_max_f32 v106, 0, v106
    v_max_f32 v178, 0, v178
    v_max_f32 v218, 0, v218
    v_add_f32 v66, 0x3727c5ac, v66
    v_add_f32 v106, 0x3727c5ac, v106
    v_add_f32 v178, 0x3727c5ac, v178
    v_add_f32 v218, 0x3727c5ac, v218
    v_rsq_f32 v66, v66
    v_rsq_f32 v106, v106
    v_rsq_f32 v178, v178
    v_rsq_f32 v218, v218
    v_pk_add_f32 v[48:49], v[32:33], v[64:65] op_sel_hi:[1,0] neg_lo:[0,1] neg_hi:[0,1]
    v_pk_add_f32 v[88:89], v[72:73], v[104:105] op_sel_hi:[1,0] neg_lo:[0,1] neg_hi:[0,1]
    v_pk_add_f32 v[160:161], v[144:145], v[176:177] op_sel_hi:[1,0] neg_lo:[0,1] neg_hi:[0,1]
    v_pk_add_f32 v[200:201], v[184:185], v[216:217] op_sel_hi:[1,0] neg_lo:[0,1] neg_hi:[0,1]
    v_pk_add_f32 v[50:51], v[34:35], v[64:65] op_sel_hi:[1,0] neg_lo:[0,1] neg_hi:[0,1]
    v_pk_add_f32 v[90:91], v[74:75], v[104:105] op_sel_hi:[1,0] neg_lo:[0,1] neg_hi:[0,1]
    v_pk_add_f32 v[162:163], v[146:147], v[176:177] op_sel_hi:[1,0] neg_lo:[0,1] neg_hi:[0,1]
    v_pk_add_f32 v[202:203], v[186:187], v[216:217] op_sel_hi:[1,0] neg_lo:[0,1] neg_hi:[0,1]
    v_pk_add_f32 v[52:53], v[36:37], v[64:65] op_sel_hi:[1,0] neg_lo:[0,1] neg_hi:[0,1]
    v_pk_add_f32 v[92:93], v[76:77], v[104:105] op_sel_hi:[1,0] neg_lo:[0,1] neg_hi:[0,1]
    v_pk_add_f32 v[164:165], v[148:149], v[176:177] op_sel_hi:[1,0] neg_lo:[0,1] neg_hi:[0,1]
    v_pk_add_f32 v[204:205], v[188:189], v[216:217] op_sel_hi:[1,0] neg_lo:[0,1] neg_hi:[0,1]
    v_pk_add_f32 v[54:55], v[38:39], v[64:65] op_sel_hi:[1,0] neg_lo:[0,1] neg_hi:[0,1]
    v_pk_add_f32 v[94:95], v[78:79], v[104:105] op_sel_hi:[1,0] neg_lo:[0,1] neg_hi:[0,1]
    v_pk_add_f32 v[166:167], v[150:151], v[176:177] op_sel_hi:[1,0] neg_lo:[0,1] neg_hi:[0,1]
    v_pk_add_f32 v[206:207], v[190:191], v[216:217] op_sel_hi:[1,0] neg_lo:[0,1] neg_hi:[0,1]
    v_pk_mul_f32 v[48:49], v[48:49], v[66:67] op_sel_hi:[1,0]
    v_pk_mul_f32 v[88:89], v[88:89], v[106:107] op_sel_hi:[1,0]
    v_pk_mul_f32 v[160:161], v[160:161], v[178:179] op_sel_hi:[1,0]
    v_pk_mul_f32 v[200:201], v[200:201], v[218:219] op_sel_hi:[1,0]
    v_pk_mul_f32 v[50:51], v[50:51], v[66:67] op_sel_hi:[1,0]
    v_pk_mul_f32 v[90:91], v[90:91], v[106:107] op_sel_hi:[1,0]
    v_pk_mul_f32 v[162:163], v[162:163], v[178:179] op_sel_hi:[1,0]
    v_pk_mul_f32 v[202:203], v[202:203], v[218:219] op_sel_hi:[1,0]
    v_pk_mul_f32 v[52:53], v[52:53], v[66:67] op_sel_hi:[1,0]
    v_pk_mul_f32 v[92:93], v[92:93], v[106:107] op_sel_hi:[1,0]
    v_pk_mul_f32 v[164:165], v[164:165], v[178:179] op_sel_hi:[1,0]
    v_pk_mul_f32 v[204:205], v[204:205], v[218:219] op_sel_hi:[1,0]
    v_pk_mul_f32 v[54:55], v[54:55], v[66:67] op_sel_hi:[1,0]
    v_pk_mul_f32 v[94:95], v[94:95], v[106:107] op_sel_hi:[1,0]
    v_pk_mul_f32 v[166:167], v[166:167], v[178:179] op_sel_hi:[1,0]
    v_pk_mul_f32 v[206:207], v[206:207], v[218:219] op_sel_hi:[1,0]
    v_cvt_pk_bf16_f32 v60, v48, v49
    v_cvt_pk_bf16_f32 v100, v88, v89
    v_cvt_pk_bf16_f32 v172, v160, v161
    v_cvt_pk_bf16_f32 v212, v200, v201
    v_cvt_pk_bf16_f32 v61, v50, v51
    v_cvt_pk_bf16_f32 v101, v90, v91
    v_cvt_pk_bf16_f32 v173, v162, v163
    v_cvt_pk_bf16_f32 v213, v202, v203
    v_cvt_pk_bf16_f32 v62, v52, v53
    v_cvt_pk_bf16_f32 v102, v92, v93
    v_cvt_pk_bf16_f32 v174, v164, v165
    v_cvt_pk_bf16_f32 v214, v204, v205
    v_cvt_pk_bf16_f32 v63, v54, v55
    v_cvt_pk_bf16_f32 v103, v94, v95
    v_cvt_pk_bf16_f32 v175, v166, v167
    v_cvt_pk_bf16_f32 v215, v206, v207
    buffer_store_dwordx4 v[60:63], v10, s[8:11], s49 offen offset:0 sc1
    buffer_store_dwordx4 v[100:103], v10, s[8:11], s49 offen offset:1024 sc1
    buffer_store_dwordx4 v[172:175], v10, s[8:11], s49 offen offset:2048 sc1
    buffer_store_dwordx4 v[212:215], v10, s[8:11], s49 offen offset:3072 sc1
    s_waitcnt vmcnt(0)
    s_barrier
    s_cmp_lg_u32 s12, 0
    s_cbranch_scc1 ann_39
    v_mov_b32_e64 v1, 2
    buffer_store_dword v1, off, s[8:11], s55 sc1
ann_39:
    buffer_store_dwordx4 v[128:131], v10, s[8:11], s50 offen offset:0 sc1
    buffer_store_dwordx4 v[56:59], v10, s[8:11], s51 offen offset:0 sc1
    buffer_store_dwordx4 v[132:135], v10, s[8:11], s50 offen offset:1024 sc1
    buffer_store_dwordx4 v[96:99], v10, s[8:11], s51 offen offset:1024 sc1
    buffer_store_dwordx4 v[136:139], v10, s[8:11], s50 offen offset:2048 sc1
    buffer_store_dwordx4 v[168:171], v10, s[8:11], s51 offen offset:2048 sc1
    buffer_store_dwordx4 v[140:143], v10, s[8:11], s50 offen offset:3072 sc1
    buffer_store_dwordx4 v[208:211], v10, s[8:11], s51 offen offset:3072 sc1
pw_done:
    v_mov_b32 v255, 0
    s_branch main_roles
main_end:
.section .rodata,"a"
.p2align 6
.amdhsa_kernel interleave_layers__ssm_conv_h3__memory_aug_recurrent_mem_tr__prompt_kernel
  .amdhsa_next_free_vgpr 512
  .amdhsa_next_free_sgpr 102
  .amdhsa_accum_offset 256
  .amdhsa_group_segment_fixed_size 0
  .amdhsa_kernarg_size 128
  .amdhsa_user_sgpr_count 2
  .amdhsa_user_sgpr_kernarg_segment_ptr 1
  .amdhsa_system_sgpr_workgroup_id_x 1
.end_amdhsa_kernel
```
